```python
import torch

def _softmax(x, axis=-1):
    return torch.softmax(x, dim=axis)
def _gelu(x):
    return torch.nn.functional.gelu(x, approximate="tanh")
def _silu(x):
    return torch.nn.functional.silu(x)
def _sigmoid(x):
    return torch.sigmoid(x)
def _layernorm(x, axis=-1, eps=1e-5):
    m = x.mean(dim=axis, keepdim=True)
    v = x.var(dim=axis, keepdim=True, unbiased=False)
    return (x - m) / torch.sqrt(v + eps)
def _scatter_add(tgt, idx, src, axis=0):
    return tgt.clone().index_add_(axis, idx, src)
def _segment_sum(src, seg, n):
    out = torch.zeros((n,) + src.shape[1:], dtype=src.dtype)
    return out.index_add_(0, seg, src)
def _pad(x, pw):
    flat = tuple(v for pair in reversed(pw) for v in pair)
    return torch.nn.functional.pad(x, flat)

kernel_name = 'concat_heads__gqa_block_cached__mha_block_cached__near_ridge'

def setup_inputs():

    _w = (lambda a: (lambda t: t.to(torch.bfloat16) if t.is_floating_point() else t)(torch.as_tensor(a)))
    def _A_setup():
        B, Sq, D = 8, 160, 448
        Hq, Hkv, Sk, Dh = 16, 8, 1024, 256
        assert Hq % Hkv == 0, (Hq, Hkv)
        return {
            "x": _w((lambda *s: torch.randn(*s, dtype=torch.bfloat16) * 0.8)(B, Sq, D)),
            "k_cache": _w((lambda *s: torch.randn(*s, dtype=torch.bfloat16) * 0.8)(B, Hkv, Sk, Dh)),
            "v_cache": _w((lambda *s: torch.randn(*s, dtype=torch.bfloat16) * 0.05)(B, Hkv, Sk, Dh)),
            "wq": _w((lambda *s: torch.randn(*s, dtype=torch.bfloat16) * 0.8)(D, Hq * Dh) * (D ** -0.5)),
            "wo": _w((lambda *s: torch.randn(*s, dtype=torch.bfloat16) * 0.05)(Hq * Dh, D) * ((Hq * Dh) ** -0.5)),
        }
    _A_in = _A_setup()

    def _B_setup():
        B, Sq, D = 8, 160, 448
        H, Sk, Dh = 16, 1024, 256
        return {
            "x": _w((lambda *s: torch.randn(*s, dtype=torch.bfloat16) * 0.8)(B, Sq, D)),
            "k_cache": _w((lambda *s: torch.randn(*s, dtype=torch.bfloat16) * 0.8)(B, H, Sk, Dh)),
            "v_cache": _w((lambda *s: torch.randn(*s, dtype=torch.bfloat16) * 0.05)(B, H, Sk, Dh)),
            "wq": _w((lambda *s: torch.randn(*s, dtype=torch.bfloat16) * 0.8)(D, H * Dh) * (D ** -0.5)),
            "wo": _w((lambda *s: torch.randn(*s, dtype=torch.bfloat16) * 0.05)(H * Dh, D) * ((H * Dh) ** -0.5)),
        }
    _B_in = _B_setup()

    return {
        "A_x": _A_in["x"],
        "A_k_cache": _A_in["k_cache"],
        "A_v_cache": _A_in["v_cache"],
        "A_wq": _A_in["wq"],
        "A_wo": _A_in["wo"],
        "B_x": _B_in["x"],
        "B_k_cache": _B_in["k_cache"],
        "B_v_cache": _B_in["v_cache"],
        "B_wq": _B_in["wq"],
        "B_wo": _B_in["wo"],
    }

def reference(A_x, A_k_cache, A_v_cache, A_wq, A_wo, B_x, B_k_cache, B_v_cache, B_wq, B_wo):
    def _A_ref(x, k_cache, v_cache, wq, wo):
        B, Sq, D = x.shape
        Hq, Dh = 16, 256
        Hkv = k_cache.shape[1]
        rep = Hq // Hkv
        q = (lambda x, *d: x.permute(*d))((x @ wq).reshape(B, Sq, Hq, Dh), 0, 2, 1, 3)
        k = (lambda x, n, axis: torch.repeat_interleave(x, n, dim=axis))(k_cache, rep, axis=1)
        v = (lambda x, n, axis: torch.repeat_interleave(x, n, dim=axis))(v_cache, rep, axis=1)
        scores = torch.einsum("bhqd,bhkd->bhqk", q, k) * (Dh ** -0.5)
        p = _softmax(scores, axis=-1)
        o = torch.einsum("bhqk,bhkd->bhqd", p, v)
        return (lambda x, *d: x.permute(*d))(o, 0, 2, 1, 3).reshape(B, Sq, Hq * Dh) @ wo

    def _B_ref(x, k_cache, v_cache, wq, wo):
        B, Sq, D = x.shape
        H, Dh = 16, 256
        q = (lambda x, *d: x.permute(*d))((x @ wq).reshape(B, Sq, H, Dh), 0, 2, 1, 3)
        scores = torch.einsum("bhqd,bhkd->bhqk", q, k_cache) * (Dh ** -0.5)
        p = _softmax(scores, axis=-1)
        o = torch.einsum("bhqk,bhkd->bhqd", p, v_cache)
        return (lambda x, *d: x.permute(*d))(o, 0, 2, 1, 3).reshape(B, Sq, H * Dh) @ wo

    a = _A_ref(A_x, A_k_cache, A_v_cache, A_wq, A_wo)
    b = _B_ref(B_x, B_k_cache, B_v_cache, B_wq, B_wo)
    return torch.concatenate([a, b], axis=-1)
```

```asm
; @launch grid=(256,1,1) block=(256,1,1) lds=163840
.amdgcn_target "amdgcn-amd-amdhsa--gfx950"
.text
.globl concat_heads__gqa_block_cached__mha_block_cached__near_ridge_kernel
.p2align 8
.type concat_heads__gqa_block_cached__mha_block_cached__near_ridge_kernel,@function
concat_heads__gqa_block_cached__mha_block_cached__near_ridge_kernel:
  s_cmp_ge_u32 s2, 256
  s_cbranch_scc1 L_exit
  s_load_dwordx16 s[40:55], s[0:1], 0
  s_load_dwordx4 s[56:59], s[0:1], 64
  s_load_dwordx2 s[24:25], s[0:1], 96
  s_load_dwordx4 s[96:99], s[0:1], 80
  v_and_b32 v24, 63, v0
  v_lshrrev_b32 v25, 6, v0
  s_lshr_b32 s39, s2, 5
  v_readfirstlane_b32 s28, v25
  s_bfe_u32 s35, s2, 0x20003
  s_and_b32 s33, s2, 6
  s_lshl1_add_u32 s33, s33, s35
  s_lshr_b32 s3, s33, 1
  v_lshrrev_b32 v26, 5, v24
  v_lshlrev_b32 v26, 15, v26
  v_lshl_add_u32 v26, v25, 16, v26
  v_and_b32 v27, 31, v24
  v_lshl_add_u32 v2, v27, 4, v26
  v_lshrrev_b32 v30, 4, v24
  v_and_b32 v31, 1, v25
  v_lshrrev_b32 v26, 3, v0
  v_mul_u32_u24 v26, 896, v26
  v_lshl_add_u32 v27, v31, 2, v30
  v_and_b32 v28, 7, v24
  v_xor_b32 v27, v27, v28
  v_lshl_add_u32 v3, v27, 4, v26
  s_mul_i32 s29, s28, 4224
  s_lshl_b32 s30, s28, 10
  s_lshl_b32 s31, s28, 12
  s_lshl_b32 s34, s39, 3
  s_add_u32 s34, s34, s3
  s_lshl_b32 s36, s39, 4
  s_add_u32 s36, s36, s33
  s_waitcnt lgkmcnt(0)
  s_bitcmp1_b32 s2, 0
  s_cselect_b32 s4, s50, s40
  s_cselect_b32 s5, s51, s41
  s_cselect_b32 s8, s56, s46
  s_cselect_b32 s9, s57, s47
  s_cselect_b32 s12, s52, s42
  s_cselect_b32 s13, s53, s43
  s_cselect_b32 s16, s54, s44
  s_cselect_b32 s17, s55, s45
  s_cselect_b32 s20, s58, s48
  s_cselect_b32 s21, s59, s49
  s_cselect_b32 s34, s36, s34
  s_cselect_b32 s37, 8, 0
  s_mov_b32 s56, s96
  s_mov_b32 s57, s97
  s_mov_b32 s58, s98
  s_mov_b32 s59, s99
  s_mul_i32 s35, s39, 143360
  s_add_u32 s4, s4, s35
  s_addc_u32 s5, s5, 0
  s_mov_b32 s6, 143360
  s_mov_b32 s7, 0x20000
  s_lshl_b32 s35, s33, 9
  s_add_u32 s8, s8, s35
  s_addc_u32 s9, s9, 0
  s_sub_u32 s10, 3670016, s35
  s_mov_b32 s11, 0x20000
  s_add_u32 m0, s29, 33792
  s_mov_b32 s35, 0
  buffer_load_dwordx4 v2, s[8:11], s35 offen lds
  s_add_u32 m0, s29, 34848
  s_mov_b32 s35, 8192
  buffer_load_dwordx4 v2, s[8:11], s35 offen lds
  s_add_u32 m0, s29, 35904
  s_mov_b32 s35, 16384
  buffer_load_dwordx4 v2, s[8:11], s35 offen lds
  s_add_u32 m0, s29, 36960
  s_mov_b32 s35, 24576
  buffer_load_dwordx4 v2, s[8:11], s35 offen lds
  s_add_u32 m0, s30, 67584
  s_mov_b32 s35, 0
  buffer_load_dwordx4 v3, s[4:7], s35 offen lds
  s_add_u32 m0, s30, 71680
  s_mov_b32 s35, 28672
  buffer_load_dwordx4 v3, s[4:7], s35 offen lds
  s_add_u32 m0, s30, 75776
  s_mov_b32 s35, 57344
  buffer_load_dwordx4 v3, s[4:7], s35 offen lds
  s_add_u32 m0, s30, 79872
  s_mov_b32 s35, 86016
  buffer_load_dwordx4 v3, s[4:7], s35 offen lds
  s_add_u32 m0, s30, 83968
  s_mov_b32 s35, 114688
  buffer_load_dwordx4 v3, s[4:7], s35 offen lds
  s_add_u32 m0, s29, 146944
  s_mov_b32 s35, 262144
  buffer_load_dwordx4 v2, s[8:11], s35 offen lds
  s_add_u32 m0, s29, 148000
  s_mov_b32 s35, 270336
  buffer_load_dwordx4 v2, s[8:11], s35 offen lds
  s_add_u32 m0, s29, 149056
  s_mov_b32 s35, 278528
  buffer_load_dwordx4 v2, s[8:11], s35 offen lds
  s_add_u32 m0, s29, 150112
  s_mov_b32 s35, 286720
  buffer_load_dwordx4 v2, s[8:11], s35 offen lds
  v_and_b32 v29, 15, v24
  v_lshrrev_b32 v32, 2, v24
  v_and_b32 v33, 3, v24
  v_lshrrev_b32 v34, 1, v25
  v_mul_u32_u24 v26, 1056, v32
  v_lshl_add_u32 v26, v31, 8, v26
  v_lshl_add_u32 v9, v33, 4, v26
  v_lshl_add_u32 v36, v33, 3, v26
  v_add_u32 v10, 130048, v9
  v_mul_u32_u24 v26, 80, v34
  v_add_u32 v26, v26, v29
  v_lshlrev_b32 v26, 7, v26
  v_lshrrev_b32 v27, 1, v29
  v_xor_b32 v27, v27, v30
  v_lshl_add_u32 v26, v27, 4, v26
  v_add_u32 v11, 67584, v26
  v_xor_b32 v12, 64, v11
  s_getpc_b64 s[40:41]
L_code_ref:
  s_lshr_b32 s42, s2, 3
  s_lshl_b32 s42, s42, 11
  v_lshl_add_u32 v26, v25, 2, v33
  v_lshl_add_u32 v26, v26, 7, s42
  v_min_u32 v26, L_code_end-L_code_ref-4, v26
  global_load_dword v93, v26, s[40:41]
  s_add_u32 m0, s29, 50688
  s_mov_b32 s35, 524288
  buffer_load_dwordx4 v2, s[8:11], s35 offen lds
  s_add_u32 m0, s29, 51744
  s_mov_b32 s35, 532480
  buffer_load_dwordx4 v2, s[8:11], s35 offen lds
  s_add_u32 m0, s29, 52800
  s_mov_b32 s35, 540672
  buffer_load_dwordx4 v2, s[8:11], s35 offen lds
  s_add_u32 m0, s29, 53856
  s_mov_b32 s35, 548864
  buffer_load_dwordx4 v2, s[8:11], s35 offen lds
  s_waitcnt vmcnt(9)
  s_barrier
  ds_read_b64_tr_b16 a[162:163], v9 offset:34304
  ds_read_b64_tr_b16 a[160:161], v9 offset:33792
  ds_read_b128 v[44:47], v11 offset:0
  ds_read_b128 v[48:51], v11 offset:2048
  ds_read_b128 v[52:55], v11 offset:4096
  s_add_u32 m0, s30, 88064
  s_mov_b32 s35, 128
  v_mov_b32 v86, 0
  ds_read_b128 v[56:59], v11 offset:6144
  v_mov_b32 v87, 0
  v_mov_b32 v84, 0
  ds_read_b64_tr_b16 a[166:167], v9 offset:34312
  v_lshlrev_b32 v89, 4, v0
  v_mov_b32 v85, 0
  ds_read_b128 v[60:63], v11 offset:8192
  s_lshr_b32 s54, s2, 3
  s_mul_i32 s54, s54, 1024
  ds_read_b64_tr_b16 a[164:165], v9 offset:33800
  s_add_u32 s54, s54, L_post-L_code_ref
  ds_read_b64_tr_b16 a[168:169], v9 offset:33856
  ds_read_b64_tr_b16 a[170:171], v9 offset:34368
  s_waitcnt lgkmcnt(8)
  v_mfma_f32_16x16x32_bf16 v[96:99], a[160:163], v[44:47], 0
  s_waitcnt lgkmcnt(7)
  ds_read_b64_tr_b16 a[172:173], v9 offset:33864
  v_mfma_f32_16x16x32_bf16 v[100:103], a[160:163], v[48:51], 0
  s_waitcnt lgkmcnt(7)
  buffer_load_dwordx4 v3, s[4:7], s35 offen lds
  s_mov_b32 s35, 28800
  v_mfma_f32_16x16x32_bf16 v[104:107], a[160:163], v[52:55], 0
  s_waitcnt lgkmcnt(6)
  s_add_u32 m0, s30, 92160
  ds_read_b64_tr_b16 a[174:175], v9 offset:34376
  v_lshlrev_b32 v26, 12, v25
  v_mfma_f32_16x16x32_bf16 v[108:111], a[160:163], v[56:59], 0
  s_waitcnt lgkmcnt(5)
  s_lshl_b32 s3, s34, 19
  ds_read_b64_tr_b16 a[176:177], v9 offset:33920
  v_lshl_add_u32 v1, v24, 4, v26
  ds_read_b64_tr_b16 a[178:179], v9 offset:34432
  ds_read_b64_tr_b16 a[180:181], v9 offset:33928
  buffer_load_dwordx4 v3, s[4:7], s35 offen lds
  s_add_u32 m0, s30, 96256
  v_mfma_f32_16x16x32_bf16 v[112:115], a[160:163], v[60:63], 0
  s_waitcnt lgkmcnt(7)
  s_mov_b32 s35, 57472
  ds_read_b64_tr_b16 a[182:183], v9 offset:34440
  v_xor_b32 v26, 4096, v1
  v_mfma_f32_16x16x32_bf16 v[116:119], a[164:167], v[44:47], 0
  s_mov_b32 s60, s33
  ds_read_b64_tr_b16 a[190:191], v9 offset:34504
  v_add_u32 v18, 77824, v26
  v_mfma_f32_16x16x32_bf16 v[120:123], a[164:167], v[48:51], 0
  s_add_u32 s12, s12, s3
  s_addc_u32 s13, s13, 0
  ds_read_b64_tr_b16 a[184:185], v9 offset:33984
  v_mul_u32_u24 v26, 1056, v29
  v_mfma_f32_16x16x32_bf16 v[124:127], a[164:167], v[52:55], 0
  s_waitcnt vmcnt(7)
  buffer_load_dwordx4 v3, s[4:7], s35 offen lds
  v_lshl_add_u32 v26, v31, 9, v26
  v_mfma_f32_16x16x32_bf16 v[128:131], a[164:167], v[56:59], 0
  s_mov_b32 s35, 86144
  ds_read_b64_tr_b16 a[186:187], v9 offset:34496
  v_lshl_add_u32 v4, v30, 4, v26
  v_mfma_f32_16x16x32_bf16 v[132:135], a[164:167], v[60:63], 0
  s_waitcnt lgkmcnt(8)
  s_add_u32 m0, s30, 100352
  ds_read_b64_tr_b16 a[188:189], v9 offset:33992
  v_lshl_add_u32 v26, v31, 9, v36
  v_mfma_f32_16x16x32_bf16 v[136:139], a[168:171], v[44:47], 0
  s_barrier
  buffer_load_dwordx4 v3, s[4:7], s35 offen lds
  v_xor_b32 v27, 1, v31
  v_mfma_f32_16x16x32_bf16 v[140:143], a[168:171], v[48:51], 0
  s_add_u32 m0, s30, 104448
  ds_read_b64_tr_b16 a[204:205], v10 offset:16968
  s_mov_b32 s35, 114816
  v_mfma_f32_16x16x32_bf16 v[144:147], a[168:171], v[52:55], 0
  s_mul_i32 s38, s33, 229376
  ds_read_b64_tr_b16 a[218:219], v10 offset:17600
  v_add_u32 v5, 96256, v26
  v_mfma_f32_16x16x32_bf16 v[148:151], a[168:171], v[56:59], 0
  s_mov_b32 s33, 0
  buffer_load_dwordx4 v3, s[4:7], s35 offen lds
  v_lshl_add_u32 v26, v27, 9, v36
  v_mfma_f32_16x16x32_bf16 v[152:155], a[168:171], v[60:63], 0
  s_waitcnt lgkmcnt(4)
  s_add_u32 m0, s29, 130048
  ds_read_b64_tr_b16 a[214:215], v10 offset:17544
  v_add_u32 v6, 96256, v26
  v_mfma_f32_16x16x32_bf16 v[156:159], a[172:175], v[44:47], 0
  s_mov_b32 s35, 786432
  ds_read_b64_tr_b16 a[198:199], v10 offset:17416
  v_mul_u32_u24 v26, 2560, v25
  v_mfma_f32_16x16x32_bf16 v[160:163], a[172:175], v[48:51], 0
  s_mov_b32 s14, 524288
  buffer_load_dwordx4 v2, s[8:11], s35 offen lds
  v_lshl_add_u32 v26, v24, 3, v26
  v_mfma_f32_16x16x32_bf16 v[164:167], a[172:175], v[52:55], 0
  s_add_u32 m0, s29, 131104
  ds_read_b128 v[64:67], v12 offset:0
  v_bfe_u32 v27, v0, 3, 1
  v_mfma_f32_16x16x32_bf16 v[168:171], a[172:175], v[56:59], 0
  s_mov_b32 s35, 794624
  ds_read_b64_tr_b16 a[210:211], v10 offset:17536
  v_add_u32 v7, 67584, v26
  v_mfma_f32_16x16x32_bf16 v[172:175], a[172:175], v[60:63], 0
  s_mov_b32 s15, 0x20000
  ds_read_b128 v[68:71], v12 offset:2048
  v_xor_b32 v35, 1, v25
  v_mfma_f32_16x16x32_bf16 v[176:179], a[176:179], v[44:47], 0
  s_add_u32 s61, s37, s39
  buffer_load_dwordx4 v2, s[8:11], s35 offen lds
  v_mul_u32_u24 v26, 2560, v35
  v_mfma_f32_16x16x32_bf16 v[180:183], a[176:179], v[48:51], 0
  s_mov_b32 s35, 802816
  ds_read_b128 v[72:75], v12 offset:4096
  v_lshl_add_u32 v26, v24, 3, v26
  v_mfma_f32_16x16x32_bf16 v[184:187], a[176:179], v[52:55], 0
  s_add_u32 m0, s29, 132160
  ds_read_b64_tr_b16 a[206:207], v10 offset:17480
  v_add_u32 v8, 67584, v26
  v_mfma_f32_16x16x32_bf16 v[188:191], a[176:179], v[56:59], 0
  s_mul_i32 s37, s61, 2301952
  ds_read_b64_tr_b16 a[202:203], v10 offset:17472
  v_lshrrev_b32 v26, 7, v0
  v_mfma_f32_16x16x32_bf16 v[192:195], a[176:179], v[60:63], 0
  s_mov_b32 s26, 2301952
  ds_read_b64_tr_b16 a[200:201], v10 offset:16960
  v_mul_u32_u24 v26, 10, v26
  v_mfma_f32_16x16x32_bf16 v[196:199], a[180:183], v[44:47], 0
  s_mov_b32 s27, 0x20000
  ds_read_b128 v[80:83], v12 offset:8192
  v_mov_b32 v21, 0xff800000
  v_mfma_f32_16x16x32_bf16 v[200:203], a[180:183], v[48:51], 0
  s_add_u32 s24, s24, s37
  s_addc_u32 s25, s25, 0
  ds_read_b64_tr_b16 a[192:193], v10 offset:16896
  v_add_u32 v26, v26, v27
  v_mfma_f32_16x16x32_bf16 v[204:207], a[180:183], v[52:55], 0
  s_mov_b32 s18, 524288
  ds_read_b128 v[76:79], v12 offset:6144
  v_mul_u32_u24 v26, 1056, v26
  v_mfma_f32_16x16x32_bf16 v[208:211], a[180:183], v[56:59], 0
  s_mov_b32 s19, 0x20000
  ds_read_b64_tr_b16 a[222:223], v10 offset:17608
  v_and_b32 v27, 7, v0
  v_mfma_f32_16x16x32_bf16 v[212:215], a[180:183], v[60:63], 0
  s_waitcnt lgkmcnt(7)
  s_mov_b32 s34, 0
  ds_read_b64_tr_b16 a[216:217], v10 offset:17088
  v_lshl_add_u32 v26, v27, 2, v26
  v_mfma_f32_16x16x32_bf16 v[216:219], a[184:187], v[44:47], 0
  s_add_u32 s16, s16, s3
  s_addc_u32 s17, s17, 0
  ds_read_b64_tr_b16 a[194:195], v10 offset:17408
  v_add_u32 v15, 1024, v26
  v_mfma_f32_16x16x32_bf16 v[220:223], a[184:187], v[48:51], 0
  s_mov_b32 s55, 0xbdb8aa3b
  ds_read_b64_tr_b16 a[212:213], v10 offset:17032
  v_lshlrev_b32 v26, 9, v25
  v_mfma_f32_16x16x32_bf16 v[224:227], a[184:187], v[52:55], 0
  s_mov_b32 s32, 0x3db8aa3b
  ds_read_b64_tr_b16 a[220:221], v10 offset:17096
  v_lshl_add_u32 v26, v24, 2, v26
  v_mfma_f32_16x16x32_bf16 v[228:231], a[184:187], v[56:59], 0
  s_mov_b32 s23, 0x20000
  ds_read_b64_tr_b16 a[196:197], v10 offset:16904
  v_lshlrev_b32 v28, 13, v34
  v_mfma_f32_16x16x32_bf16 v[232:235], a[184:187], v[60:63], 0
  s_mul_i32 s3, s28, 1056
  ds_read_b64_tr_b16 a[208:209], v10 offset:17024
  v_lshl_add_u32 v28, v24, 4, v28
  v_mfma_f32_16x16x32_bf16 v[236:239], a[188:191], v[44:47], 0
  s_add_u32 s20, s20, s38
  s_addc_u32 s21, s21, 0
  buffer_load_dwordx4 v2, s[8:11], s35 offen lds
  s_add_u32 m0, s29, 133216
  v_mfma_f32_16x16x32_bf16 v[240:243], a[188:191], v[48:51], 0
  s_mov_b32 s35, 811008
  v_add_u32 v14, 50688, v28
  v_lshlrev_b32 v27, 1, v31
  v_mfma_f32_16x16x32_bf16 v[244:247], a[188:191], v[52:55], 0
  s_mov_b32 s22, 229376
  v_add_u32 v16, 159744, v26
  v_lshrrev_b32 v26, 3, v24
  v_mfma_f32_16x16x32_bf16 v[248:251], a[188:191], v[56:59], 0
  s_mov_b32 s36, 0
  buffer_load_dwordx4 v2, s[8:11], s35 offen lds
  s_add_u32 m0, s29, 16896
  v_mfma_f32_16x16x32_bf16 v[252:255], a[188:191], v[60:63], 0
  s_waitcnt lgkmcnt(3)
  s_mov_b32 s35, 1048576
  v_and_b32 v28, 3, v26
  v_xor_b32 v27, v27, v28
  v_mfma_f32_16x16x32_bf16 v[96:99], a[192:195], v[64:67], v[96:99]
  s_and_b32 s49, s28, 1
  v_lshlrev_b32 v27, 5, v27
  s_waitcnt vmcnt(4) lgkmcnt(0)
  v_mfma_f32_16x16x32_bf16 v[100:103], a[192:195], v[68:71], v[100:103]
  s_barrier
  ds_read_b128 v[48:51], v11 offset:22528
  v_lshl_add_u32 v27, v32, 7, v27
  ds_read_b64_tr_b16 a[172:173], v9 offset:50760
  ds_read_b128 v[60:63], v11 offset:28672
  ds_read_b128 v[52:55], v11 offset:24576
  ds_read_b64_tr_b16 a[164:165], v9 offset:50696
  ds_read_b64_tr_b16 a[162:163], v9 offset:51200
  buffer_load_dwordx4 v2, s[8:11], s35 offen lds
  s_add_u32 m0, s29, 17952
  s_mov_b32 s35, 1056768
  ds_read_b64_tr_b16 a[160:161], v9 offset:50688
  v_and_b32 v28, 7, v24
  v_lshl_add_u32 v19, v33, 3, v27
  v_lshl_add_u32 v26, v25, 5, v26
  ds_read_b128 v[56:59], v11 offset:26624
  v_mul_u32_u24 v26, 896, v26
  v_lshlrev_b32 v27, 1, v30
  ds_read_b128 v[44:47], v11 offset:20480
  buffer_load_dwordx4 v2, s[8:11], s35 offen lds
  s_add_u32 m0, s29, 19008
  ds_read_b64_tr_b16 a[168:169], v9 offset:50752
  s_mov_b32 s35, 1064960
  v_xor_b32 v27, v27, v28
  v_lshl_add_u32 v23, v27, 4, v26
  ds_read_b64_tr_b16 a[166:167], v9 offset:51208
  v_add_u32 v17, 77824, v1
  v_subrev_u32 v13, 27136, v17
  ds_read_b64_tr_b16 a[174:175], v9 offset:51272
  buffer_load_dwordx4 v2, s[8:11], s35 offen lds
  s_add_u32 m0, s29, 20064
  ds_read_b64_tr_b16 a[170:171], v9 offset:51264
  s_mov_b32 s35, 1073152
  v_mov_b32 v22, 0
  v_xor_b32 v20, 32, v19
  ds_read_b64_tr_b16 a[176:177], v9 offset:50816
  v_mfma_f32_16x16x32_bf16 v[104:107], a[192:195], v[72:75], v[104:107]
  s_mov_b32 s38, 0x53800000
  ds_read_b64_tr_b16 a[184:185], v9 offset:50880
  v_mfma_f32_16x16x32_bf16 v[108:111], a[192:195], v[76:79], v[108:111]
  ds_read_b64_tr_b16 a[186:187], v9 offset:51392
  v_mfma_f32_16x16x32_bf16 v[112:115], a[192:195], v[80:83], v[112:115]
  ds_read_b64_tr_b16 a[182:183], v9 offset:51336
  v_mfma_f32_16x16x32_bf16 v[116:119], a[196:199], v[64:67], v[116:119]
  ds_read_b64_tr_b16 a[180:181], v9 offset:50824
  v_mfma_f32_16x16x32_bf16 v[120:123], a[196:199], v[68:71], v[120:123]
  ds_read_b64_tr_b16 a[178:179], v9 offset:51328
  v_mfma_f32_16x16x32_bf16 v[124:127], a[196:199], v[72:75], v[124:127]
  ds_read_b64_tr_b16 a[188:189], v9 offset:50888
  v_mfma_f32_16x16x32_bf16 v[128:131], a[196:199], v[76:79], v[128:131]
  buffer_load_dwordx4 v2, s[8:11], s35 offen lds
  s_mov_b32 s35, 256
  v_mfma_f32_16x16x32_bf16 v[132:135], a[196:199], v[80:83], v[132:135]
  s_add_u32 m0, s30, 108544
  ds_read_b64_tr_b16 a[190:191], v9 offset:51400
  v_mfma_f32_16x16x32_bf16 v[136:139], a[200:203], v[64:67], v[136:139]
  v_mfma_f32_16x16x32_bf16 v[140:143], a[200:203], v[68:71], v[140:143]
  v_mfma_f32_16x16x32_bf16 v[144:147], a[200:203], v[72:75], v[144:147]
  buffer_load_dwordx4 v3, s[4:7], s35 offen lds
  s_add_u32 m0, s30, 112640
  v_mfma_f32_16x16x32_bf16 v[148:151], a[200:203], v[76:79], v[148:151]
  s_mov_b32 s35, 28928
  v_mfma_f32_16x16x32_bf16 v[152:155], a[200:203], v[80:83], v[152:155]
  v_mfma_f32_16x16x32_bf16 v[156:159], a[204:207], v[64:67], v[156:159]
  v_mfma_f32_16x16x32_bf16 v[160:163], a[204:207], v[68:71], v[160:163]
  v_mfma_f32_16x16x32_bf16 v[164:167], a[204:207], v[72:75], v[164:167]
  buffer_load_dwordx4 v3, s[4:7], s35 offen lds
  s_add_u32 m0, s30, 116736
  v_mfma_f32_16x16x32_bf16 v[168:171], a[204:207], v[76:79], v[168:171]
  s_mov_b32 s35, 57600
  v_mfma_f32_16x16x32_bf16 v[172:175], a[204:207], v[80:83], v[172:175]
  v_mfma_f32_16x16x32_bf16 v[176:179], a[208:211], v[64:67], v[176:179]
  v_mfma_f32_16x16x32_bf16 v[180:183], a[208:211], v[68:71], v[180:183]
  v_mfma_f32_16x16x32_bf16 v[184:187], a[208:211], v[72:75], v[184:187]
  buffer_load_dwordx4 v3, s[4:7], s35 offen lds
  s_add_u32 m0, s30, 120832
  v_mfma_f32_16x16x32_bf16 v[188:191], a[208:211], v[76:79], v[188:191]
  s_mov_b32 s35, 86272
  v_mfma_f32_16x16x32_bf16 v[192:195], a[208:211], v[80:83], v[192:195]
  v_mfma_f32_16x16x32_bf16 v[196:199], a[212:215], v[64:67], v[196:199]
  v_mfma_f32_16x16x32_bf16 v[200:203], a[212:215], v[68:71], v[200:203]
  buffer_load_dwordx4 v3, s[4:7], s35 offen lds
  s_mov_b32 s35, 114944
  v_mfma_f32_16x16x32_bf16 v[204:207], a[212:215], v[72:75], v[204:207]
  s_add_u32 m0, s30, 124928
  v_mfma_f32_16x16x32_bf16 v[208:211], a[212:215], v[76:79], v[208:211]
  v_mfma_f32_16x16x32_bf16 v[212:215], a[212:215], v[80:83], v[212:215]
  v_mfma_f32_16x16x32_bf16 v[216:219], a[216:219], v[64:67], v[216:219]
  v_mfma_f32_16x16x32_bf16 v[220:223], a[216:219], v[68:71], v[220:223]
  buffer_load_dwordx4 v3, s[4:7], s35 offen lds
  s_add_u32 m0, s29, 33792
  v_mfma_f32_16x16x32_bf16 v[224:227], a[216:219], v[72:75], v[224:227]
  s_mov_b32 s35, 1310720
  v_mfma_f32_16x16x32_bf16 v[228:231], a[216:219], v[76:79], v[228:231]
  v_mfma_f32_16x16x32_bf16 v[232:235], a[216:219], v[80:83], v[232:235]
  v_mfma_f32_16x16x32_bf16 v[236:239], a[220:223], v[64:67], v[236:239]
  buffer_load_dwordx4 v2, s[8:11], s35 offen lds
  s_add_u32 m0, s29, 34848
  v_mfma_f32_16x16x32_bf16 v[240:243], a[220:223], v[68:71], v[240:243]
  s_mov_b32 s35, 1318912
  v_mfma_f32_16x16x32_bf16 v[244:247], a[220:223], v[72:75], v[244:247]
  s_waitcnt vmcnt(10) lgkmcnt(0)
  s_barrier
  v_mfma_f32_16x16x32_bf16 v[248:251], a[220:223], v[76:79], v[248:251]
  ds_read_b64_tr_b16 a[204:205], v10 offset:72
  v_mfma_f32_16x16x32_bf16 v[252:255], a[220:223], v[80:83], v[252:255]
  ds_read_b64_tr_b16 a[198:199], v10 offset:520
  v_mfma_f32_16x16x32_bf16 v[96:99], a[160:163], v[44:47], v[96:99]
  ds_read_b64_tr_b16 a[192:193], v10 offset:0
  v_mfma_f32_16x16x32_bf16 v[100:103], a[160:163], v[48:51], v[100:103]
  ds_read_b128 v[64:67], v12 offset:20480
  ds_read_b64_tr_b16 a[206:207], v10 offset:584
  ds_read_b64_tr_b16 a[208:209], v10 offset:128
  ds_read_b128 v[80:83], v12 offset:28672
  ds_read_b64_tr_b16 a[196:197], v10 offset:8
  buffer_load_dwordx4 v2, s[8:11], s35 offen lds
  s_add_u32 m0, s29, 35904
  ds_read_b64_tr_b16 a[194:195], v10 offset:512
  s_mov_b32 s35, 1327104
  ds_read_b128 v[68:71], v12 offset:22528
  ds_read_b64_tr_b16 a[200:201], v10 offset:64
  buffer_load_dwordx4 v2, s[8:11], s35 offen lds
  s_add_u32 m0, s29, 36960
  ds_read_b128 v[76:79], v12 offset:26624
  s_mov_b32 s35, 1335296
  ds_read_b128 v[72:75], v12 offset:24576
  ds_read_b64_tr_b16 a[202:203], v10 offset:576
  v_mfma_f32_16x16x32_bf16 v[104:107], a[160:163], v[52:55], v[104:107]
  ds_read_b64_tr_b16 a[216:217], v10 offset:192
  v_mfma_f32_16x16x32_bf16 v[108:111], a[160:163], v[56:59], v[108:111]
  ds_read_b64_tr_b16 a[218:219], v10 offset:704
  v_mfma_f32_16x16x32_bf16 v[112:115], a[160:163], v[60:63], v[112:115]
  ds_read_b64_tr_b16 a[212:213], v10 offset:136
  v_mfma_f32_16x16x32_bf16 v[116:119], a[164:167], v[44:47], v[116:119]
  ds_read_b64_tr_b16 a[222:223], v10 offset:712
  v_mfma_f32_16x16x32_bf16 v[120:123], a[164:167], v[48:51], v[120:123]
  ds_read_b64_tr_b16 a[214:215], v10 offset:648
  v_mfma_f32_16x16x32_bf16 v[124:127], a[164:167], v[52:55], v[124:127]
  ds_read_b64_tr_b16 a[210:211], v10 offset:640
  v_mfma_f32_16x16x32_bf16 v[128:131], a[164:167], v[56:59], v[128:131]
  ds_read_b64_tr_b16 a[220:221], v10 offset:200
  v_mfma_f32_16x16x32_bf16 v[132:135], a[164:167], v[60:63], v[132:135]
  buffer_load_dwordx4 v2, s[8:11], s35 offen lds
  s_add_u32 m0, s29, 146944
  v_mfma_f32_16x16x32_bf16 v[136:139], a[168:171], v[44:47], v[136:139]
  s_mov_b32 s35, 1572864
  v_mfma_f32_16x16x32_bf16 v[140:143], a[168:171], v[48:51], v[140:143]
  v_mfma_f32_16x16x32_bf16 v[144:147], a[168:171], v[52:55], v[144:147]
  v_mfma_f32_16x16x32_bf16 v[148:151], a[168:171], v[56:59], v[148:151]
  v_mfma_f32_16x16x32_bf16 v[152:155], a[168:171], v[60:63], v[152:155]
  buffer_load_dwordx4 v2, s[8:11], s35 offen lds
  s_mov_b32 s35, 1581056
  v_mfma_f32_16x16x32_bf16 v[156:159], a[172:175], v[44:47], v[156:159]
  s_add_u32 m0, s29, 148000
  v_mfma_f32_16x16x32_bf16 v[160:163], a[172:175], v[48:51], v[160:163]
  v_mfma_f32_16x16x32_bf16 v[164:167], a[172:175], v[52:55], v[164:167]
  v_mfma_f32_16x16x32_bf16 v[168:171], a[172:175], v[56:59], v[168:171]
  buffer_load_dwordx4 v2, s[8:11], s35 offen lds
  s_mov_b32 s35, 1589248
  v_mfma_f32_16x16x32_bf16 v[172:175], a[172:175], v[60:63], v[172:175]
  s_add_u32 m0, s29, 149056
  v_mfma_f32_16x16x32_bf16 v[176:179], a[176:179], v[44:47], v[176:179]
  v_mfma_f32_16x16x32_bf16 v[180:183], a[176:179], v[48:51], v[180:183]
  v_mfma_f32_16x16x32_bf16 v[184:187], a[176:179], v[52:55], v[184:187]
  v_mfma_f32_16x16x32_bf16 v[188:191], a[176:179], v[56:59], v[188:191]
  buffer_load_dwordx4 v2, s[8:11], s35 offen lds
  s_mov_b32 s35, 1597440
  v_mfma_f32_16x16x32_bf16 v[192:195], a[176:179], v[60:63], v[192:195]
  s_add_u32 m0, s29, 150112
  v_mfma_f32_16x16x32_bf16 v[196:199], a[180:183], v[44:47], v[196:199]
  v_mfma_f32_16x16x32_bf16 v[200:203], a[180:183], v[48:51], v[200:203]
  v_mfma_f32_16x16x32_bf16 v[204:207], a[180:183], v[52:55], v[204:207]
  v_mfma_f32_16x16x32_bf16 v[208:211], a[180:183], v[56:59], v[208:211]
  buffer_load_dwordx4 v2, s[8:11], s35 offen lds
  s_mov_b32 s35, 384
  v_mfma_f32_16x16x32_bf16 v[212:215], a[180:183], v[60:63], v[212:215]
  s_add_u32 m0, s30, 67584
  v_mfma_f32_16x16x32_bf16 v[216:219], a[184:187], v[44:47], v[216:219]
  ds_write_b32 v15, v21 offset:2112
  v_mfma_f32_16x16x32_bf16 v[220:223], a[184:187], v[48:51], v[220:223]
  ds_write_b32 v15, v21 offset:0
  v_mfma_f32_16x16x32_bf16 v[224:227], a[184:187], v[52:55], v[224:227]
  buffer_load_dwordx4 v3, s[4:7], s35 offen lds
  s_mov_b32 s35, 29056
  v_mfma_f32_16x16x32_bf16 v[228:231], a[184:187], v[56:59], v[228:231]
  s_add_u32 m0, s30, 71680
  ds_write_b32 v15, v21 offset:6336
  v_mfma_f32_16x16x32_bf16 v[232:235], a[184:187], v[60:63], v[232:235]
  ds_write_b32 v15, v21 offset:4224
  v_mfma_f32_16x16x32_bf16 v[236:239], a[188:191], v[44:47], v[236:239]
  ds_write_b32 v15, v21 offset:8448
  v_mfma_f32_16x16x32_bf16 v[240:243], a[188:191], v[48:51], v[240:243]
  v_mfma_f32_16x16x32_bf16 v[244:247], a[188:191], v[52:55], v[244:247]
  s_waitcnt vmcnt(9) lgkmcnt(5)
  buffer_load_dwordx4 v3, s[4:7], s35 offen lds
  s_add_u32 m0, s30, 75776
  v_mfma_f32_16x16x32_bf16 v[248:251], a[188:191], v[56:59], v[248:251]
  s_barrier
  ds_read_b64_tr_b16 a[160:161], v9 offset:16896
  s_mov_b32 s35, 57728
  v_mfma_f32_16x16x32_bf16 v[252:255], a[188:191], v[60:63], v[252:255]
  ds_read_b128 v[52:55], v11 offset:45056
  v_mfma_f32_16x16x32_bf16 v[96:99], a[192:195], v[64:67], v[96:99]
  ds_read_b64_tr_b16 a[174:175], v9 offset:17480
  v_mfma_f32_16x16x32_bf16 v[100:103], a[192:195], v[68:71], v[100:103]
  ds_read_b64_tr_b16 a[176:177], v9 offset:17024
  ds_read_b64_tr_b16 a[172:173], v9 offset:16968
  ds_read_b64_tr_b16 a[166:167], v9 offset:17416
  ds_read_b128 v[48:51], v11 offset:43008
  ds_read_b128 v[44:47], v11 offset:40960
  buffer_load_dwordx4 v3, s[4:7], s35 offen lds
  s_add_u32 m0, s30, 79872
  ds_read_b128 v[60:63], v11 offset:49152
  s_mov_b32 s35, 86400
  ds_read_b64_tr_b16 a[164:165], v9 offset:16904
  ds_read_b64_tr_b16 a[168:169], v9 offset:16960
  buffer_load_dwordx4 v3, s[4:7], s35 offen lds
  s_add_u32 m0, s30, 83968
  ds_read_b128 v[56:59], v11 offset:47104
  s_mov_b32 s35, 115072
  ds_read_b64_tr_b16 a[170:171], v9 offset:17472
  ds_read_b64_tr_b16 a[162:163], v9 offset:17408
  v_mfma_f32_16x16x32_bf16 v[104:107], a[192:195], v[72:75], v[104:107]
  ds_read_b64_tr_b16 a[182:183], v9 offset:17544
  v_mfma_f32_16x16x32_bf16 v[108:111], a[192:195], v[76:79], v[108:111]
  ds_read_b64_tr_b16 a[178:179], v9 offset:17536
  v_mfma_f32_16x16x32_bf16 v[112:115], a[192:195], v[80:83], v[112:115]
  ds_read_b64_tr_b16 a[180:181], v9 offset:17032
  v_mfma_f32_16x16x32_bf16 v[116:119], a[196:199], v[64:67], v[116:119]
  ds_read_b64_tr_b16 a[186:187], v9 offset:17600
  v_mfma_f32_16x16x32_bf16 v[120:123], a[196:199], v[68:71], v[120:123]
  ds_read_b64_tr_b16 a[188:189], v9 offset:17096
  v_mfma_f32_16x16x32_bf16 v[124:127], a[196:199], v[72:75], v[124:127]
  ds_read_b64_tr_b16 a[190:191], v9 offset:17608
  v_mfma_f32_16x16x32_bf16 v[128:131], a[196:199], v[76:79], v[128:131]
  ds_read_b64_tr_b16 a[184:185], v9 offset:17088
  v_mfma_f32_16x16x32_bf16 v[132:135], a[196:199], v[80:83], v[132:135]
  v_mfma_f32_16x16x32_bf16 v[136:139], a[200:203], v[64:67], v[136:139]
  v_mfma_f32_16x16x32_bf16 v[140:143], a[200:203], v[68:71], v[140:143]
  buffer_load_dwordx4 v3, s[4:7], s35 offen lds
  s_add_u32 m0, s29, 50688
  v_mfma_f32_16x16x32_bf16 v[144:147], a[200:203], v[72:75], v[144:147]
  s_mov_b32 s35, 1835008
  v_mfma_f32_16x16x32_bf16 v[148:151], a[200:203], v[76:79], v[148:151]
  v_mfma_f32_16x16x32_bf16 v[152:155], a[200:203], v[80:83], v[152:155]
  v_mfma_f32_16x16x32_bf16 v[156:159], a[204:207], v[64:67], v[156:159]
  buffer_load_dwordx4 v2, s[8:11], s35 offen lds
  s_mov_b32 s35, 1843200
  v_mfma_f32_16x16x32_bf16 v[160:163], a[204:207], v[68:71], v[160:163]
  s_add_u32 m0, s29, 51744
  v_mfma_f32_16x16x32_bf16 v[164:167], a[204:207], v[72:75], v[164:167]
  v_mfma_f32_16x16x32_bf16 v[168:171], a[204:207], v[76:79], v[168:171]
  v_mfma_f32_16x16x32_bf16 v[172:175], a[204:207], v[80:83], v[172:175]
  v_mfma_f32_16x16x32_bf16 v[176:179], a[208:211], v[64:67], v[176:179]
  buffer_load_dwordx4 v2, s[8:11], s35 offen lds
  s_add_u32 m0, s29, 52800
  v_mfma_f32_16x16x32_bf16 v[180:183], a[208:211], v[68:71], v[180:183]
  s_mov_b32 s35, 1851392
  v_mfma_f32_16x16x32_bf16 v[184:187], a[208:211], v[72:75], v[184:187]
  v_mfma_f32_16x16x32_bf16 v[188:191], a[208:211], v[76:79], v[188:191]
  v_mfma_f32_16x16x32_bf16 v[192:195], a[208:211], v[80:83], v[192:195]
  buffer_load_dwordx4 v2, s[8:11], s35 offen lds
  s_add_u32 m0, s29, 53856
  v_mfma_f32_16x16x32_bf16 v[196:199], a[212:215], v[64:67], v[196:199]
  s_mov_b32 s35, 1859584
  v_mfma_f32_16x16x32_bf16 v[200:203], a[212:215], v[68:71], v[200:203]
  v_mfma_f32_16x16x32_bf16 v[204:207], a[212:215], v[72:75], v[204:207]
  v_mfma_f32_16x16x32_bf16 v[208:211], a[212:215], v[76:79], v[208:211]
  v_mfma_f32_16x16x32_bf16 v[212:215], a[212:215], v[80:83], v[212:215]
  buffer_load_dwordx4 v2, s[8:11], s35 offen lds
  s_add_u32 m0, s29, 130048
  v_mfma_f32_16x16x32_bf16 v[216:219], a[216:219], v[64:67], v[216:219]
  s_mov_b32 s35, 2097152
  v_mfma_f32_16x16x32_bf16 v[220:223], a[216:219], v[68:71], v[220:223]
  v_mfma_f32_16x16x32_bf16 v[224:227], a[216:219], v[72:75], v[224:227]
  v_mfma_f32_16x16x32_bf16 v[228:231], a[216:219], v[76:79], v[228:231]
  v_mfma_f32_16x16x32_bf16 v[232:235], a[216:219], v[80:83], v[232:235]
  buffer_load_dwordx4 v2, s[8:11], s35 offen lds
  s_add_u32 m0, s29, 131104
  v_mfma_f32_16x16x32_bf16 v[236:239], a[220:223], v[64:67], v[236:239]
  s_mov_b32 s35, 2105344
  v_mfma_f32_16x16x32_bf16 v[240:243], a[220:223], v[68:71], v[240:243]
  v_mfma_f32_16x16x32_bf16 v[244:247], a[220:223], v[72:75], v[244:247]
  s_waitcnt vmcnt(14) lgkmcnt(0)
  s_barrier
  v_mfma_f32_16x16x32_bf16 v[248:251], a[220:223], v[76:79], v[248:251]
  ds_read_b64_tr_b16 a[206:207], v9 offset:34376
  v_mfma_f32_16x16x32_bf16 v[252:255], a[220:223], v[80:83], v[252:255]
  ds_read_b128 v[72:75], v12 offset:45056
  v_mfma_f32_16x16x32_bf16 v[96:99], a[160:163], v[44:47], v[96:99]
  ds_read_b64_tr_b16 a[202:203], v9 offset:34368
  v_mfma_f32_16x16x32_bf16 v[100:103], a[160:163], v[48:51], v[100:103]
  ds_read_b128 v[80:83], v12 offset:49152
  ds_read_b64_tr_b16 a[204:205], v9 offset:33864
  ds_read_b64_tr_b16 a[200:201], v9 offset:33856
  ds_read_b64_tr_b16 a[192:193], v9 offset:33792
  ds_read_b64_tr_b16 a[196:197], v9 offset:33800
  buffer_load_dwordx4 v2, s[8:11], s35 offen lds
  s_add_u32 m0, s29, 132160
  ds_read_b128 v[76:79], v12 offset:47104
  s_mov_b32 s35, 2113536
  ds_read_b128 v[68:71], v12 offset:43008
  ds_read_b64_tr_b16 a[194:195], v9 offset:34304
  buffer_load_dwordx4 v2, s[8:11], s35 offen lds
  s_mov_b32 s35, 2121728
  ds_read_b64_tr_b16 a[198:199], v9 offset:34312
  s_add_u32 m0, s29, 133216
  ds_read_b128 v[64:67], v12 offset:40960
  ds_read_b64_tr_b16 a[208:209], v9 offset:33920
  v_mfma_f32_16x16x32_bf16 v[104:107], a[160:163], v[52:55], v[104:107]
  ds_read_b64_tr_b16 a[218:219], v9 offset:34496
  v_mfma_f32_16x16x32_bf16 v[108:111], a[160:163], v[56:59], v[108:111]
  ds_read_b64_tr_b16 a[222:223], v9 offset:34504
  v_mfma_f32_16x16x32_bf16 v[112:115], a[160:163], v[60:63], v[112:115]
  ds_read_b64_tr_b16 a[212:213], v9 offset:33928
  v_mfma_f32_16x16x32_bf16 v[116:119], a[164:167], v[44:47], v[116:119]
  ds_read_b64_tr_b16 a[216:217], v9 offset:33984
  v_mfma_f32_16x16x32_bf16 v[120:123], a[164:167], v[48:51], v[120:123]
  ds_read_b64_tr_b16 a[220:221], v9 offset:33992
  v_mfma_f32_16x16x32_bf16 v[124:127], a[164:167], v[52:55], v[124:127]
  buffer_load_dwordx4 v2, s[8:11], s35 offen lds
  s_add_u32 m0, s30, 88064
  v_mfma_f32_16x16x32_bf16 v[128:131], a[164:167], v[56:59], v[128:131]
  s_mov_b32 s35, 512
  ds_read_b64_tr_b16 a[214:215], v9 offset:34440
  v_mfma_f32_16x16x32_bf16 v[132:135], a[164:167], v[60:63], v[132:135]
  ds_read_b64_tr_b16 a[210:211], v9 offset:34432
  v_mfma_f32_16x16x32_bf16 v[136:139], a[168:171], v[44:47], v[136:139]
  v_mfma_f32_16x16x32_bf16 v[140:143], a[168:171], v[48:51], v[140:143]
  v_mfma_f32_16x16x32_bf16 v[144:147], a[168:171], v[52:55], v[144:147]
  buffer_load_dwordx4 v3, s[4:7], s35 offen lds
  s_mov_b32 s35, 29184
  v_mfma_f32_16x16x32_bf16 v[148:151], a[168:171], v[56:59], v[148:151]
  s_add_u32 m0, s30, 92160
  v_mfma_f32_16x16x32_bf16 v[152:155], a[168:171], v[60:63], v[152:155]
  v_mfma_f32_16x16x32_bf16 v[156:159], a[172:175], v[44:47], v[156:159]
  v_mfma_f32_16x16x32_bf16 v[160:163], a[172:175], v[48:51], v[160:163]
  v_mfma_f32_16x16x32_bf16 v[164:167], a[172:175], v[52:55], v[164:167]
  buffer_load_dwordx4 v3, s[4:7], s35 offen lds
  s_mov_b32 s35, 57856
  v_mfma_f32_16x16x32_bf16 v[168:171], a[172:175], v[56:59], v[168:171]
  s_add_u32 m0, s30, 96256
  v_mfma_f32_16x16x32_bf16 v[172:175], a[172:175], v[60:63], v[172:175]
  v_mfma_f32_16x16x32_bf16 v[176:179], a[176:179], v[44:47], v[176:179]
  v_mfma_f32_16x16x32_bf16 v[180:183], a[176:179], v[48:51], v[180:183]
  buffer_load_dwordx4 v3, s[4:7], s35 offen lds
  s_mov_b32 s35, 86528
  v_mfma_f32_16x16x32_bf16 v[184:187], a[176:179], v[52:55], v[184:187]
  s_add_u32 m0, s30, 100352
  v_mfma_f32_16x16x32_bf16 v[188:191], a[176:179], v[56:59], v[188:191]
  v_mfma_f32_16x16x32_bf16 v[192:195], a[176:179], v[60:63], v[192:195]
  v_mfma_f32_16x16x32_bf16 v[196:199], a[180:183], v[44:47], v[196:199]
  v_mfma_f32_16x16x32_bf16 v[200:203], a[180:183], v[48:51], v[200:203]
  buffer_load_dwordx4 v3, s[4:7], s35 offen lds
  s_add_u32 m0, s30, 104448
  v_mfma_f32_16x16x32_bf16 v[204:207], a[180:183], v[52:55], v[204:207]
  s_mov_b32 s35, 115200
  v_mfma_f32_16x16x32_bf16 v[208:211], a[180:183], v[56:59], v[208:211]
  v_mfma_f32_16x16x32_bf16 v[212:215], a[180:183], v[60:63], v[212:215]
  v_mfma_f32_16x16x32_bf16 v[216:219], a[184:187], v[44:47], v[216:219]
  buffer_load_dwordx4 v3, s[4:7], s35 offen lds
  s_mov_b32 s35, 2359296
  v_mfma_f32_16x16x32_bf16 v[220:223], a[184:187], v[48:51], v[220:223]
  s_add_u32 m0, s29, 16896
  v_mfma_f32_16x16x32_bf16 v[224:227], a[184:187], v[52:55], v[224:227]
  v_mfma_f32_16x16x32_bf16 v[228:231], a[184:187], v[56:59], v[228:231]
  v_mfma_f32_16x16x32_bf16 v[232:235], a[184:187], v[60:63], v[232:235]
  v_mfma_f32_16x16x32_bf16 v[236:239], a[188:191], v[44:47], v[236:239]
  buffer_load_dwordx4 v2, s[8:11], s35 offen lds
  s_mov_b32 s35, 2367488
  v_mfma_f32_16x16x32_bf16 v[240:243], a[188:191], v[48:51], v[240:243]
  s_add_u32 m0, s29, 17952
  v_mfma_f32_16x16x32_bf16 v[244:247], a[188:191], v[52:55], v[244:247]
  s_waitcnt vmcnt(14) lgkmcnt(0)
  s_barrier
  v_mfma_f32_16x16x32_bf16 v[248:251], a[188:191], v[56:59], v[248:251]
  ds_read_b64_tr_b16 a[174:175], v10 offset:17480
  v_mfma_f32_16x16x32_bf16 v[252:255], a[188:191], v[60:63], v[252:255]
  ds_read_b64_tr_b16 a[168:169], v10 offset:16960
  v_mfma_f32_16x16x32_bf16 v[96:99], a[192:195], v[64:67], v[96:99]
  ds_read_b128 v[44:47], v11 offset:0
  v_mfma_f32_16x16x32_bf16 v[100:103], a[192:195], v[68:71], v[100:103]
  ds_read_b64_tr_b16 a[170:171], v10 offset:17472
  ds_read_b128 v[60:63], v11 offset:8192
  ds_read_b64_tr_b16 a[166:167], v10 offset:17416
  ds_read_b128 v[48:51], v11 offset:2048
  ds_read_b64_tr_b16 a[160:161], v10 offset:16896
  buffer_load_dwordx4 v2, s[8:11], s35 offen lds
  s_mov_b32 s35, 2375680
  ds_read_b128 v[56:59], v11 offset:6144
  s_add_u32 m0, s29, 19008
  ds_read_b128 v[52:55], v11 offset:4096
  ds_read_b64_tr_b16 a[164:165], v10 offset:16904
  buffer_load_dwordx4 v2, s[8:11], s35 offen lds
  s_add_u32 m0, s29, 20064
  ds_read_b64_tr_b16 a[162:163], v10 offset:17408
  s_mov_b32 s35, 2383872
  ds_read_b64_tr_b16 a[172:173], v10 offset:16968
  ds_read_b64_tr_b16 a[176:177], v10 offset:17024
  v_mfma_f32_16x16x32_bf16 v[104:107], a[192:195], v[72:75], v[104:107]
  ds_read_b64_tr_b16 a[190:191], v10 offset:17608
  v_mfma_f32_16x16x32_bf16 v[108:111], a[192:195], v[76:79], v[108:111]
  ds_read_b64_tr_b16 a[188:189], v10 offset:17096
  v_mfma_f32_16x16x32_bf16 v[112:115], a[192:195], v[80:83], v[112:115]
  ds_read_b64_tr_b16 a[182:183], v10 offset:17544
  v_mfma_f32_16x16x32_bf16 v[116:119], a[196:199], v[64:67], v[116:119]
  ds_read_b64_tr_b16 a[180:181], v10 offset:17032
  v_mfma_f32_16x16x32_bf16 v[120:123], a[196:199], v[68:71], v[120:123]
  ds_read_b64_tr_b16 a[186:187], v10 offset:17600
  v_mfma_f32_16x16x32_bf16 v[124:127], a[196:199], v[72:75], v[124:127]
  ds_read_b64_tr_b16 a[178:179], v10 offset:17536
  v_mfma_f32_16x16x32_bf16 v[128:131], a[196:199], v[76:79], v[128:131]
  ds_read_b64_tr_b16 a[184:185], v10 offset:17088
  v_mfma_f32_16x16x32_bf16 v[132:135], a[196:199], v[80:83], v[132:135]
  buffer_load_dwordx4 v2, s[8:11], s35 offen lds
  s_mov_b32 s35, 2621440
  v_mfma_f32_16x16x32_bf16 v[136:139], a[200:203], v[64:67], v[136:139]
  s_add_u32 m0, s29, 33792
  v_mfma_f32_16x16x32_bf16 v[140:143], a[200:203], v[68:71], v[140:143]
  v_mfma_f32_16x16x32_bf16 v[144:147], a[200:203], v[72:75], v[144:147]
  v_mfma_f32_16x16x32_bf16 v[148:151], a[200:203], v[76:79], v[148:151]
  buffer_load_dwordx4 v2, s[8:11], s35 offen lds
  s_add_u32 m0, s29, 34848
  v_mfma_f32_16x16x32_bf16 v[152:155], a[200:203], v[80:83], v[152:155]
  s_mov_b32 s35, 2629632
  v_mfma_f32_16x16x32_bf16 v[156:159], a[204:207], v[64:67], v[156:159]
  v_mfma_f32_16x16x32_bf16 v[160:163], a[204:207], v[68:71], v[160:163]
  v_mfma_f32_16x16x32_bf16 v[164:167], a[204:207], v[72:75], v[164:167]
  v_mfma_f32_16x16x32_bf16 v[168:171], a[204:207], v[76:79], v[168:171]
  buffer_load_dwordx4 v2, s[8:11], s35 offen lds
  s_mov_b32 s35, 2637824
  v_mfma_f32_16x16x32_bf16 v[172:175], a[204:207], v[80:83], v[172:175]
  s_add_u32 m0, s29, 35904
  v_mfma_f32_16x16x32_bf16 v[176:179], a[208:211], v[64:67], v[176:179]
  v_mfma_f32_16x16x32_bf16 v[180:183], a[208:211], v[68:71], v[180:183]
  v_mfma_f32_16x16x32_bf16 v[184:187], a[208:211], v[72:75], v[184:187]
  v_mfma_f32_16x16x32_bf16 v[188:191], a[208:211], v[76:79], v[188:191]
  buffer_load_dwordx4 v2, s[8:11], s35 offen lds
  s_add_u32 m0, s29, 36960
  v_mfma_f32_16x16x32_bf16 v[192:195], a[208:211], v[80:83], v[192:195]
  s_mov_b32 s35, 2646016
  v_mfma_f32_16x16x32_bf16 v[196:199], a[212:215], v[64:67], v[196:199]
  v_mfma_f32_16x16x32_bf16 v[200:203], a[212:215], v[68:71], v[200:203]
  v_mfma_f32_16x16x32_bf16 v[204:207], a[212:215], v[72:75], v[204:207]
  buffer_load_dwordx4 v2, s[8:11], s35 offen lds
  s_add_u32 m0, s30, 108544
  v_mfma_f32_16x16x32_bf16 v[208:211], a[212:215], v[76:79], v[208:211]
  s_mov_b32 s35, 640
  v_mfma_f32_16x16x32_bf16 v[212:215], a[212:215], v[80:83], v[212:215]
  v_mfma_f32_16x16x32_bf16 v[216:219], a[216:219], v[64:67], v[216:219]
  v_mfma_f32_16x16x32_bf16 v[220:223], a[216:219], v[68:71], v[220:223]
  v_mfma_f32_16x16x32_bf16 v[224:227], a[216:219], v[72:75], v[224:227]
  buffer_load_dwordx4 v3, s[4:7], s35 offen lds
  s_add_u32 m0, s30, 112640
  v_mfma_f32_16x16x32_bf16 v[228:231], a[216:219], v[76:79], v[228:231]
  s_mov_b32 s35, 29312
  v_mfma_f32_16x16x32_bf16 v[232:235], a[216:219], v[80:83], v[232:235]
  v_mfma_f32_16x16x32_bf16 v[236:239], a[220:223], v[64:67], v[236:239]
  v_mfma_f32_16x16x32_bf16 v[240:243], a[220:223], v[68:71], v[240:243]
  buffer_load_dwordx4 v3, s[4:7], s35 offen lds
  s_mov_b32 s35, 57984
  v_mfma_f32_16x16x32_bf16 v[244:247], a[220:223], v[72:75], v[244:247]
  s_waitcnt vmcnt(19) lgkmcnt(0)
  s_barrier
  s_add_u32 m0, s30, 116736
  v_mfma_f32_16x16x32_bf16 v[248:251], a[220:223], v[76:79], v[248:251]
  ds_read_b128 v[64:67], v12 offset:0
  v_mfma_f32_16x16x32_bf16 v[252:255], a[220:223], v[80:83], v[252:255]
  ds_read_b128 v[80:83], v12 offset:8192
  v_mfma_f32_16x16x32_bf16 v[96:99], a[160:163], v[44:47], v[96:99]
  ds_read_b128 v[76:79], v12 offset:6144
  v_mfma_f32_16x16x32_bf16 v[100:103], a[160:163], v[48:51], v[100:103]
  ds_read_b64_tr_b16 a[204:205], v9 offset:50760
  ds_read_b64_tr_b16 a[196:197], v9 offset:50696
  ds_read_b64_tr_b16 a[206:207], v9 offset:51272
  ds_read_b64_tr_b16 a[198:199], v9 offset:51208
  ds_read_b64_tr_b16 a[202:203], v9 offset:51264
  buffer_load_dwordx4 v3, s[4:7], s35 offen lds
  s_mov_b32 s35, 86656
  ds_read_b128 v[72:75], v12 offset:4096
  s_add_u32 m0, s30, 120832
  ds_read_b64_tr_b16 a[208:209], v9 offset:50816
  ds_read_b64_tr_b16 a[192:193], v9 offset:50688
  buffer_load_dwordx4 v3, s[4:7], s35 offen lds
  s_add_u32 m0, s30, 124928
  ds_read_b64_tr_b16 a[200:201], v9 offset:50752
  s_mov_b32 s35, 115328
  ds_read_b64_tr_b16 a[194:195], v9 offset:51200
  ds_read_b128 v[68:71], v12 offset:2048
  v_mfma_f32_16x16x32_bf16 v[104:107], a[160:163], v[52:55], v[104:107]
  ds_read_b64_tr_b16 a[210:211], v9 offset:51328
  v_mfma_f32_16x16x32_bf16 v[108:111], a[160:163], v[56:59], v[108:111]
  ds_read_b64_tr_b16 a[216:217], v9 offset:50880
  v_mfma_f32_16x16x32_bf16 v[112:115], a[160:163], v[60:63], v[112:115]
  ds_read_b64_tr_b16 a[222:223], v9 offset:51400
  v_mfma_f32_16x16x32_bf16 v[116:119], a[164:167], v[44:47], v[116:119]
  ds_read_b64_tr_b16 a[214:215], v9 offset:51336
  v_mfma_f32_16x16x32_bf16 v[120:123], a[164:167], v[48:51], v[120:123]
  ds_read_b64_tr_b16 a[218:219], v9 offset:51392
  v_mfma_f32_16x16x32_bf16 v[124:127], a[164:167], v[52:55], v[124:127]
  ds_read_b64_tr_b16 a[220:221], v9 offset:50888
  v_mfma_f32_16x16x32_bf16 v[128:131], a[164:167], v[56:59], v[128:131]
  ds_read_b64_tr_b16 a[212:213], v9 offset:50824
  v_mfma_f32_16x16x32_bf16 v[132:135], a[164:167], v[60:63], v[132:135]
  v_mfma_f32_16x16x32_bf16 v[136:139], a[168:171], v[44:47], v[136:139]
  buffer_load_dwordx4 v3, s[4:7], s35 offen lds
  s_mov_b32 s35, 2883584
  v_mfma_f32_16x16x32_bf16 v[140:143], a[168:171], v[48:51], v[140:143]
  s_add_u32 m0, s29, 146944
  v_mfma_f32_16x16x32_bf16 v[144:147], a[168:171], v[52:55], v[144:147]
  v_mfma_f32_16x16x32_bf16 v[148:151], a[168:171], v[56:59], v[148:151]
  v_mfma_f32_16x16x32_bf16 v[152:155], a[168:171], v[60:63], v[152:155]
  v_mfma_f32_16x16x32_bf16 v[156:159], a[172:175], v[44:47], v[156:159]
  buffer_load_dwordx4 v2, s[8:11], s35 offen lds
  s_add_u32 m0, s29, 148000
  v_mfma_f32_16x16x32_bf16 v[160:163], a[172:175], v[48:51], v[160:163]
  s_mov_b32 s35, 2891776
  v_mfma_f32_16x16x32_bf16 v[164:167], a[172:175], v[52:55], v[164:167]
  v_mfma_f32_16x16x32_bf16 v[168:171], a[172:175], v[56:59], v[168:171]
  v_mfma_f32_16x16x32_bf16 v[172:175], a[172:175], v[60:63], v[172:175]
  buffer_load_dwordx4 v2, s[8:11], s35 offen lds
  s_add_u32 m0, s29, 149056
  v_mfma_f32_16x16x32_bf16 v[176:179], a[176:179], v[44:47], v[176:179]
  s_mov_b32 s35, 2899968
  v_mfma_f32_16x16x32_bf16 v[180:183], a[176:179], v[48:51], v[180:183]
  v_mfma_f32_16x16x32_bf16 v[184:187], a[176:179], v[52:55], v[184:187]
  v_mfma_f32_16x16x32_bf16 v[188:191], a[176:179], v[56:59], v[188:191]
  v_mfma_f32_16x16x32_bf16 v[192:195], a[176:179], v[60:63], v[192:195]
  buffer_load_dwordx4 v2, s[8:11], s35 offen lds
  s_add_u32 m0, s29, 150112
  v_mfma_f32_16x16x32_bf16 v[196:199], a[180:183], v[44:47], v[196:199]
  s_mov_b32 s35, 2908160
  v_mfma_f32_16x16x32_bf16 v[200:203], a[180:183], v[48:51], v[200:203]
  v_mfma_f32_16x16x32_bf16 v[204:207], a[180:183], v[52:55], v[204:207]
  v_mfma_f32_16x16x32_bf16 v[208:211], a[180:183], v[56:59], v[208:211]
  v_mfma_f32_16x16x32_bf16 v[212:215], a[180:183], v[60:63], v[212:215]
  buffer_load_dwordx4 v2, s[8:11], s35 offen lds
  s_add_u32 m0, s29, 50688
  v_mfma_f32_16x16x32_bf16 v[216:219], a[184:187], v[44:47], v[216:219]
  s_mov_b32 s35, 3145728
  v_mfma_f32_16x16x32_bf16 v[220:223], a[184:187], v[48:51], v[220:223]
  v_mfma_f32_16x16x32_bf16 v[224:227], a[184:187], v[52:55], v[224:227]
  v_mfma_f32_16x16x32_bf16 v[228:231], a[184:187], v[56:59], v[228:231]
  v_mfma_f32_16x16x32_bf16 v[232:235], a[184:187], v[60:63], v[232:235]
  v_mfma_f32_16x16x32_bf16 v[236:239], a[188:191], v[44:47], v[236:239]
  v_mfma_f32_16x16x32_bf16 v[240:243], a[188:191], v[48:51], v[240:243]
  v_mfma_f32_16x16x32_bf16 v[244:247], a[188:191], v[52:55], v[244:247]
  s_waitcnt vmcnt(17) lgkmcnt(0)
  s_barrier
  v_mfma_f32_16x16x32_bf16 v[248:251], a[188:191], v[56:59], v[248:251]
  ds_read_b64_tr_b16 a[166:167], v10 offset:520
  v_mfma_f32_16x16x32_bf16 v[252:255], a[188:191], v[60:63], v[252:255]
  ds_read_b128 v[60:63], v11 offset:28672
  v_mfma_f32_16x16x32_bf16 v[96:99], a[192:195], v[64:67], v[96:99]
  ds_read_b128 v[52:55], v11 offset:24576
  v_mfma_f32_16x16x32_bf16 v[100:103], a[192:195], v[68:71], v[100:103]
  ds_read_b64_tr_b16 a[162:163], v10 offset:512
  ds_read_b128 v[48:51], v11 offset:22528
  ds_read_b64_tr_b16 a[160:161], v10 offset:0
  ds_read_b64_tr_b16 a[172:173], v10 offset:72
  ds_read_b64_tr_b16 a[170:171], v10 offset:576
  buffer_load_dwordx4 v2, s[8:11], s35 offen lds
  s_add_u32 m0, s29, 51744
  ds_read_b128 v[56:59], v11 offset:26624
  s_mov_b32 s35, 3153920
  ds_read_b64_tr_b16 a[176:177], v10 offset:128
  ds_read_b128 v[44:47], v11 offset:20480
  buffer_load_dwordx4 v2, s[8:11], s35 offen lds
  s_add_u32 m0, s29, 52800
  ds_read_b64_tr_b16 a[174:175], v10 offset:584
  s_mov_b32 s35, 3162112
  ds_read_b64_tr_b16 a[168:169], v10 offset:64
  ds_read_b64_tr_b16 a[164:165], v10 offset:8
  v_mfma_f32_16x16x32_bf16 v[104:107], a[192:195], v[72:75], v[104:107]
  ds_read_b64_tr_b16 a[182:183], v10 offset:648
  v_mfma_f32_16x16x32_bf16 v[108:111], a[192:195], v[76:79], v[108:111]
  ds_read_b64_tr_b16 a[184:185], v10 offset:192
  v_mfma_f32_16x16x32_bf16 v[112:115], a[192:195], v[80:83], v[112:115]
  ds_read_b64_tr_b16 a[178:179], v10 offset:640
  v_mfma_f32_16x16x32_bf16 v[116:119], a[196:199], v[64:67], v[116:119]
  ds_read_b64_tr_b16 a[180:181], v10 offset:136
  v_mfma_f32_16x16x32_bf16 v[120:123], a[196:199], v[68:71], v[120:123]
  ds_read_b64_tr_b16 a[190:191], v10 offset:712
  v_mfma_f32_16x16x32_bf16 v[124:127], a[196:199], v[72:75], v[124:127]
  buffer_load_dwordx4 v2, s[8:11], s35 offen lds
  s_mov_b32 s35, 3170304
  v_mfma_f32_16x16x32_bf16 v[128:131], a[196:199], v[76:79], v[128:131]
  s_add_u32 m0, s29, 53856
  ds_read_b64_tr_b16 a[186:187], v10 offset:704
  v_mfma_f32_16x16x32_bf16 v[132:135], a[196:199], v[80:83], v[132:135]
  ds_read_b64_tr_b16 a[188:189], v10 offset:200
  v_mfma_f32_16x16x32_bf16 v[136:139], a[200:203], v[64:67], v[136:139]
  v_mfma_f32_16x16x32_bf16 v[140:143], a[200:203], v[68:71], v[140:143]
  buffer_load_dwordx4 v2, s[8:11], s35 offen lds
  s_mov_b32 s35, 768
  v_mfma_f32_16x16x32_bf16 v[144:147], a[200:203], v[72:75], v[144:147]
  s_add_u32 m0, s30, 67584
  v_mfma_f32_16x16x32_bf16 v[148:151], a[200:203], v[76:79], v[148:151]
  v_mfma_f32_16x16x32_bf16 v[152:155], a[200:203], v[80:83], v[152:155]
  v_mfma_f32_16x16x32_bf16 v[156:159], a[204:207], v[64:67], v[156:159]
  v_mfma_f32_16x16x32_bf16 v[160:163], a[204:207], v[68:71], v[160:163]
  buffer_load_dwordx4 v3, s[4:7], s35 offen lds
  s_mov_b32 s35, 29440
  v_mfma_f32_16x16x32_bf16 v[164:167], a[204:207], v[72:75], v[164:167]
  s_add_u32 m0, s30, 71680
  v_mfma_f32_16x16x32_bf16 v[168:171], a[204:207], v[76:79], v[168:171]
  v_mfma_f32_16x16x32_bf16 v[172:175], a[204:207], v[80:83], v[172:175]
  v_mfma_f32_16x16x32_bf16 v[176:179], a[208:211], v[64:67], v[176:179]
  v_mfma_f32_16x16x32_bf16 v[180:183], a[208:211], v[68:71], v[180:183]
  buffer_load_dwordx4 v3, s[4:7], s35 offen lds
  s_mov_b32 s35, 58112
  v_mfma_f32_16x16x32_bf16 v[184:187], a[208:211], v[72:75], v[184:187]
  s_add_u32 m0, s30, 75776
  v_mfma_f32_16x16x32_bf16 v[188:191], a[208:211], v[76:79], v[188:191]
  v_mfma_f32_16x16x32_bf16 v[192:195], a[208:211], v[80:83], v[192:195]
  v_mfma_f32_16x16x32_bf16 v[196:199], a[212:215], v[64:67], v[196:199]
  buffer_load_dwordx4 v3, s[4:7], s35 offen lds
  s_mov_b32 s35, 86784
  v_mfma_f32_16x16x32_bf16 v[200:203], a[212:215], v[68:71], v[200:203]
  s_add_u32 m0, s30, 79872
  v_mfma_f32_16x16x32_bf16 v[204:207], a[212:215], v[72:75], v[204:207]
  v_mfma_f32_16x16x32_bf16 v[208:211], a[212:215], v[76:79], v[208:211]
  v_mfma_f32_16x16x32_bf16 v[212:215], a[212:215], v[80:83], v[212:215]
  v_mfma_f32_16x16x32_bf16 v[216:219], a[216:219], v[64:67], v[216:219]
  buffer_load_dwordx4 v3, s[4:7], s35 offen lds
  s_add_u32 m0, s30, 83968
  v_mfma_f32_16x16x32_bf16 v[220:223], a[216:219], v[68:71], v[220:223]
  s_mov_b32 s35, 115456
  v_mfma_f32_16x16x32_bf16 v[224:227], a[216:219], v[72:75], v[224:227]
  v_mfma_f32_16x16x32_bf16 v[228:231], a[216:219], v[76:79], v[228:231]
  v_mfma_f32_16x16x32_bf16 v[232:235], a[216:219], v[80:83], v[232:235]
  buffer_load_dwordx4 v3, s[4:7], s35 offen lds
  s_add_u32 m0, s29, 130048
  v_mfma_f32_16x16x32_bf16 v[236:239], a[220:223], v[64:67], v[236:239]
  s_mov_b32 s35, 3407872
  s_mov_b32 s7, 0x20000
  s_mov_b32 s4, s58
  v_mfma_f32_16x16x32_bf16 v[240:243], a[220:223], v[68:71], v[240:243]
  s_mov_b32 s5, s59
  s_mov_b32 s6, 256
  v_mfma_f32_16x16x32_bf16 v[244:247], a[220:223], v[72:75], v[244:247]
  s_waitcnt vmcnt(22) lgkmcnt(0)
  s_barrier
  v_mfma_f32_16x16x32_bf16 v[248:251], a[220:223], v[76:79], v[248:251]
  ds_read_b64_tr_b16 a[206:207], v9 offset:17480
  v_mfma_f32_16x16x32_bf16 v[252:255], a[220:223], v[80:83], v[252:255]
  ds_read_b64_tr_b16 a[202:203], v9 offset:17472
  v_mfma_f32_16x16x32_bf16 v[96:99], a[160:163], v[44:47], v[96:99]
  ds_read_b64_tr_b16 a[196:197], v9 offset:16904
  v_mfma_f32_16x16x32_bf16 v[100:103], a[160:163], v[48:51], v[100:103]
  ds_read_b128 v[64:67], v12 offset:20480
  ds_read_b64_tr_b16 a[194:195], v9 offset:17408
  ds_read_b128 v[76:79], v12 offset:26624
  ds_read_b128 v[72:75], v12 offset:24576
  ds_read_b64_tr_b16 a[204:205], v9 offset:16968
  buffer_load_dwordx4 v2, s[8:11], s35 offen lds
  s_mov_b32 s35, 3416064
  ds_read_b128 v[80:83], v12 offset:28672
  s_add_u32 m0, s29, 131104
  ds_read_b64_tr_b16 a[200:201], v9 offset:16960
  ds_read_b64_tr_b16 a[198:199], v9 offset:17416
  buffer_load_dwordx4 v2, s[8:11], s35 offen lds
  s_add_u32 m0, s29, 132160
  ds_read_b64_tr_b16 a[208:209], v9 offset:17024
  s_mov_b32 s35, 3424256
  ds_read_b128 v[68:71], v12 offset:22528
  ds_read_b64_tr_b16 a[192:193], v9 offset:16896
  v_mfma_f32_16x16x32_bf16 v[104:107], a[160:163], v[52:55], v[104:107]
  ds_read_b64_tr_b16 a[214:215], v9 offset:17544
  v_mfma_f32_16x16x32_bf16 v[108:111], a[160:163], v[56:59], v[108:111]
  ds_read_b64_tr_b16 a[218:219], v9 offset:17600
  v_mfma_f32_16x16x32_bf16 v[112:115], a[160:163], v[60:63], v[112:115]
  ds_read_b64_tr_b16 a[210:211], v9 offset:17536
  v_mfma_f32_16x16x32_bf16 v[116:119], a[164:167], v[44:47], v[116:119]
  ds_read_b64_tr_b16 a[220:221], v9 offset:17096
  v_mfma_f32_16x16x32_bf16 v[120:123], a[164:167], v[48:51], v[120:123]
  ds_read_b64_tr_b16 a[212:213], v9 offset:17032
  v_mfma_f32_16x16x32_bf16 v[124:127], a[164:167], v[52:55], v[124:127]
  ds_read_b64_tr_b16 a[222:223], v9 offset:17608
  v_mfma_f32_16x16x32_bf16 v[128:131], a[164:167], v[56:59], v[128:131]
  buffer_load_dwordx4 v2, s[8:11], s35 offen lds
  s_mov_b32 s35, 3432448
  v_mfma_f32_16x16x32_bf16 v[132:135], a[164:167], v[60:63], v[132:135]
  s_add_u32 m0, s29, 133216
  ds_read_b64_tr_b16 a[216:217], v9 offset:17088
  v_mfma_f32_16x16x32_bf16 v[136:139], a[168:171], v[44:47], v[136:139]
  v_mfma_f32_16x16x32_bf16 v[140:143], a[168:171], v[48:51], v[140:143]
  v_mfma_f32_16x16x32_bf16 v[144:147], a[168:171], v[52:55], v[144:147]
  v_mfma_f32_16x16x32_bf16 v[148:151], a[168:171], v[56:59], v[148:151]
  buffer_load_dwordx4 v2, s[8:11], s35 offen lds
  s_add_u32 m0, s29, 0
  v_mfma_f32_16x16x32_bf16 v[152:155], a[168:171], v[60:63], v[152:155]
  s_min_u32 s35, s60, 1
  s_lshl_b32 s35, s35, 30
  s_add_u32 s35, s35, 2293760
  v_mfma_f32_16x16x32_bf16 v[156:159], a[172:175], v[44:47], v[156:159]
  s_mov_b32 s11, 0x20000
  s_mov_b32 s8, s56
  s_mov_b32 s9, s57
  v_mfma_f32_16x16x32_bf16 v[160:163], a[172:175], v[48:51], v[160:163]
  s_mov_b32 s10, 2293760
  v_mfma_f32_16x16x32_bf16 v[164:167], a[172:175], v[52:55], v[164:167]
  buffer_load_dwordx4 v1, s[12:15], s33 offen nt lds
  s_add_u32 m0, s29, 32
  v_mfma_f32_16x16x32_bf16 v[168:171], a[172:175], v[56:59], v[168:171]
  v_mfma_f32_16x16x32_bf16 v[172:175], a[172:175], v[60:63], v[172:175]
  v_mfma_f32_16x16x32_bf16 v[176:179], a[176:179], v[44:47], v[176:179]
  v_mfma_f32_16x16x32_bf16 v[180:183], a[176:179], v[48:51], v[180:183]
  v_mfma_f32_16x16x32_bf16 v[184:187], a[176:179], v[52:55], v[184:187]
  buffer_load_dwordx4 v1, s[12:15], s33 offen offset:1024 nt lds
  s_add_u32 m0, s29, 64
  v_mfma_f32_16x16x32_bf16 v[188:191], a[176:179], v[56:59], v[188:191]
  v_mfma_f32_16x16x32_bf16 v[192:195], a[176:179], v[60:63], v[192:195]
  v_mfma_f32_16x16x32_bf16 v[196:199], a[180:183], v[44:47], v[196:199]
  v_mfma_f32_16x16x32_bf16 v[200:203], a[180:183], v[48:51], v[200:203]
  v_mfma_f32_16x16x32_bf16 v[204:207], a[180:183], v[52:55], v[204:207]
  buffer_load_dwordx4 v1, s[12:15], s33 offen offset:2048 nt lds
  s_add_u32 m0, s29, 96
  v_mfma_f32_16x16x32_bf16 v[208:211], a[180:183], v[56:59], v[208:211]
  v_mfma_f32_16x16x32_bf16 v[212:215], a[180:183], v[60:63], v[212:215]
  v_mfma_f32_16x16x32_bf16 v[216:219], a[184:187], v[44:47], v[216:219]
  v_mfma_f32_16x16x32_bf16 v[220:223], a[184:187], v[48:51], v[220:223]
  buffer_load_dwordx4 v1, s[12:15], s33 offen offset:3072 nt lds
  s_mov_b32 s33, 16384
  v_mfma_f32_16x16x32_bf16 v[224:227], a[184:187], v[52:55], v[224:227]
  s_add_u32 m0, s29, 16896
  v_mfma_f32_16x16x32_bf16 v[228:231], a[184:187], v[56:59], v[228:231]
  v_mfma_f32_16x16x32_bf16 v[232:235], a[184:187], v[60:63], v[232:235]
  v_mfma_f32_16x16x32_bf16 v[236:239], a[188:191], v[44:47], v[236:239]
  v_mfma_f32_16x16x32_bf16 v[240:243], a[188:191], v[48:51], v[240:243]
  v_mfma_f32_16x16x32_bf16 v[244:247], a[188:191], v[52:55], v[244:247]
  s_waitcnt vmcnt(21) lgkmcnt(0)
  s_barrier
  v_mfma_f32_16x16x32_bf16 v[248:251], a[188:191], v[56:59], v[248:251]
  ds_read_b128 v[56:59], v11 offset:47104
  v_mfma_f32_16x16x32_bf16 v[252:255], a[188:191], v[60:63], v[252:255]
  ds_read_b128 v[60:63], v11 offset:49152
  v_mfma_f32_16x16x32_bf16 v[96:99], a[192:195], v[64:67], v[96:99]
  ds_read_b64_tr_b16 a[170:171], v9 offset:34368
  v_mfma_f32_16x16x32_bf16 v[100:103], a[192:195], v[68:71], v[100:103]
  ds_read_b64_tr_b16 a[160:161], v9 offset:33792
  ds_read_b64_tr_b16 a[162:163], v9 offset:34304
  ds_read_b128 v[48:51], v11 offset:43008
  ds_read_b64_tr_b16 a[174:175], v9 offset:34376
  ds_read_b128 v[44:47], v11 offset:40960
  buffer_load_dwordx4 v1, s[12:15], s33 offen nt lds
  s_add_u32 m0, s29, 16928
  ds_read_b64_tr_b16 a[172:173], v9 offset:33864
  ds_read_b64_tr_b16 a[166:167], v9 offset:34312
  ds_read_b128 v[52:55], v11 offset:45056
  buffer_store_dwordx4 v[84:87], v89, s[24:27], s35 offen sc1
  ds_read_b64_tr_b16 a[164:165], v9 offset:33800
  s_add_u32 s35, s35, 4096
  buffer_load_dwordx4 v1, s[12:15], s33 offen offset:1024 nt lds
  ds_read_b64_tr_b16 a[176:177], v9 offset:33920
  s_add_u32 m0, s29, 16960
  ds_read_b64_tr_b16 a[168:169], v9 offset:33856
  v_mfma_f32_16x16x32_bf16 v[104:107], a[192:195], v[72:75], v[104:107]
  ds_read_b64_tr_b16 a[186:187], v9 offset:34496
  v_mfma_f32_16x16x32_bf16 v[108:111], a[192:195], v[76:79], v[108:111]
  buffer_store_dwordx4 v[84:87], v89, s[24:27], s35 offen sc1
  v_mfma_f32_16x16x32_bf16 v[112:115], a[192:195], v[80:83], v[112:115]
  s_min_u32 s35, s60, 1
  ds_read_b64_tr_b16 a[184:185], v9 offset:33984
  s_lshl_b32 s35, s35, 30
  v_mfma_f32_16x16x32_bf16 v[116:119], a[196:199], v[64:67], v[116:119]
  s_lshl2_add_u32 s35, s61, s35
  ds_read_b64_tr_b16 a[178:179], v9 offset:34432
  v_mfma_f32_16x16x32_bf16 v[120:123], a[196:199], v[68:71], v[120:123]
  ds_read_b64_tr_b16 a[188:189], v9 offset:33992
  v_mfma_f32_16x16x32_bf16 v[124:127], a[196:199], v[72:75], v[124:127]
  ds_read_b64_tr_b16 a[180:181], v9 offset:33928
  v_mfma_f32_16x16x32_bf16 v[128:131], a[196:199], v[76:79], v[128:131]
  ds_read_b64_tr_b16 a[182:183], v9 offset:34440
  v_mfma_f32_16x16x32_bf16 v[132:135], a[196:199], v[80:83], v[132:135]
  ds_read_b64_tr_b16 a[190:191], v9 offset:34504
  v_mfma_f32_16x16x32_bf16 v[136:139], a[200:203], v[64:67], v[136:139]
  v_mfma_f32_16x16x32_bf16 v[140:143], a[200:203], v[68:71], v[140:143]
  v_mfma_f32_16x16x32_bf16 v[144:147], a[200:203], v[72:75], v[144:147]
  v_mfma_f32_16x16x32_bf16 v[148:151], a[200:203], v[76:79], v[148:151]
  v_mfma_f32_16x16x32_bf16 v[152:155], a[200:203], v[80:83], v[152:155]
  v_mfma_f32_16x16x32_bf16 v[156:159], a[204:207], v[64:67], v[156:159]
  v_mfma_f32_16x16x32_bf16 v[160:163], a[204:207], v[68:71], v[160:163]
  buffer_load_dwordx4 v1, s[12:15], s33 offen offset:2048 nt lds
  s_add_u32 m0, s29, 16992
  v_mfma_f32_16x16x32_bf16 v[164:167], a[204:207], v[72:75], v[164:167]
  v_mfma_f32_16x16x32_bf16 v[168:171], a[204:207], v[76:79], v[168:171]
  v_mfma_f32_16x16x32_bf16 v[172:175], a[204:207], v[80:83], v[172:175]
  v_mfma_f32_16x16x32_bf16 v[176:179], a[208:211], v[64:67], v[176:179]
  v_mfma_f32_16x16x32_bf16 v[180:183], a[208:211], v[68:71], v[180:183]
  v_mfma_f32_16x16x32_bf16 v[184:187], a[208:211], v[72:75], v[184:187]
  v_mfma_f32_16x16x32_bf16 v[188:191], a[208:211], v[76:79], v[188:191]
  v_mfma_f32_16x16x32_bf16 v[192:195], a[208:211], v[80:83], v[192:195]
  v_mfma_f32_16x16x32_bf16 v[196:199], a[212:215], v[64:67], v[196:199]
  buffer_load_dwordx4 v1, s[12:15], s33 offen offset:3072 nt lds
  s_add_u32 m0, s29, 33792
  v_mfma_f32_16x16x32_bf16 v[200:203], a[212:215], v[68:71], v[200:203]
  s_mov_b32 s33, 32768
  v_mfma_f32_16x16x32_bf16 v[204:207], a[212:215], v[72:75], v[204:207]
  v_mfma_f32_16x16x32_bf16 v[208:211], a[212:215], v[76:79], v[208:211]
  v_mfma_f32_16x16x32_bf16 v[212:215], a[212:215], v[80:83], v[212:215]
  v_mfma_f32_16x16x32_bf16 v[216:219], a[216:219], v[64:67], v[216:219]
  v_mfma_f32_16x16x32_bf16 v[220:223], a[216:219], v[68:71], v[220:223]
  v_mfma_f32_16x16x32_bf16 v[224:227], a[216:219], v[72:75], v[224:227]
  v_mfma_f32_16x16x32_bf16 v[228:231], a[216:219], v[76:79], v[228:231]
  v_mfma_f32_16x16x32_bf16 v[232:235], a[216:219], v[80:83], v[232:235]
  v_mfma_f32_16x16x32_bf16 v[236:239], a[220:223], v[64:67], v[236:239]
  v_mfma_f32_16x16x32_bf16 v[240:243], a[220:223], v[68:71], v[240:243]
  s_waitcnt vmcnt(14) lgkmcnt(0)
  s_barrier
  v_mfma_f32_16x16x32_bf16 v[244:247], a[220:223], v[72:75], v[244:247]
  ds_read_b64_tr_b16 a[194:195], v10 offset:17408
  v_mfma_f32_16x16x32_bf16 v[248:251], a[220:223], v[76:79], v[248:251]
  buffer_load_dwordx4 v1, s[12:15], s33 offen nt lds
  s_add_u32 m0, s29, 33824
  v_mfma_f32_16x16x32_bf16 v[252:255], a[220:223], v[80:83], v[252:255]
  ds_read_b64_tr_b16 a[192:193], v10 offset:16896
  v_mfma_f32_16x16x32_bf16 v[96:99], a[160:163], v[44:47], v[96:99]
  ds_read_b64_tr_b16 a[196:197], v10 offset:16904
  v_mfma_f32_16x16x32_bf16 v[100:103], a[160:163], v[48:51], v[100:103]
  ds_read_b128 v[64:67], v12 offset:40960
  v_mfma_f32_16x16x32_bf16 v[104:107], a[160:163], v[52:55], v[104:107]
  ds_read_b64_tr_b16 a[198:199], v10 offset:17416
  v_mfma_f32_16x16x32_bf16 v[108:111], a[160:163], v[56:59], v[108:111]
  ds_read_b64_tr_b16 a[200:201], v10 offset:16960
  v_mfma_f32_16x16x32_bf16 v[112:115], a[160:163], v[60:63], v[112:115]
  ds_read_b64_tr_b16 a[206:207], v10 offset:17480
  v_mfma_f32_16x16x32_bf16 v[116:119], a[164:167], v[44:47], v[116:119]
  ds_read_b64_tr_b16 a[202:203], v10 offset:17472
  v_mfma_f32_16x16x32_bf16 v[120:123], a[164:167], v[48:51], v[120:123]
  ds_read_b64_tr_b16 a[204:205], v10 offset:16968
  v_mfma_f32_16x16x32_bf16 v[124:127], a[164:167], v[52:55], v[124:127]
  buffer_load_dwordx4 v1, s[12:15], s33 offen offset:1024 nt lds
  s_add_u32 m0, s29, 33856
  v_mfma_f32_16x16x32_bf16 v[128:131], a[164:167], v[56:59], v[128:131]
  ds_read_b64_tr_b16 a[210:211], v10 offset:17536
  v_mfma_f32_16x16x32_bf16 v[132:135], a[164:167], v[60:63], v[132:135]
  ds_read_b64_tr_b16 a[208:209], v10 offset:17024
  v_mfma_f32_16x16x32_bf16 v[136:139], a[168:171], v[44:47], v[136:139]
  ds_read_b64_tr_b16 a[212:213], v10 offset:17032
  v_mfma_f32_16x16x32_bf16 v[140:143], a[168:171], v[48:51], v[140:143]
  ds_read_b64_tr_b16 a[216:217], v10 offset:17088
  v_mfma_f32_16x16x32_bf16 v[144:147], a[168:171], v[52:55], v[144:147]
  ds_read_b64_tr_b16 a[214:215], v10 offset:17544
  v_mfma_f32_16x16x32_bf16 v[148:151], a[168:171], v[56:59], v[148:151]
  ds_read_b64_tr_b16 a[218:219], v10 offset:17600
  v_mfma_f32_16x16x32_bf16 v[152:155], a[168:171], v[60:63], v[152:155]
  ds_read_b64_tr_b16 a[220:221], v10 offset:17096
  v_mfma_f32_16x16x32_bf16 v[156:159], a[172:175], v[44:47], v[156:159]
  ds_read_b64_tr_b16 a[16:17], v9 offset:50688
  v_mfma_f32_16x16x32_bf16 v[160:163], a[172:175], v[48:51], v[160:163]
  buffer_load_dwordx4 v1, s[12:15], s33 offen offset:2048 nt lds
  s_add_u32 m0, s29, 33888
  v_mfma_f32_16x16x32_bf16 v[164:167], a[172:175], v[52:55], v[164:167]
  ds_read_b64_tr_b16 a[222:223], v10 offset:17608
  v_mfma_f32_16x16x32_bf16 v[168:171], a[172:175], v[56:59], v[168:171]
  ds_read_b128 v[24:27], v11 offset:0
  v_mfma_f32_16x16x32_bf16 v[172:175], a[172:175], v[60:63], v[172:175]
  ds_read_b128 v[72:75], v12 offset:45056
  v_mfma_f32_16x16x32_bf16 v[176:179], a[176:179], v[44:47], v[176:179]
  ds_read_b64_tr_b16 a[18:19], v9 offset:51200
  v_mfma_f32_16x16x32_bf16 v[180:183], a[176:179], v[48:51], v[180:183]
  ds_read_b64_tr_b16 a[38:39], v9 offset:51208
  v_mfma_f32_16x16x32_bf16 v[184:187], a[176:179], v[52:55], v[184:187]
  ds_read_b128 v[68:71], v12 offset:43008
  v_mfma_f32_16x16x32_bf16 v[188:191], a[176:179], v[56:59], v[188:191]
  ds_read_b128 v[76:79], v12 offset:47104
  v_mfma_f32_16x16x32_bf16 v[192:195], a[176:179], v[60:63], v[192:195]
  ds_read_b64_tr_b16 a[36:37], v9 offset:50696
  v_mfma_f32_16x16x32_bf16 v[196:199], a[180:183], v[44:47], v[196:199]
  buffer_load_dwordx4 v1, s[12:15], s33 offen offset:3072 nt lds
  s_add_u32 m0, s29, 146944
  v_mfma_f32_16x16x32_bf16 v[200:203], a[180:183], v[48:51], v[200:203]
  s_mov_b32 s33, 65536
  ds_read_b128 v[80:83], v12 offset:49152
  v_mfma_f32_16x16x32_bf16 v[204:207], a[180:183], v[52:55], v[204:207]
  ds_read_b64_tr_b16 a[58:59], v9 offset:51264
  v_mfma_f32_16x16x32_bf16 v[208:211], a[180:183], v[56:59], v[208:211]
  ds_read_b64_tr_b16 a[56:57], v9 offset:50752
  v_mfma_f32_16x16x32_bf16 v[212:215], a[180:183], v[60:63], v[212:215]
  ds_read_b64_tr_b16 a[76:77], v9 offset:50760
  v_mfma_f32_16x16x32_bf16 v[216:219], a[184:187], v[44:47], v[216:219]
  ds_read_b64_tr_b16 a[96:97], v9 offset:50816
  v_mfma_f32_16x16x32_bf16 v[220:223], a[184:187], v[48:51], v[220:223]
  ds_read_b64_tr_b16 a[78:79], v9 offset:51272
  v_mfma_f32_16x16x32_bf16 v[224:227], a[184:187], v[52:55], v[224:227]
  ds_read_b64_tr_b16 a[98:99], v9 offset:51328
  v_mfma_f32_16x16x32_bf16 v[228:231], a[184:187], v[56:59], v[228:231]
  ds_read_b64_tr_b16 a[118:119], v9 offset:51336
  v_mfma_f32_16x16x32_bf16 v[232:235], a[184:187], v[60:63], v[232:235]
  ds_read_b64_tr_b16 a[116:117], v9 offset:50824
  v_mfma_f32_16x16x32_bf16 v[236:239], a[188:191], v[44:47], v[236:239]
  ds_read_b64_tr_b16 a[136:137], v9 offset:50880
  v_mfma_f32_16x16x32_bf16 v[240:243], a[188:191], v[48:51], v[240:243]
  s_waitcnt vmcnt(14) lgkmcnt(9)
  ds_read_b64_tr_b16 a[138:139], v9 offset:51392
  s_barrier
  v_mfma_f32_16x16x32_bf16 v[244:247], a[188:191], v[52:55], v[244:247]
  ds_read_b64_tr_b16 a[156:157], v9 offset:50888
  v_mfma_f32_16x16x32_bf16 v[248:251], a[188:191], v[56:59], v[248:251]
  ds_read_b64_tr_b16 a[158:159], v9 offset:51400
  v_lshlrev_b32 v9, 8, v0
  v_mfma_f32_16x16x32_bf16 v[252:255], a[188:191], v[60:63], v[252:255]
  ds_read_b64_tr_b16 a[160:161], v10 offset:0
  v_mfma_f32_16x16x32_bf16 v[96:99], a[192:195], v[64:67], v[96:99]
  ds_read_b64_tr_b16 a[162:163], v10 offset:512
  v_mfma_f32_16x16x32_bf16 v[116:119], a[196:199], v[64:67], v[116:119]
  ds_read_b128 v[44:47], v12 offset:0
  v_mfma_f32_16x16x32_bf16 v[136:139], a[200:203], v[64:67], v[136:139]
  ds_read_b64_tr_b16 a[164:165], v10 offset:8
  v_mfma_f32_16x16x32_bf16 v[156:159], a[204:207], v[64:67], v[156:159]
  ds_read_b64_tr_b16 a[166:167], v10 offset:520
  v_mfma_f32_16x16x32_bf16 v[176:179], a[208:211], v[64:67], v[176:179]
  ds_read_b64_tr_b16 a[168:169], v10 offset:64
  v_mfma_f32_16x16x32_bf16 v[196:199], a[212:215], v[64:67], v[196:199]
  ds_read_b64_tr_b16 a[178:179], v10 offset:640
  v_mfma_f32_16x16x32_bf16 v[216:219], a[216:219], v[64:67], v[216:219]
  ds_read_b64_tr_b16 a[180:181], v10 offset:136
  v_mfma_f32_16x16x32_bf16 v[236:239], a[220:223], v[64:67], v[236:239]
  ds_read_b64_tr_b16 a[182:183], v10 offset:648
  v_mfma_f32_16x16x32_bf16 v[96:99], a[16:19], v[24:27], v[96:99]
  ds_read_b64_tr_b16 a[170:171], v10 offset:576
  v_mfma_f32_16x16x32_bf16 v[116:119], a[36:39], v[24:27], v[116:119]
  s_waitcnt lgkmcnt(7)
  ds_read_b64_tr_b16 a[186:187], v10 offset:704
  v_mfma_f32_16x16x32_bf16 v[136:139], a[56:59], v[24:27], v[136:139]
  ds_read_b64_tr_b16 a[176:177], v10 offset:128
  v_mfma_f32_16x16x32_bf16 v[156:159], a[76:79], v[24:27], v[156:159]
  ds_read_b64_tr_b16 a[172:173], v10 offset:72
  v_mfma_f32_16x16x32_bf16 v[176:179], a[96:99], v[24:27], v[176:179]
  ds_read_b64_tr_b16 a[174:175], v10 offset:584
  v_mfma_f32_16x16x32_bf16 v[196:199], a[116:119], v[24:27], v[196:199]
  ds_read_b64_tr_b16 a[184:185], v10 offset:192
  v_mfma_f32_16x16x32_bf16 v[216:219], a[136:139], v[24:27], v[216:219]
  ds_read_b64_tr_b16 a[188:189], v10 offset:200
  v_mfma_f32_16x16x32_bf16 v[236:239], a[156:159], v[24:27], v[236:239]
  ds_read_b64_tr_b16 a[190:191], v10 offset:712
  v_mov_b32 v10, 1
  v_mfma_f32_16x16x32_bf16 v[96:99], a[160:163], v[44:47], v[96:99]
  s_waitcnt lgkmcnt(7)
  ds_read_b128 v[48:51], v12 offset:2048
  v_mfma_f32_16x16x32_bf16 v[116:119], a[164:167], v[44:47], v[116:119]
  ds_read_b128 v[32:35], v11 offset:4096
  v_mfma_f32_16x16x32_bf16 v[136:139], a[168:171], v[44:47], v[136:139]
  s_waitcnt lgkmcnt(5)
  ds_read_b128 v[28:31], v11 offset:2048
  v_mfma_f32_16x16x32_bf16 v[156:159], a[172:175], v[44:47], v[156:159]
  ds_read_b128 v[60:63], v12 offset:8192
  v_mfma_f32_16x16x32_bf16 v[176:179], a[176:179], v[44:47], v[176:179]
  ds_read_b128 v[56:59], v12 offset:6144
  v_cvt_pk_bf16_f32 v96, v96, v97
  v_mfma_f32_16x16x32_bf16 v[196:199], a[180:183], v[44:47], v[196:199]
  s_waitcnt lgkmcnt(7)
  ds_read_b128 v[52:55], v12 offset:4096
  v_cvt_pk_bf16_f32 v97, v98, v99
  v_mfma_f32_16x16x32_bf16 v[216:219], a[184:187], v[44:47], v[216:219]
  s_waitcnt lgkmcnt(6)
  ds_read_b128 v[36:39], v11 offset:6144
  v_cvt_pk_bf16_f32 v98, v116, v117
  v_mfma_f32_16x16x32_bf16 v[236:239], a[188:191], v[44:47], v[236:239]
  ds_read_b128 v[40:43], v11 offset:8192
  v_cvt_pk_bf16_f32 v99, v118, v119
  v_mfma_f32_16x16x32_bf16 v[100:103], a[192:195], v[68:71], v[100:103]
  s_waitcnt lgkmcnt(5)
  buffer_load_dwordx4 v1, s[16:19], s34 offen nt lds
  s_add_u32 m0, s29, 146976
  v_mfma_f32_16x16x32_bf16 v[100:103], a[16:19], v[28:31], v[100:103]
  v_cvt_pk_bf16_f32 v136, v136, v137
  v_cvt_pk_bf16_f32 v137, v138, v139
  v_mfma_f32_16x16x32_bf16 v[100:103], a[160:163], v[48:51], v[100:103]
  v_cvt_pk_bf16_f32 v139, v158, v159
  v_cvt_pk_bf16_f32 v138, v156, v157
  v_mfma_f32_16x16x32_bf16 v[120:123], a[196:199], v[68:71], v[120:123]
  buffer_load_dwordx4 v1, s[16:19], s34 offen offset:1024 nt lds
  v_cvt_pk_bf16_f32 v176, v176, v177
  v_mfma_f32_16x16x32_bf16 v[120:123], a[36:39], v[28:31], v[120:123]
  s_add_u32 m0, s29, 147008
  v_cvt_pk_bf16_f32 v177, v178, v179
  v_cvt_pk_bf16_f32 v178, v196, v197
  v_mfma_f32_16x16x32_bf16 v[120:123], a[164:167], v[48:51], v[120:123]
  v_cvt_pk_bf16_f32 v179, v198, v199
  s_waitcnt vmcnt(12) lgkmcnt(0)
  v_mfma_f32_16x16x32_bf16 v[140:143], a[200:203], v[68:71], v[140:143]
  s_barrier
  ds_write_b128 v13, v[96:99] offset:0
  v_mfma_f32_16x16x32_bf16 v[140:143], a[56:59], v[28:31], v[140:143]
  v_cvt_pk_bf16_f32 v100, v100, v101
  v_cvt_pk_bf16_f32 v101, v102, v103
  v_mfma_f32_16x16x32_bf16 v[140:143], a[168:171], v[48:51], v[140:143]
  ds_write_b128 v13, v[136:139] offset:1024
  v_mfma_f32_16x16x32_bf16 v[160:163], a[204:207], v[68:71], v[160:163]
  v_cvt_pk_bf16_f32 v103, v122, v123
  v_cvt_pk_bf16_f32 v102, v120, v121
  v_mfma_f32_16x16x32_bf16 v[160:163], a[76:79], v[28:31], v[160:163]
  v_cvt_pk_bf16_f32 v216, v216, v217
  v_cvt_pk_bf16_f32 v217, v218, v219
  v_mfma_f32_16x16x32_bf16 v[160:163], a[172:175], v[48:51], v[160:163]
  ds_write_b128 v13, v[176:179] offset:2048
  v_mfma_f32_16x16x32_bf16 v[180:183], a[208:211], v[68:71], v[180:183]
  buffer_load_dwordx4 v1, s[16:19], s34 offen offset:2048 nt lds
  v_cvt_pk_bf16_f32 v219, v238, v239
  v_mfma_f32_16x16x32_bf16 v[180:183], a[96:99], v[28:31], v[180:183]
  s_add_u32 m0, s29, 147040
  v_cvt_pk_bf16_f32 v218, v236, v237
  v_cvt_pk_bf16_f32 v140, v140, v141
  v_mfma_f32_16x16x32_bf16 v[180:183], a[176:179], v[48:51], v[180:183]
  ds_write_b128 v13, v[216:219] offset:3072
  v_mfma_f32_16x16x32_bf16 v[200:203], a[212:215], v[68:71], v[200:203]
  v_cvt_pk_bf16_f32 v141, v142, v143
  v_cvt_pk_bf16_f32 v142, v160, v161
  v_mfma_f32_16x16x32_bf16 v[200:203], a[116:119], v[28:31], v[200:203]
  v_cvt_pk_bf16_f32 v143, v162, v163
  v_lshrrev_b32 v12, 5, v0
  v_mfma_f32_16x16x32_bf16 v[200:203], a[180:183], v[48:51], v[200:203]
  ds_write_b128 v13, v[100:103] offset:45568
  v_mfma_f32_16x16x32_bf16 v[220:223], a[216:219], v[68:71], v[220:223]
  v_cvt_pk_bf16_f32 v180, v180, v181
  v_cvt_pk_bf16_f32 v181, v182, v183
  v_mfma_f32_16x16x32_bf16 v[220:223], a[136:139], v[28:31], v[220:223]
  v_lshl_add_u32 v12, v12, 7, s54
  v_min_u32 v12, L_code_end-L_code_ref-4, v12
  v_mfma_f32_16x16x32_bf16 v[220:223], a[184:187], v[48:51], v[220:223]
  ds_write_b128 v13, v[140:143] offset:46592
  v_mfma_f32_16x16x32_bf16 v[240:243], a[220:223], v[68:71], v[240:243]
  s_waitcnt lgkmcnt(2)
  buffer_load_dwordx4 v1, s[16:19], s34 offen offset:3072 nt lds
  v_cvt_pk_bf16_f32 v183, v202, v203
  v_mfma_f32_16x16x32_bf16 v[240:243], a[156:159], v[28:31], v[240:243]
  s_add_u32 m0, s29, 0
  v_cvt_pk_bf16_f32 v182, v200, v201
  s_barrier
  v_mfma_f32_16x16x32_bf16 v[240:243], a[188:191], v[48:51], v[240:243]
  s_mov_b32 s34, 16384
  ds_write_b128 v13, v[180:183] offset:47616
  v_mfma_f32_16x16x32_bf16 v[104:107], a[192:195], v[72:75], v[104:107]
  v_cvt_pk_bf16_f32 v220, v220, v221
  v_cvt_pk_bf16_f32 v221, v222, v223
  v_mfma_f32_16x16x32_bf16 v[104:107], a[16:19], v[32:35], v[104:107]
  v_mfma_f32_16x16x32_bf16 v[104:107], a[160:163], v[52:55], v[104:107]
  ds_read_b128 a[232:235], v4 offset:128
  v_cvt_pk_bf16_f32 v223, v242, v243
  v_mfma_f32_16x16x32_bf16 v[124:127], a[196:199], v[72:75], v[124:127]
  ds_read_b128 a[236:239], v4 offset:192
  v_cvt_pk_bf16_f32 v222, v240, v241
  v_mfma_f32_16x16x32_bf16 v[124:127], a[36:39], v[32:35], v[124:127]
  v_mfma_f32_16x16x32_bf16 v[124:127], a[164:167], v[52:55], v[124:127]
  ds_write_b128 v13, v[220:223] offset:48640
  v_mfma_f32_16x16x32_bf16 v[144:147], a[200:203], v[72:75], v[144:147]
  v_cvt_pk_bf16_f32 v104, v104, v105
  v_cvt_pk_bf16_f32 v105, v106, v107
  v_mfma_f32_16x16x32_bf16 v[144:147], a[56:59], v[32:35], v[144:147]
  v_mfma_f32_16x16x32_bf16 v[144:147], a[168:171], v[52:55], v[144:147]
  ds_read_b128 a[252:255], v4 offset:448
  v_mfma_f32_16x16x32_bf16 v[164:167], a[204:207], v[72:75], v[164:167]
  ds_read_b128 a[228:231], v4 offset:64
  v_cvt_pk_bf16_f32 v107, v126, v127
  v_mfma_f32_16x16x32_bf16 v[164:167], a[76:79], v[32:35], v[164:167]
  ds_read_b128 a[240:243], v4 offset:256
  v_cvt_pk_bf16_f32 v106, v124, v125
  v_mfma_f32_16x16x32_bf16 v[164:167], a[172:175], v[52:55], v[164:167]
  ds_read_b128 a[244:247], v4 offset:320
  v_cvt_pk_bf16_f32 v144, v144, v145
  v_mfma_f32_16x16x32_bf16 v[184:187], a[208:211], v[72:75], v[184:187]
  ds_read_b128 a[224:227], v4 offset:0
  v_cvt_pk_bf16_f32 v145, v146, v147
  v_mfma_f32_16x16x32_bf16 v[184:187], a[96:99], v[32:35], v[184:187]
  ds_read_b128 a[248:251], v4 offset:384
  v_mfma_f32_16x16x32_bf16 v[184:187], a[176:179], v[52:55], v[184:187]
  ds_read_b128 a[0:3], v14 offset:0
  v_cvt_pk_bf16_f32 v146, v164, v165
  v_mfma_f32_16x16x32_bf16 v[204:207], a[212:215], v[72:75], v[204:207]
  ds_read_b128 a[20:23], v14 offset:1024
  v_cvt_pk_bf16_f32 v147, v166, v167
  v_mfma_f32_16x16x32_bf16 v[204:207], a[116:119], v[32:35], v[204:207]
  ds_read_b128 a[40:43], v14 offset:2048
  v_mfma_f32_16x16x32_bf16 v[204:207], a[180:183], v[52:55], v[204:207]
  v_cvt_pk_bf16_f32 v184, v184, v185
  v_cvt_pk_bf16_f32 v185, v186, v187
  v_mfma_f32_16x16x32_bf16 v[224:227], a[216:219], v[72:75], v[224:227]
  ds_write_b128 v13, v[104:107] offset:27136
  v_mfma_f32_16x16x32_bf16 v[224:227], a[136:139], v[32:35], v[224:227]
  s_waitcnt lgkmcnt(4)
  s_barrier
  v_mfma_f32_16x16x32_bf16 v[224:227], a[184:187], v[52:55], v[224:227]
  ds_read_b128 a[60:63], v14 offset:3072
  v_cvt_pk_bf16_f32 v187, v206, v207
  v_mfma_f32_16x16x32_bf16 v[244:247], a[220:223], v[72:75], v[244:247]
  ds_read_b128 a[80:83], v14 offset:4096
  v_cvt_pk_bf16_f32 v186, v204, v205
  v_mfma_f32_16x16x32_bf16 v[244:247], a[156:159], v[32:35], v[244:247]
  buffer_load_dwordx4 v1, s[12:15], s33 offen nt lds
  s_add_u32 m0, s29, 32
  v_mfma_f32_16x16x32_bf16 v[244:247], a[188:191], v[52:55], v[244:247]
  s_waitcnt lgkmcnt(4)
  ds_read_b128 a[100:103], v14 offset:5120
  v_cvt_pk_bf16_f32 v224, v224, v225
  v_mfma_f32_16x16x32_bf16 v[24:27], a[224:227], a[0:3], 0
  ds_read_b128 a[120:123], v14 offset:6144
  v_cvt_pk_bf16_f32 v225, v226, v227
  v_mfma_f32_16x16x32_bf16 v[24:27], a[228:231], a[20:23], v[24:27]
  s_waitcnt lgkmcnt(5)
  ds_read_b128 a[140:143], v14 offset:7168
  v_mfma_f32_16x16x32_bf16 v[24:27], a[232:235], a[40:43], v[24:27]
  s_waitcnt lgkmcnt(4)
  buffer_load_dwordx4 v1, s[12:15], s33 offen offset:1024 nt lds
  s_add_u32 m0, s29, 64
  v_mfma_f32_16x16x32_bf16 v[24:27], a[236:239], a[60:63], v[24:27]
  s_waitcnt lgkmcnt(3)
  ds_write_b128 v13, v[144:147] offset:28160
  v_mfma_f32_16x16x32_bf16 v[24:27], a[240:243], a[80:83], v[24:27]
  s_waitcnt lgkmcnt(3)
  v_cvt_pk_bf16_f32 v226, v244, v245
  v_cvt_pk_bf16_f32 v227, v246, v247
  v_mfma_f32_16x16x32_bf16 v[24:27], a[244:247], a[100:103], v[24:27]
  s_waitcnt lgkmcnt(2)
  buffer_load_dwordx4 v1, s[12:15], s33 offen offset:2048 nt lds
  s_add_u32 m0, s29, 96
  v_mfma_f32_16x16x32_bf16 v[24:27], a[248:251], a[120:123], v[24:27]
  s_waitcnt lgkmcnt(1)
  ds_write_b128 v13, v[184:187] offset:29184
  v_mfma_f32_16x16x32_bf16 v[24:27], a[252:255], a[140:143], v[24:27]
  v_mfma_f32_16x16x32_bf16 v[108:111], a[192:195], v[76:79], v[108:111]
  v_mfma_f32_16x16x32_bf16 v[108:111], a[16:19], v[36:39], v[108:111]
  ds_write_b128 v13, v[224:227] offset:30208
  v_mfma_f32_16x16x32_bf16 v[108:111], a[160:163], v[56:59], v[108:111]
  v_add_u32 v13, 62464, v13
  v_mfma_f32_16x16x32_bf16 v[128:131], a[196:199], v[76:79], v[128:131]
  buffer_load_dwordx4 v1, s[12:15], s33 offen offset:3072 nt lds
  s_mov_b32 s33, 49152
  v_mfma_f32_16x16x32_bf16 v[128:131], a[36:39], v[36:39], v[128:131]
  s_add_u32 m0, s29, 50688
  ds_read_b128 a[144:147], v14 offset:52736
  v_max3_f32 v89, v24, v25, v26
  v_mfma_f32_16x16x32_bf16 v[128:131], a[164:167], v[56:59], v[128:131]
  ds_read_b128 a[104:107], v14 offset:50688
  v_max_f32 v89, v89, v27
  v_mfma_f32_16x16x32_bf16 v[148:151], a[200:203], v[76:79], v[148:151]
  ds_max_f32 v15, v89 offset:0
  v_mfma_f32_16x16x32_bf16 v[148:151], a[56:59], v[36:39], v[148:151]
  ds_read_b128 a[124:127], v14 offset:51712
  v_cvt_pk_bf16_f32 v108, v108, v109
  v_mfma_f32_16x16x32_bf16 v[148:151], a[168:171], v[56:59], v[148:151]
  ds_read_b128 a[84:87], v14 offset:49664
  v_cvt_pk_bf16_f32 v109, v110, v111
  v_mfma_f32_16x16x32_bf16 v[168:171], a[204:207], v[76:79], v[168:171]
  ds_read_b128 a[64:67], v14 offset:48640
  v_cvt_pk_bf16_f32 v110, v128, v129
  v_mfma_f32_16x16x32_bf16 v[168:171], a[76:79], v[36:39], v[168:171]
  ds_read_b128 a[44:47], v14 offset:47616
  v_cvt_pk_bf16_f32 v111, v130, v131
  v_mfma_f32_16x16x32_bf16 v[168:171], a[172:175], v[56:59], v[168:171]
  v_cvt_pk_bf16_f32 v148, v148, v149
  v_cvt_pk_bf16_f32 v149, v150, v151
  v_mfma_f32_16x16x32_bf16 v[188:191], a[208:211], v[76:79], v[188:191]
  ds_write_b128 v13, v[108:111] offset:0
  v_mfma_f32_16x16x32_bf16 v[188:191], a[96:99], v[36:39], v[188:191]
  s_waitcnt vmcnt(14) lgkmcnt(5)
  s_barrier
  v_mfma_f32_16x16x32_bf16 v[188:191], a[176:179], v[56:59], v[188:191]
  buffer_load_dwordx4 v1, s[12:15], s33 offen nt lds
  v_cvt_pk_bf16_f32 v151, v170, v171
  v_mfma_f32_16x16x32_bf16 v[208:211], a[212:215], v[76:79], v[208:211]
  s_add_u32 m0, s29, 50720
  ds_read_b32 v89, v15 offset:0
  v_cvt_pk_bf16_f32 v150, v168, v169
  v_mfma_f32_16x16x32_bf16 v[208:211], a[116:119], v[36:39], v[208:211]
  ds_write_b128 v13, v[148:151] offset:1024
  v_mfma_f32_16x16x32_bf16 v[208:211], a[180:183], v[56:59], v[208:211]
  v_cvt_pk_bf16_f32 v188, v188, v189
  v_cvt_pk_bf16_f32 v189, v190, v191
  v_mfma_f32_16x16x32_bf16 v[228:231], a[216:219], v[76:79], v[228:231]
  v_mfma_f32_16x16x32_bf16 v[228:231], a[136:139], v[36:39], v[228:231]
  buffer_load_dwordx4 v1, s[12:15], s33 offen offset:1024 nt lds
  s_add_u32 m0, s29, 50752
  v_mfma_f32_16x16x32_bf16 v[228:231], a[184:187], v[56:59], v[228:231]
  ds_read_b128 a[24:27], v14 offset:46592
  v_cvt_pk_bf16_f32 v190, v208, v209
  v_mfma_f32_16x16x32_bf16 v[248:251], a[220:223], v[76:79], v[248:251]
  ds_read_b128 a[4:7], v14 offset:45568
  v_cvt_pk_bf16_f32 v191, v210, v211
  v_mfma_f32_16x16x32_bf16 v[248:251], a[156:159], v[36:39], v[248:251]
  s_waitcnt lgkmcnt(3)
  v_mul_f32 v89, s55, v89
  v_fma_f32 v24, v24, s32, v89
  v_mfma_f32_16x16x32_bf16 v[248:251], a[188:191], v[56:59], v[248:251]
  ds_write_b128 v13, v[188:191] offset:2048
  v_mfma_f32_16x16x32_bf16 v[28:31], a[252:255], a[144:147], 0
  v_cvt_pk_bf16_f32 v228, v228, v229
  v_cvt_pk_bf16_f32 v229, v230, v231
  v_mfma_f32_16x16x32_bf16 v[28:31], a[248:251], a[124:127], v[28:31]
  v_exp_f32 v24, v24
  v_mfma_f32_16x16x32_bf16 v[28:31], a[244:247], a[104:107], v[28:31]
  buffer_load_dwordx4 v1, s[12:15], s33 offen offset:2048 nt lds
  v_cvt_pk_bf16_f32 v231, v250, v251
  v_mfma_f32_16x16x32_bf16 v[28:31], a[240:243], a[84:87], v[28:31]
  s_add_u32 m0, s29, 50784
  ds_read_b128 a[148:151], v14 offset:34304
  v_cvt_pk_bf16_f32 v230, v248, v249
  v_mfma_f32_16x16x32_bf16 v[28:31], a[236:239], a[64:67], v[28:31]
  ds_write_b128 v13, v[228:231] offset:3072
  v_mfma_f32_16x16x32_bf16 v[28:31], a[232:235], a[44:47], v[28:31]
  s_waitcnt lgkmcnt(3)
  v_fma_f32 v25, v25, s32, v89
  v_fma_f32 v27, v27, s32, v89
  v_mfma_f32_16x16x32_bf16 v[28:31], a[228:231], a[24:27], v[28:31]
  buffer_store_dword v10, v9, s[4:7], s35 offen sc1
  v_mfma_f32_16x16x32_bf16 v[28:31], a[224:227], a[4:7], v[28:31]
  v_exp_f32 v27, v27
  v_mfma_f32_16x16x32_bf16 v[112:115], a[192:195], v[80:83], v[112:115]
  ds_read_b128 a[28:31], v14 offset:28160
  v_fma_f32 v26, v26, s32, v89
  v_mfma_f32_16x16x32_bf16 v[112:115], a[16:19], v[40:43], v[112:115]
  buffer_load_dwordx4 v1, s[12:15], s33 offen offset:3072 nt lds
  s_add_u32 m0, s29, 96256
  v_mfma_f32_16x16x32_bf16 v[112:115], a[160:163], v[60:63], v[112:115]
  s_mov_b32 s33, 81920
  v_exp_f32 v26, v26
  v_mfma_f32_16x16x32_bf16 v[132:135], a[196:199], v[80:83], v[132:135]
  v_exp_f32 v25, v25
  v_mfma_f32_16x16x32_bf16 v[132:135], a[36:39], v[40:43], v[132:135]
  ds_read_b128 a[68:71], v14 offset:30208
  v_cvt_pk_bf16_f32 v44, v24, v25
  v_mfma_f32_16x16x32_bf16 v[132:135], a[164:167], v[60:63], v[132:135]
  ds_read_b128 a[128:131], v14 offset:33280
  v_cvt_pk_bf16_f32 v45, v26, v27
  v_mfma_f32_16x16x32_bf16 v[152:155], a[200:203], v[80:83], v[152:155]
  ds_read_b128 a[8:11], v14 offset:27136
  v_max3_f32 v90, v28, v29, v30
  v_mfma_f32_16x16x32_bf16 v[152:155], a[56:59], v[40:43], v[152:155]
  ds_read_b128 a[48:51], v14 offset:29184
  v_max_f32 v90, v90, v31
  v_mfma_f32_16x16x32_bf16 v[152:155], a[168:171], v[60:63], v[152:155]
  ds_read_b128 a[108:111], v14 offset:32256
  v_cvt_pk_bf16_f32 v112, v112, v113
  v_mfma_f32_16x16x32_bf16 v[172:175], a[204:207], v[80:83], v[172:175]
  ds_read_b128 a[88:91], v14 offset:31232
  v_cvt_pk_bf16_f32 v113, v114, v115
  v_mfma_f32_16x16x32_bf16 v[172:175], a[76:79], v[40:43], v[172:175]
  ds_max_f32 v15, v90 offset:2112
  v_mfma_f32_16x16x32_bf16 v[172:175], a[172:175], v[60:63], v[172:175]
  v_cvt_pk_bf16_f32 v114, v132, v133
  v_cvt_pk_bf16_f32 v115, v134, v135
  v_mfma_f32_16x16x32_bf16 v[192:195], a[208:211], v[80:83], v[192:195]
  ds_write_b128 v13, v[112:115] offset:16896
  v_mfma_f32_16x16x32_bf16 v[192:195], a[96:99], v[40:43], v[192:195]
  v_cvt_pk_bf16_f32 v152, v152, v153
  v_cvt_pk_bf16_f32 v153, v154, v155
  v_mfma_f32_16x16x32_bf16 v[192:195], a[176:179], v[60:63], v[192:195]
  v_cvt_pk_bf16_f32 v154, v172, v173
  v_cvt_pk_bf16_f32 v155, v174, v175
  v_mfma_f32_16x16x32_bf16 v[212:215], a[212:215], v[80:83], v[212:215]
  ds_write_b128 v13, v[152:155] offset:17920
  v_mfma_f32_16x16x32_bf16 v[212:215], a[116:119], v[40:43], v[212:215]
  v_add_u32 v14, 62464, v14
  s_waitcnt vmcnt(9) lgkmcnt(2)
  v_mfma_f32_16x16x32_bf16 v[212:215], a[180:183], v[60:63], v[212:215]
  s_barrier
  buffer_load_dwordx4 v1, s[16:19], s34 offen nt lds
  v_cvt_pk_bf16_f32 v192, v192, v193
  v_mfma_f32_16x16x32_bf16 v[232:235], a[216:219], v[80:83], v[232:235]
  s_add_u32 m0, s29, 96288
  ds_read_b32 v90, v15 offset:2112
  v_cvt_pk_bf16_f32 v193, v194, v195
  v_mfma_f32_16x16x32_bf16 v[232:235], a[136:139], v[40:43], v[232:235]
  buffer_load_dwordx4 v1, s[16:19], s34 offen offset:1024 nt lds
  v_cvt_pk_bf16_f32 v194, v212, v213
  v_mfma_f32_16x16x32_bf16 v[232:235], a[184:187], v[60:63], v[232:235]
  s_add_u32 m0, s29, 96320
  ds_read_b128 a[132:135], v14 offset:6144
  v_cvt_pk_bf16_f32 v195, v214, v215
  v_mfma_f32_16x16x32_bf16 v[252:255], a[220:223], v[80:83], v[252:255]
  ds_write_b128 v13, v[192:195] offset:18944
  v_mfma_f32_16x16x32_bf16 v[252:255], a[156:159], v[40:43], v[252:255]
  v_add_f32 v84, v24, v25
  v_add_f32 v84, v84, v26
  v_mfma_f32_16x16x32_bf16 v[252:255], a[188:191], v[60:63], v[252:255]
  v_cvt_pk_bf16_f32 v232, v232, v233
  v_cvt_pk_bf16_f32 v233, v234, v235
  v_mfma_f32_16x16x32_bf16 v[32:35], a[224:227], a[8:11], 0
  s_waitcnt lgkmcnt(2)
  ds_read_b128 a[152:155], v14 offset:7168
  v_mul_f32 v90, s55, v90
  v_mfma_f32_16x16x32_bf16 v[32:35], a[228:231], a[28:31], v[32:35]
  ds_read_b128 a[112:115], v14 offset:5120
  v_fma_f32 v31, v31, s32, v90
  v_mfma_f32_16x16x32_bf16 v[32:35], a[232:235], a[48:51], v[32:35]
  ds_read_b128 a[92:95], v14 offset:4096
  v_cvt_pk_bf16_f32 v235, v254, v255
  v_mfma_f32_16x16x32_bf16 v[32:35], a[236:239], a[68:71], v[32:35]
  ds_read_b128 a[52:55], v14 offset:2048
  v_cvt_pk_bf16_f32 v234, v252, v253
  v_mfma_f32_16x16x32_bf16 v[32:35], a[240:243], a[88:91], v[32:35]
  ds_read_b128 a[72:75], v14 offset:3072
  v_fma_f32 v30, v30, s32, v90
  v_mfma_f32_16x16x32_bf16 v[32:35], a[244:247], a[108:111], v[32:35]
  buffer_load_dwordx4 v1, s[16:19], s34 offen offset:2048 nt lds
  v_fma_f32 v29, v29, s32, v90
  v_mfma_f32_16x16x32_bf16 v[32:35], a[248:251], a[128:131], v[32:35]
  s_add_u32 m0, s29, 96352
  ds_read_b128 a[32:35], v14 offset:1024
  v_fma_f32 v28, v28, s32, v90
  v_mfma_f32_16x16x32_bf16 v[32:35], a[252:255], a[148:151], v[32:35]
  s_waitcnt lgkmcnt(5)
  ds_read_b128 a[12:15], v14 offset:0
  v_add_f32 v84, v84, v27
  v_mfma_f32_16x16x32_bf16 v[36:39], a[252:255], a[152:155], 0
  ds_read_b128 a[160:163], v4 offset:16896
  v_mfma_f32_16x16x32_bf16 v[36:39], a[248:251], a[132:135], v[36:39]
  s_waitcnt lgkmcnt(6)
  ds_read_b128 a[168:171], v4 offset:17024
  v_mfma_f32_16x16x32_bf16 v[36:39], a[244:247], a[112:115], v[36:39]
  s_waitcnt lgkmcnt(6)
  ds_read_b128 a[164:167], v4 offset:16960
  v_max3_f32 v91, v32, v33, v34
  v_mfma_f32_16x16x32_bf16 v[36:39], a[240:243], a[92:95], v[36:39]
  s_waitcnt lgkmcnt(5)
  ds_read_b128 a[188:191], v4 offset:17344
  v_max_f32 v91, v91, v35
  v_mfma_f32_16x16x32_bf16 v[36:39], a[236:239], a[72:75], v[36:39]
  ds_read_b128 a[172:175], v4 offset:17088
  v_mfma_f32_16x16x32_bf16 v[36:39], a[232:235], a[52:55], v[36:39]
  s_waitcnt lgkmcnt(6)
  ds_read_b128 a[184:187], v4 offset:17280
  v_mfma_f32_16x16x32_bf16 v[36:39], a[228:231], a[32:35], v[36:39]
  s_waitcnt lgkmcnt(6)
  ds_read_b128 a[180:183], v4 offset:17216
  v_mfma_f32_16x16x32_bf16 v[36:39], a[224:227], a[12:15], v[36:39]
  s_waitcnt lgkmcnt(6)
  ds_read_b128 a[176:179], v4 offset:17152
  v_mfma_f32_16x16x32_bf16 v[24:27], a[160:163], a[0:3], 0
  s_waitcnt lgkmcnt(5)
  v_exp_f32 v30, v30
  v_mfma_f32_16x16x32_bf16 v[24:27], a[164:167], a[20:23], v[24:27]
  ds_write_b128 v13, v[232:235] offset:19968
  v_mfma_f32_16x16x32_bf16 v[24:27], a[168:171], a[40:43], v[24:27]
  s_waitcnt lgkmcnt(4)
  buffer_load_dwordx4 v1, s[16:19], s34 offen offset:3072 nt lds
  s_add_u32 m0, s29, 113152
  v_mfma_f32_16x16x32_bf16 v[24:27], a[172:175], a[60:63], v[24:27]
  s_waitcnt lgkmcnt(1)
  s_mov_b32 s34, 32768
  v_exp_f32 v29, v29
  v_exp_f32 v28, v28
  v_exp_f32 v31, v31
  v_mfma_f32_16x16x32_bf16 v[24:27], a[176:179], a[80:83], v[24:27]
  ds_read_b64_tr_b16 a[194:195], v6 offset:50688
  v_cvt_pk_bf16_f32 v49, v30, v31
  v_mfma_f32_16x16x32_bf16 v[24:27], a[180:183], a[100:103], v[24:27]
  ds_read_b64_tr_b16 a[192:193], v5 offset:50688
  v_add_f32 v85, v28, v29
  v_mfma_f32_16x16x32_bf16 v[24:27], a[184:187], a[120:123], v[24:27]
  ds_read_b64_tr_b16 a[198:199], v6 offset:50720
  v_cvt_pk_bf16_f32 v48, v28, v29
  v_mfma_f32_16x16x32_bf16 v[24:27], a[188:191], a[140:143], v[24:27]
  ds_write_b64 v7, v[48:49] offset:10752
  v_add_f32 v85, v85, v30
  v_add_f32 v85, v85, v31
  v_mfma_f32_16x16x32_bf16 v[28:31], a[188:191], a[144:147], 0
  ds_write_b64 v7, v[44:45] offset:10240
  v_mfma_f32_16x16x32_bf16 v[28:31], a[184:187], a[124:127], v[28:31]
  ds_max_f32 v15, v91 offset:4224
  v_mfma_f32_16x16x32_bf16 v[28:31], a[180:183], a[104:107], v[28:31]
  ds_read_b64_tr_b16 a[200:201], v5 offset:50752
  v_max3_f32 v92, v36, v37, v38
  v_mfma_f32_16x16x32_bf16 v[28:31], a[176:179], a[84:87], v[28:31]
  ds_read_b64_tr_b16 a[206:207], v6 offset:50784
  v_max_f32 v92, v92, v39
  v_mfma_f32_16x16x32_bf16 v[28:31], a[172:175], a[64:67], v[28:31]
  ds_max_f32 v15, v92 offset:6336
  v_mfma_f32_16x16x32_bf16 v[28:31], a[168:171], a[44:47], v[28:31]
  ds_read_b64_tr_b16 a[196:197], v5 offset:50720
  v_fma_f32 v27, v27, s32, v89
  v_mfma_f32_16x16x32_bf16 v[28:31], a[164:167], a[24:27], v[28:31]
  ds_read_b64_tr_b16 a[204:205], v5 offset:50784
  v_fma_f32 v25, v25, s32, v89
  v_mfma_f32_16x16x32_bf16 v[28:31], a[160:163], a[4:7], v[28:31]
  ds_read_b64_tr_b16 a[218:219], v6 offset:50880
  v_fma_f32 v24, v24, s32, v89
  ds_read_b64_tr_b16 a[212:213], v5 offset:50848
  ds_read_b64_tr_b16 a[202:203], v6 offset:50752
  ds_read_b64_tr_b16 a[214:215], v6 offset:50848
  ds_read_b64_tr_b16 a[210:211], v6 offset:50816
  ds_read_b64_tr_b16 a[216:217], v5 offset:50880
  ds_read_b64_tr_b16 a[208:209], v5 offset:50816
  ds_read_b64_tr_b16 a[220:221], v5 offset:50912
  ds_read_b64_tr_b16 a[222:223], v6 offset:50912
  v_exp_f32 v27, v27
  v_fma_f32 v28, v28, s32, v90
  v_exp_f32 v28, v28
  v_exp_f32 v24, v24
  v_fma_f32 v29, v29, s32, v90
  v_fma_f32 v31, v31, s32, v90
  v_exp_f32 v31, v31
  s_waitcnt lgkmcnt(11)
  s_barrier
  ds_read_b128 a[16:19], v14 offset:16896
  ds_read_b128 a[36:39], v14 offset:17920
  ds_read_b128 a[56:59], v14 offset:18944
  ds_read_b128 a[76:79], v14 offset:19968
  ds_read_b128 a[96:99], v14 offset:20992
  buffer_load_dwordx4 v1, s[16:19], s34 offen nt lds
  s_add_u32 m0, s29, 113184
  v_exp_f32 v25, v25
  ds_read_b128 a[116:119], v14 offset:22016
  v_cvt_pk_bf16_f32 v64, v24, v25
  ds_read_b128 a[136:139], v14 offset:23040
  v_add_f32 v84, v84, v24
  v_add_f32 v84, v84, v25
  ds_read_b128 a[156:159], v14 offset:24064
  buffer_load_dwordx4 v1, s[16:19], s34 offen offset:1024 nt lds
  s_add_u32 m0, s29, 113216
  ds_read_b32 v91, v15 offset:4224
  v_fma_f32 v26, v26, s32, v89
  ds_read_b64 v[46:47], v8 offset:10240
  s_waitcnt lgkmcnt(9)
  v_mfma_f32_16x16x32_bf16 v[40:43], a[224:227], a[16:19], 0
  s_waitcnt lgkmcnt(8)
  ds_read_b32 v92, v15 offset:6336
  v_fma_f32 v30, v30, s32, v90
  v_mfma_f32_16x16x32_bf16 v[40:43], a[228:231], a[36:39], v[40:43]
  s_waitcnt lgkmcnt(8)
  ds_read_b64 v[50:51], v8 offset:10752
  v_add_f32 v85, v85, v28
  v_mfma_f32_16x16x32_bf16 v[40:43], a[232:235], a[56:59], v[40:43]
  s_waitcnt lgkmcnt(8)
  v_exp_f32 v26, v26
  v_mfma_f32_16x16x32_bf16 v[40:43], a[236:239], a[76:79], v[40:43]
  s_waitcnt lgkmcnt(7)
  v_add_f32 v84, v84, v26
  v_add_f32 v84, v84, v27
  v_mfma_f32_16x16x32_bf16 v[40:43], a[240:243], a[96:99], v[40:43]
  s_waitcnt lgkmcnt(6)
  v_exp_f32 v30, v30
  v_mfma_f32_16x16x32_bf16 v[40:43], a[244:247], a[116:119], v[40:43]
  s_waitcnt lgkmcnt(5)
  v_cvt_pk_bf16_f32 v65, v26, v27
  v_cvt_pk_bf16_f32 v69, v30, v31
  v_mfma_f32_16x16x32_bf16 v[40:43], a[248:251], a[136:139], v[40:43]
  s_waitcnt lgkmcnt(4)
  buffer_load_dwordx4 v1, s[16:19], s34 offen offset:2048 nt lds
  s_add_u32 m0, s29, 113248
  v_mfma_f32_16x16x32_bf16 v[40:43], a[252:255], a[156:159], v[40:43]
  s_waitcnt lgkmcnt(2)
  v_mul_f32 v91, s55, v91
  v_fma_f32 v33, v33, s32, v91
  v_mfma_f32_16x16x32_bf16 v[96:99], v[44:47], a[192:195], 0
  v_exp_f32 v33, v33
  v_mfma_f32_16x16x32_bf16 v[116:119], v[44:47], a[196:199], 0
  v_fma_f32 v34, v34, s32, v91
  v_fma_f32 v32, v32, s32, v91
  v_mfma_f32_16x16x32_bf16 v[136:139], v[44:47], a[200:203], 0
  v_exp_f32 v34, v34
  v_mfma_f32_16x16x32_bf16 v[156:159], v[44:47], a[204:207], 0
  v_exp_f32 v32, v32
  v_mfma_f32_16x16x32_bf16 v[176:179], v[44:47], a[208:211], 0
  v_add_f32 v86, v32, v33
  v_add_f32 v86, v86, v34
  v_mfma_f32_16x16x32_bf16 v[196:199], v[44:47], a[212:215], 0
  buffer_load_dwordx4 v1, s[16:19], s34 offen offset:3072 nt lds
  v_cvt_pk_bf16_f32 v52, v32, v33
  v_mfma_f32_16x16x32_bf16 v[216:219], v[44:47], a[216:219], 0
  s_add_u32 m0, s29, 16896
  v_max3_f32 v93, v40, v41, v42
  v_max_f32 v93, v93, v43
  v_mfma_f32_16x16x32_bf16 v[236:239], v[44:47], a[220:223], 0
  s_waitcnt lgkmcnt(0)
  s_mov_b32 s34, 49152
  ds_max_f32 v15, v93 offset:8448
  v_fma_f32 v35, v35, s32, v91
  v_exp_f32 v35, v35
  v_mul_f32 v92, s55, v92
  v_add_f32 v86, v86, v35
  v_cvt_pk_bf16_f32 v53, v34, v35
  v_mfma_f32_16x16x32_bf16 v[32:35], a[160:163], a[8:11], 0
  ds_write_b64 v7, v[52:53] offset:11264
  v_mfma_f32_16x16x32_bf16 v[32:35], a[164:167], a[28:31], v[32:35]
  v_fma_f32 v36, v36, s32, v92
  v_fma_f32 v39, v39, s32, v92
  v_mfma_f32_16x16x32_bf16 v[32:35], a[168:171], a[48:51], v[32:35]
  v_exp_f32 v39, v39
  v_mfma_f32_16x16x32_bf16 v[32:35], a[172:175], a[68:71], v[32:35]
  v_exp_f32 v36, v36
  v_mfma_f32_16x16x32_bf16 v[32:35], a[176:179], a[88:91], v[32:35]
  v_fma_f32 v37, v37, s32, v92
  v_fma_f32 v38, v38, s32, v92
  v_mfma_f32_16x16x32_bf16 v[32:35], a[180:183], a[108:111], v[32:35]
  s_waitcnt lgkmcnt(1)
  v_exp_f32 v37, v37
  v_mfma_f32_16x16x32_bf16 v[32:35], a[184:187], a[128:131], v[32:35]
  s_barrier
  ds_read_b32 v93, v15 offset:8448
  v_cvt_pk_bf16_f32 v56, v36, v37
  v_mfma_f32_16x16x32_bf16 v[32:35], a[188:191], a[148:151], v[32:35]
  buffer_load_dwordx4 v1, s[12:15], s33 offen nt lds
  v_add_f32 v87, v36, v37
  v_mfma_f32_16x16x32_bf16 v[100:103], v[48:51], a[192:195], 0
  s_add_u32 m0, s29, 16928
  v_exp_f32 v38, v38
  v_mfma_f32_16x16x32_bf16 v[120:123], v[48:51], a[196:199], 0
  v_add_f32 v87, v87, v38
  v_add_f32 v87, v87, v39
  v_mfma_f32_16x16x32_bf16 v[140:143], v[48:51], a[200:203], 0
  s_waitcnt lgkmcnt(0)
  v_cvt_pk_bf16_f32 v57, v38, v39
  v_mul_f32 v93, s55, v93
  v_mfma_f32_16x16x32_bf16 v[160:163], v[48:51], a[204:207], 0
  ds_write_b64 v7, v[56:57] offset:11776
  v_mfma_f32_16x16x32_bf16 v[180:183], v[48:51], a[208:211], 0
  buffer_load_dwordx4 v1, s[12:15], s33 offen offset:1024 nt lds
  v_fma_f32 v42, v42, s32, v93
  v_mfma_f32_16x16x32_bf16 v[200:203], v[48:51], a[212:215], 0
  s_add_u32 m0, s29, 16960
  v_exp_f32 v42, v42
  v_mfma_f32_16x16x32_bf16 v[220:223], v[48:51], a[216:219], 0
  v_fma_f32 v40, v40, s32, v93
  v_fma_f32 v41, v41, s32, v93
  v_mfma_f32_16x16x32_bf16 v[240:243], v[48:51], a[220:223], 0
  v_exp_f32 v40, v40
  v_mfma_f32_16x16x32_bf16 v[36:39], a[188:191], a[152:155], 0
  v_exp_f32 v41, v41
  v_mfma_f32_16x16x32_bf16 v[36:39], a[184:187], a[132:135], v[36:39]
  v_cvt_pk_bf16_f32 v60, v40, v41
  v_fma_f32 v43, v43, s32, v93
  v_mfma_f32_16x16x32_bf16 v[36:39], a[180:183], a[112:115], v[36:39]
  v_exp_f32 v43, v43
  v_mfma_f32_16x16x32_bf16 v[36:39], a[176:179], a[92:95], v[36:39]
  buffer_load_dwordx4 v1, s[12:15], s33 offen offset:2048 nt lds
  v_cvt_pk_bf16_f32 v61, v42, v43
  v_mfma_f32_16x16x32_bf16 v[36:39], a[172:175], a[72:75], v[36:39]
  s_add_u32 m0, s29, 16992
  ds_write_b64 v7, v[60:61] offset:12288
  v_mfma_f32_16x16x32_bf16 v[36:39], a[168:171], a[52:55], v[36:39]
  v_add_f32 v88, v40, v41
  v_add_f32 v88, v88, v42
  v_mfma_f32_16x16x32_bf16 v[36:39], a[164:167], a[32:35], v[36:39]
  v_add_f32 v88, v88, v43
  v_fma_f32 v35, v35, s32, v91
  v_mfma_f32_16x16x32_bf16 v[36:39], a[160:163], a[12:15], v[36:39]
  v_fma_f32 v33, v33, s32, v91
  v_fma_f32 v34, v34, s32, v91
  v_mfma_f32_16x16x32_bf16 v[40:43], a[160:163], a[16:19], 0
  buffer_load_dwordx4 v1, s[12:15], s33 offen offset:3072 nt lds
  v_fma_f32 v32, v32, s32, v91
  v_mfma_f32_16x16x32_bf16 v[40:43], a[164:167], a[36:39], v[40:43]
  s_add_u32 m0, s29, 130048
  v_exp_f32 v33, v33
  v_mfma_f32_16x16x32_bf16 v[40:43], a[168:171], a[56:59], v[40:43]
  s_mov_b32 s33, 98304
  ds_read_b128 a[160:163], v4 offset:33792
  s_waitcnt lgkmcnt(1)
  v_mfma_f32_16x16x32_bf16 v[40:43], a[172:175], a[76:79], v[40:43]
  s_barrier
  ds_read_b64 v[54:55], v8 offset:11264
  v_fma_f32 v37, v37, s32, v92
  v_mfma_f32_16x16x32_bf16 v[40:43], a[176:179], a[96:99], v[40:43]
  ds_read_b64 v[58:59], v8 offset:11776
  v_fma_f32 v38, v38, s32, v92
  v_mfma_f32_16x16x32_bf16 v[40:43], a[180:183], a[116:119], v[40:43]
  ds_read_b64 v[62:63], v8 offset:12288
  v_fma_f32 v39, v39, s32, v92
  v_mfma_f32_16x16x32_bf16 v[40:43], a[184:187], a[136:139], v[40:43]
  buffer_load_dwordx4 v1, s[16:19], s34 offen nt lds
  v_fma_f32 v36, v36, s32, v92
  v_mfma_f32_16x16x32_bf16 v[40:43], a[188:191], a[156:159], v[40:43]
  s_waitcnt lgkmcnt(2)
  s_add_u32 m0, s29, 130080
  v_exp_f32 v37, v37
  v_mfma_f32_16x16x32_bf16 v[104:107], v[52:55], a[192:195], 0
  v_exp_f32 v36, v36
  v_mfma_f32_16x16x32_bf16 v[124:127], v[52:55], a[196:199], 0
  ds_read_b128 a[184:187], v4 offset:34176
  v_cvt_pk_bf16_f32 v76, v36, v37
  v_mfma_f32_16x16x32_bf16 v[144:147], v[52:55], a[200:203], 0
  ds_read_b128 a[164:167], v4 offset:33856
  v_fma_f32 v43, v43, s32, v93
  v_mfma_f32_16x16x32_bf16 v[164:167], v[52:55], a[204:207], 0
  v_exp_f32 v34, v34
  v_mfma_f32_16x16x32_bf16 v[184:187], v[52:55], a[208:211], 0
  buffer_load_dwordx4 v1, s[16:19], s34 offen offset:1024 nt lds
  v_fma_f32 v42, v42, s32, v93
  v_mfma_f32_16x16x32_bf16 v[204:207], v[52:55], a[212:215], 0
  s_add_u32 m0, s29, 130112
  v_exp_f32 v43, v43
  v_mfma_f32_16x16x32_bf16 v[224:227], v[52:55], a[216:219], 0
  ds_read_b128 a[172:175], v4 offset:33984
  v_fma_f32 v41, v41, s32, v93
  v_mfma_f32_16x16x32_bf16 v[244:247], v[52:55], a[220:223], 0
  s_waitcnt lgkmcnt(3)
  v_exp_f32 v41, v41
  v_mfma_f32_16x16x32_bf16 v[108:111], v[56:59], a[192:195], 0
  ds_read_b128 a[176:179], v4 offset:34048
  v_fma_f32 v40, v40, s32, v93
  v_mfma_f32_16x16x32_bf16 v[128:131], v[56:59], a[196:199], 0
  ds_read_b128 a[168:171], v4 offset:33920
  v_add_f32 v87, v87, v36
  v_mfma_f32_16x16x32_bf16 v[148:151], v[56:59], a[200:203], 0
  buffer_load_dwordx4 v1, s[16:19], s34 offen offset:2048 nt lds
  v_add_f32 v87, v87, v37
  v_mfma_f32_16x16x32_bf16 v[168:171], v[56:59], a[204:207], 0
  s_add_u32 m0, s29, 130144
  v_exp_f32 v40, v40
  v_mfma_f32_16x16x32_bf16 v[188:191], v[56:59], a[208:211], 0
  ds_read_b128 a[188:191], v4 offset:34240
  v_cvt_pk_bf16_f32 v80, v40, v41
  v_mfma_f32_16x16x32_bf16 v[208:211], v[56:59], a[212:215], 0
  v_exp_f32 v38, v38
  v_mfma_f32_16x16x32_bf16 v[228:231], v[56:59], a[216:219], 0
  v_exp_f32 v35, v35
  v_mfma_f32_16x16x32_bf16 v[248:251], v[56:59], a[220:223], 0
  v_exp_f32 v42, v42
  v_mfma_f32_16x16x32_bf16 v[112:115], v[60:63], a[192:195], 0
  buffer_load_dwordx4 v1, s[16:19], s34 offen offset:3072 nt lds
  v_cvt_pk_bf16_f32 v73, v34, v35
  v_mfma_f32_16x16x32_bf16 v[132:135], v[60:63], a[196:199], 0
  s_add_u32 m0, s29, 33792
  v_exp_f32 v32, v32
  v_mfma_f32_16x16x32_bf16 v[152:155], v[60:63], a[200:203], 0
  s_mov_b32 s34, 65536
  ds_read_b128 a[180:183], v4 offset:34112
  v_cvt_pk_bf16_f32 v72, v32, v33
  v_mfma_f32_16x16x32_bf16 v[172:175], v[60:63], a[204:207], 0
  ds_write_b64 v7, v[72:73] offset:1024
  v_mfma_f32_16x16x32_bf16 v[192:195], v[60:63], a[208:211], 0
  v_cvt_pk_bf16_f32 v81, v42, v43
  v_add_f32 v86, v86, v32
  v_mfma_f32_16x16x32_bf16 v[212:215], v[60:63], a[212:215], 0
  v_exp_f32 v29, v29
  v_mfma_f32_16x16x32_bf16 v[232:235], v[60:63], a[216:219], 0
  v_cvt_pk_bf16_f32 v68, v28, v29
  v_add_f32 v85, v85, v29
  v_mfma_f32_16x16x32_bf16 v[252:255], v[60:63], a[220:223], 0
  v_exp_f32 v39, v39
  v_mfma_f32_16x16x32_bf16 v[24:27], a[160:163], a[0:3], 0
  s_waitcnt lgkmcnt(2)
  v_cvt_pk_bf16_f32 v77, v38, v39
  v_add_f32 v85, v85, v30
  v_mfma_f32_16x16x32_bf16 v[24:27], a[164:167], a[20:23], v[24:27]
  ds_write_b64 v7, v[76:77] offset:1536
  v_mfma_f32_16x16x32_bf16 v[24:27], a[168:171], a[40:43], v[24:27]
  ds_write_b64 v7, v[64:65] offset:0
  v_mfma_f32_16x16x32_bf16 v[24:27], a[172:175], a[60:63], v[24:27]
  ds_write_b64 v7, v[80:81] offset:2048
  v_mfma_f32_16x16x32_bf16 v[24:27], a[176:179], a[80:83], v[24:27]
  s_waitcnt lgkmcnt(3)
  ds_write_b64 v7, v[68:69] offset:512
  v_mfma_f32_16x16x32_bf16 v[24:27], a[180:183], a[100:103], v[24:27]
  v_add_f32 v85, v85, v31
  v_add_f32 v86, v86, v33
  v_mfma_f32_16x16x32_bf16 v[24:27], a[184:187], a[120:123], v[24:27]
  v_add_f32 v86, v86, v34
  v_add_f32 v86, v86, v35
  v_mfma_f32_16x16x32_bf16 v[24:27], a[188:191], a[140:143], v[24:27]
  v_add_f32 v87, v87, v38
  v_add_f32 v87, v87, v39
  v_mfma_f32_16x16x32_bf16 v[28:31], a[188:191], a[144:147], 0
  v_add_f32 v88, v88, v40
  v_add_f32 v88, v88, v41
  v_mfma_f32_16x16x32_bf16 v[28:31], a[184:187], a[124:127], v[28:31]
  v_add_f32 v88, v88, v42
  v_add_f32 v88, v88, v43
  v_mfma_f32_16x16x32_bf16 v[28:31], a[180:183], a[104:107], v[28:31]
  v_fma_f32 v25, v25, s32, v89
  v_fma_f32 v27, v27, s32, v89
  v_mfma_f32_16x16x32_bf16 v[28:31], a[176:179], a[84:87], v[28:31]
  v_fma_f32 v26, v26, s32, v89
  s_waitcnt vmcnt(12) lgkmcnt(0)
  v_mfma_f32_16x16x32_bf16 v[28:31], a[172:175], a[64:67], v[28:31]
  s_barrier
  buffer_load_dwordx4 v1, s[12:15], s33 offen nt lds
  s_add_u32 m0, s29, 33824
  v_mfma_f32_16x16x32_bf16 v[28:31], a[168:171], a[44:47], v[28:31]
  v_exp_f32 v25, v25
  v_mfma_f32_16x16x32_bf16 v[28:31], a[164:167], a[24:27], v[28:31]
  buffer_load_dwordx4 v1, s[12:15], s33 offen offset:1024 nt lds
  v_fma_f32 v24, v24, s32, v89
  v_mfma_f32_16x16x32_bf16 v[28:31], a[160:163], a[4:7], v[28:31]
  s_add_u32 m0, s29, 33856
  v_exp_f32 v24, v24
  v_mfma_f32_16x16x32_bf16 v[32:35], a[160:163], a[8:11], 0
  v_exp_f32 v27, v27
  v_mfma_f32_16x16x32_bf16 v[32:35], a[164:167], a[28:31], v[32:35]
  v_exp_f32 v26, v26
  v_mfma_f32_16x16x32_bf16 v[32:35], a[168:171], a[48:51], v[32:35]
  ds_read_b64_tr_b16 a[192:193], v5 offset:0
  v_cvt_pk_bf16_f32 v45, v26, v27
  v_mfma_f32_16x16x32_bf16 v[32:35], a[172:175], a[68:71], v[32:35]
  ds_read_b64_tr_b16 a[194:195], v6 offset:0
  v_cvt_pk_bf16_f32 v44, v24, v25
  v_mfma_f32_16x16x32_bf16 v[32:35], a[176:179], a[88:91], v[32:35]
  buffer_load_dwordx4 v1, s[12:15], s33 offen offset:2048 nt lds
  v_fma_f32 v29, v29, s32, v90
  v_mfma_f32_16x16x32_bf16 v[32:35], a[180:183], a[108:111], v[32:35]
  s_add_u32 m0, s29, 33888
  ds_write_b64 v7, v[44:45] offset:10240
  v_mfma_f32_16x16x32_bf16 v[32:35], a[184:187], a[128:131], v[32:35]
  ds_read_b64 v[66:67], v8 offset:0
  v_fma_f32 v28, v28, s32, v90
  v_mfma_f32_16x16x32_bf16 v[32:35], a[188:191], a[148:151], v[32:35]
  ds_read_b64 v[70:71], v8 offset:512
  v_fma_f32 v31, v31, s32, v90
  v_mfma_f32_16x16x32_bf16 v[36:39], a[188:191], a[152:155], 0
  v_exp_f32 v31, v31
  v_mfma_f32_16x16x32_bf16 v[36:39], a[184:187], a[132:135], v[36:39]
  v_exp_f32 v28, v28
  v_mfma_f32_16x16x32_bf16 v[36:39], a[180:183], a[112:115], v[36:39]
  ds_read_b64 v[74:75], v8 offset:1024
  v_fma_f32 v30, v30, s32, v90
  v_mfma_f32_16x16x32_bf16 v[36:39], a[176:179], a[92:95], v[36:39]
  v_exp_f32 v30, v30
  v_mfma_f32_16x16x32_bf16 v[36:39], a[172:175], a[72:75], v[36:39]
  v_exp_f32 v29, v29
  v_mfma_f32_16x16x32_bf16 v[36:39], a[168:171], a[52:55], v[36:39]
  buffer_load_dwordx4 v1, s[12:15], s33 offen offset:3072 nt lds
  v_cvt_pk_bf16_f32 v48, v28, v29
  v_mfma_f32_16x16x32_bf16 v[36:39], a[164:167], a[32:35], v[36:39]
  s_add_u32 m0, s29, 146944
  ds_read_b64 v[82:83], v8 offset:2048
  v_cvt_pk_bf16_f32 v49, v30, v31
  v_mfma_f32_16x16x32_bf16 v[36:39], a[160:163], a[12:15], v[36:39]
  s_mov_b32 s33, 114688
  ds_write_b64 v7, v[48:49] offset:10752
  v_mfma_f32_16x16x32_bf16 v[40:43], a[160:163], a[16:19], 0
  ds_read_b64 v[78:79], v8 offset:1536
  v_fma_f32 v34, v34, s32, v91
  v_mfma_f32_16x16x32_bf16 v[40:43], a[164:167], a[36:39], v[40:43]
  ds_read_b64_tr_b16 a[196:197], v5 offset:32
  v_fma_f32 v32, v32, s32, v91
  v_mfma_f32_16x16x32_bf16 v[40:43], a[168:171], a[56:59], v[40:43]
  ds_read_b64_tr_b16 a[198:199], v6 offset:32
  v_fma_f32 v35, v35, s32, v91
  v_mfma_f32_16x16x32_bf16 v[40:43], a[172:175], a[76:79], v[40:43]
  ds_read_b64_tr_b16 a[202:203], v6 offset:64
  v_fma_f32 v33, v33, s32, v91
  v_mfma_f32_16x16x32_bf16 v[40:43], a[176:179], a[96:99], v[40:43]
  ds_read_b64_tr_b16 a[200:201], v5 offset:64
  v_fma_f32 v36, v36, s32, v92
  v_mfma_f32_16x16x32_bf16 v[40:43], a[180:183], a[116:119], v[40:43]
  v_exp_f32 v34, v34
  v_mfma_f32_16x16x32_bf16 v[40:43], a[184:187], a[136:139], v[40:43]
  buffer_load_dwordx4 v1, s[16:19], s34 offen nt lds
  v_fma_f32 v37, v37, s32, v92
  v_mfma_f32_16x16x32_bf16 v[40:43], a[188:191], a[156:159], v[40:43]
  s_waitcnt lgkmcnt(5)
  s_add_u32 m0, s29, 146976
  v_exp_f32 v33, v33
  v_mfma_f32_16x16x32_bf16 v[96:99], v[64:67], a[192:195], v[96:99]
  v_exp_f32 v32, v32
  v_mfma_f32_16x16x32_bf16 v[100:103], v[68:71], a[192:195], v[100:103]
  v_exp_f32 v35, v35
  v_mfma_f32_16x16x32_bf16 v[104:107], v[72:75], a[192:195], v[104:107]
  s_waitcnt lgkmcnt(2)
  ds_read_b64_tr_b16 a[204:205], v5 offset:96
  v_cvt_pk_bf16_f32 v53, v34, v35
  v_mfma_f32_16x16x32_bf16 v[108:111], v[76:79], a[192:195], v[108:111]
  ds_read_b64_tr_b16 a[206:207], v6 offset:96
  v_cvt_pk_bf16_f32 v52, v32, v33
  v_mfma_f32_16x16x32_bf16 v[112:115], v[80:83], a[192:195], v[112:115]
  ds_write_b64 v7, v[52:53] offset:11264
  v_mfma_f32_16x16x32_bf16 v[132:135], v[80:83], a[196:199], v[132:135]
  ds_read_b64_tr_b16 a[210:211], v6 offset:128
  v_fma_f32 v38, v38, s32, v92
  v_mfma_f32_16x16x32_bf16 v[128:131], v[76:79], a[196:199], v[128:131]
  ds_read_b64_tr_b16 a[208:209], v5 offset:128
  v_fma_f32 v39, v39, s32, v92
  v_mfma_f32_16x16x32_bf16 v[124:127], v[72:75], a[196:199], v[124:127]
  buffer_load_dwordx4 v1, s[16:19], s34 offen offset:1024 nt lds
  v_fma_f32 v40, v40, s32, v93
  v_mfma_f32_16x16x32_bf16 v[120:123], v[68:71], a[196:199], v[120:123]
  s_add_u32 m0, s29, 147008
  v_exp_f32 v36, v36
  v_mfma_f32_16x16x32_bf16 v[116:119], v[64:67], a[196:199], v[116:119]
  s_waitcnt lgkmcnt(5)
  v_exp_f32 v39, v39
  v_mfma_f32_16x16x32_bf16 v[136:139], v[64:67], a[200:203], v[136:139]
  v_exp_f32 v38, v38
  v_mfma_f32_16x16x32_bf16 v[140:143], v[68:71], a[200:203], v[140:143]
  ds_read_b64_tr_b16 a[214:215], v6 offset:160
  v_cvt_pk_bf16_f32 v57, v38, v39
  v_mfma_f32_16x16x32_bf16 v[144:147], v[72:75], a[200:203], v[144:147]
  v_exp_f32 v37, v37
  v_mfma_f32_16x16x32_bf16 v[148:151], v[76:79], a[200:203], v[148:151]
  ds_read_b64_tr_b16 a[212:213], v5 offset:160
  v_cvt_pk_bf16_f32 v56, v36, v37
  v_mfma_f32_16x16x32_bf16 v[152:155], v[80:83], a[200:203], v[152:155]
  s_waitcnt lgkmcnt(2)
  ds_write_b64 v7, v[56:57] offset:11776
  v_mfma_f32_16x16x32_bf16 v[172:175], v[80:83], a[204:207], v[172:175]
  ds_read_b64_tr_b16 a[216:217], v5 offset:192
  v_fma_f32 v43, v43, s32, v93
  v_mfma_f32_16x16x32_bf16 v[168:171], v[76:79], a[204:207], v[168:171]
  buffer_load_dwordx4 v1, s[16:19], s34 offen offset:2048 nt lds
  v_fma_f32 v42, v42, s32, v93
  v_mfma_f32_16x16x32_bf16 v[164:167], v[72:75], a[204:207], v[164:167]
  s_add_u32 m0, s29, 147040
  ds_read_b64_tr_b16 a[218:219], v6 offset:192
  v_fma_f32 v41, v41, s32, v93
  v_mfma_f32_16x16x32_bf16 v[160:163], v[68:71], a[204:207], v[160:163]
  v_exp_f32 v40, v40
  v_mfma_f32_16x16x32_bf16 v[156:159], v[64:67], a[204:207], v[156:159]
  v_exp_f32 v42, v42
  v_mfma_f32_16x16x32_bf16 v[176:179], v[64:67], a[208:211], v[176:179]
  v_exp_f32 v41, v41
  v_mfma_f32_16x16x32_bf16 v[180:183], v[68:71], a[208:211], v[180:183]
  v_exp_f32 v43, v43
  v_mfma_f32_16x16x32_bf16 v[184:187], v[72:75], a[208:211], v[184:187]
  ds_read_b64_tr_b16 a[220:221], v5 offset:224
  v_cvt_pk_bf16_f32 v60, v40, v41
  v_mfma_f32_16x16x32_bf16 v[188:191], v[76:79], a[208:211], v[188:191]
  ds_read_b64_tr_b16 a[222:223], v6 offset:224
  v_cvt_pk_bf16_f32 v61, v42, v43
  v_mfma_f32_16x16x32_bf16 v[192:195], v[80:83], a[208:211], v[192:195]
  s_waitcnt lgkmcnt(3)
  ds_write_b64 v7, v[60:61] offset:12288
  v_mfma_f32_16x16x32_bf16 v[212:215], v[80:83], a[212:215], v[212:215]
  buffer_load_dwordx4 v1, s[16:19], s34 offen offset:3072 nt lds
  v_add_f32 v84, v84, v24
  v_mfma_f32_16x16x32_bf16 v[208:211], v[76:79], a[212:215], v[208:211]
  s_add_u32 m0, s29, 50688
  ds_read_b128 a[160:163], v4 offset:50688
  v_add_f32 v84, v84, v25
  v_mfma_f32_16x16x32_bf16 v[204:207], v[72:75], a[212:215], v[204:207]
  s_mov_b32 s34, 81920
  ds_read_b128 a[176:179], v4 offset:50944
  v_add_f32 v84, v84, v26
  v_mfma_f32_16x16x32_bf16 v[200:203], v[68:71], a[212:215], v[200:203]
  ds_read_b128 a[184:187], v4 offset:51072
  v_add_f32 v84, v84, v27
  v_mfma_f32_16x16x32_bf16 v[196:199], v[64:67], a[212:215], v[196:199]
  s_waitcnt lgkmcnt(6)
  ds_read_b128 a[168:171], v4 offset:50816
  v_add_f32 v85, v85, v28
  v_mfma_f32_16x16x32_bf16 v[216:219], v[64:67], a[216:219], v[216:219]
  ds_read_b128 a[164:167], v4 offset:50752
  v_add_f32 v85, v85, v29
  v_mfma_f32_16x16x32_bf16 v[220:223], v[68:71], a[216:219], v[220:223]
  ds_read_b128 a[188:191], v4 offset:51136
  v_add_f32 v85, v85, v30
  v_mfma_f32_16x16x32_bf16 v[224:227], v[72:75], a[216:219], v[224:227]
  ds_read_b128 a[180:183], v4 offset:51008
  v_add_f32 v85, v85, v31
  v_mfma_f32_16x16x32_bf16 v[228:231], v[76:79], a[216:219], v[228:231]
  ds_read_b128 a[172:175], v4 offset:50880
  v_add_f32 v86, v86, v32
  v_mfma_f32_16x16x32_bf16 v[232:235], v[80:83], a[216:219], v[232:235]
  s_waitcnt lgkmcnt(7)
  v_add_f32 v86, v86, v33
  v_add_f32 v86, v86, v34
  v_mfma_f32_16x16x32_bf16 v[252:255], v[80:83], a[220:223], v[252:255]
  v_add_f32 v86, v86, v35
  v_add_f32 v87, v87, v36
  v_mfma_f32_16x16x32_bf16 v[248:251], v[76:79], a[220:223], v[248:251]
  v_add_f32 v87, v87, v37
  v_add_f32 v87, v87, v38
  v_mfma_f32_16x16x32_bf16 v[244:247], v[72:75], a[220:223], v[244:247]
  v_add_f32 v87, v87, v39
  v_add_f32 v88, v88, v40
  v_mfma_f32_16x16x32_bf16 v[240:243], v[68:71], a[220:223], v[240:243]
  v_add_f32 v88, v88, v41
  v_add_f32 v88, v88, v42
  v_mfma_f32_16x16x32_bf16 v[236:239], v[64:67], a[220:223], v[236:239]
  v_add_f32 v88, v88, v43
  s_waitcnt vmcnt(6) lgkmcnt(0)
  v_mfma_f32_16x16x32_bf16 v[24:27], a[160:163], a[0:3], 0
  s_barrier
  ds_read_b64 v[46:47], v8 offset:10240
  v_mfma_f32_16x16x32_bf16 v[24:27], a[164:167], a[20:23], v[24:27]
  ds_read_b64_tr_b16 a[192:193], v5 offset:16896
  v_mfma_f32_16x16x32_bf16 v[24:27], a[168:171], a[40:43], v[24:27]
  buffer_load_dwordx4 v1, s[12:15], s33 offen nt lds
  s_add_u32 m0, s29, 50720
  v_mfma_f32_16x16x32_bf16 v[24:27], a[172:175], a[60:63], v[24:27]
  ds_read_b64 v[50:51], v8 offset:10752
  v_mfma_f32_16x16x32_bf16 v[24:27], a[176:179], a[80:83], v[24:27]
  ds_read_b64_tr_b16 a[194:195], v6 offset:16896
  v_mfma_f32_16x16x32_bf16 v[24:27], a[180:183], a[100:103], v[24:27]
  ds_read_b64 v[58:59], v8 offset:11776
  v_mfma_f32_16x16x32_bf16 v[24:27], a[184:187], a[120:123], v[24:27]
  ds_read_b64 v[54:55], v8 offset:11264
  v_mfma_f32_16x16x32_bf16 v[24:27], a[188:191], a[140:143], v[24:27]
  ds_read_b64 v[62:63], v8 offset:12288
  v_mfma_f32_16x16x32_bf16 v[28:31], a[188:191], a[144:147], 0
  ds_read_b64_tr_b16 a[196:197], v5 offset:16928
  v_mfma_f32_16x16x32_bf16 v[28:31], a[184:187], a[124:127], v[28:31]
  ds_read_b64_tr_b16 a[198:199], v6 offset:16928
  v_mfma_f32_16x16x32_bf16 v[28:31], a[180:183], a[104:107], v[28:31]
  ds_read_b64_tr_b16 a[202:203], v6 offset:16960
  v_mfma_f32_16x16x32_bf16 v[28:31], a[176:179], a[84:87], v[28:31]
  buffer_load_dwordx4 v1, s[12:15], s33 offen offset:1024 nt lds
  v_fma_f32 v25, v25, s32, v89
  v_mfma_f32_16x16x32_bf16 v[28:31], a[172:175], a[64:67], v[28:31]
  s_add_u32 m0, s29, 50752
  v_exp_f32 v25, v25
  v_mfma_f32_16x16x32_bf16 v[28:31], a[168:171], a[44:47], v[28:31]
  ds_read_b64_tr_b16 a[200:201], v5 offset:16960
  v_fma_f32 v24, v24, s32, v89
  v_mfma_f32_16x16x32_bf16 v[28:31], a[164:167], a[24:27], v[28:31]
  v_exp_f32 v24, v24
  v_mfma_f32_16x16x32_bf16 v[28:31], a[160:163], a[4:7], v[28:31]
  ds_read_b64_tr_b16 a[206:207], v6 offset:16992
  v_fma_f32 v27, v27, s32, v89
  v_mfma_f32_16x16x32_bf16 v[32:35], a[160:163], a[8:11], 0
  v_exp_f32 v27, v27
  v_mfma_f32_16x16x32_bf16 v[32:35], a[164:167], a[28:31], v[32:35]
  ds_read_b64_tr_b16 a[204:205], v5 offset:16992
  v_cvt_pk_bf16_f32 v64, v24, v25
  v_mfma_f32_16x16x32_bf16 v[32:35], a[168:171], a[48:51], v[32:35]
  ds_read_b64_tr_b16 a[210:211], v6 offset:17024
  v_fma_f32 v26, v26, s32, v89
  v_mfma_f32_16x16x32_bf16 v[32:35], a[172:175], a[68:71], v[32:35]
  v_exp_f32 v26, v26
  v_mfma_f32_16x16x32_bf16 v[32:35], a[176:179], a[88:91], v[32:35]
  buffer_load_dwordx4 v1, s[12:15], s33 offen offset:2048 nt lds
  v_cvt_pk_bf16_f32 v65, v26, v27
  v_mfma_f32_16x16x32_bf16 v[32:35], a[180:183], a[108:111], v[32:35]
  s_add_u32 m0, s29, 50784
  ds_write_b64 v7, v[64:65] offset:0
  v_mfma_f32_16x16x32_bf16 v[32:35], a[184:187], a[128:131], v[32:35]
  ds_read_b64_tr_b16 a[208:209], v5 offset:17024
  v_fma_f32 v31, v31, s32, v90
  v_mfma_f32_16x16x32_bf16 v[32:35], a[188:191], a[148:151], v[32:35]
  v_exp_f32 v31, v31
  v_mfma_f32_16x16x32_bf16 v[36:39], a[188:191], a[152:155], 0
  ds_read_b64_tr_b16 a[214:215], v6 offset:17056
  v_fma_f32 v28, v28, s32, v90
  v_mfma_f32_16x16x32_bf16 v[36:39], a[184:187], a[132:135], v[36:39]
  v_exp_f32 v28, v28
  v_mfma_f32_16x16x32_bf16 v[36:39], a[180:183], a[112:115], v[36:39]
  ds_read_b64_tr_b16 a[212:213], v5 offset:17056
  v_fma_f32 v29, v29, s32, v90
  v_mfma_f32_16x16x32_bf16 v[36:39], a[176:179], a[92:95], v[36:39]
  v_exp_f32 v29, v29
  v_mfma_f32_16x16x32_bf16 v[36:39], a[172:175], a[72:75], v[36:39]
  ds_read_b64_tr_b16 a[216:217], v5 offset:17088
  v_cvt_pk_bf16_f32 v68, v28, v29
  v_mfma_f32_16x16x32_bf16 v[36:39], a[168:171], a[52:55], v[36:39]
  buffer_load_dwordx4 v1, s[12:15], s33 offen offset:3072 nt lds
  v_fma_f32 v30, v30, s32, v90
  v_mfma_f32_16x16x32_bf16 v[36:39], a[164:167], a[32:35], v[36:39]
  s_add_u32 m0, s29, 96256
  v_exp_f32 v30, v30
  v_mfma_f32_16x16x32_bf16 v[36:39], a[160:163], a[12:15], v[36:39]
  ds_read_b64_tr_b16 a[218:219], v6 offset:17088
  v_cvt_pk_bf16_f32 v69, v30, v31
  v_mfma_f32_16x16x32_bf16 v[40:43], a[160:163], a[16:19], 0
  ds_write_b64 v7, v[68:69] offset:512
  v_mfma_f32_16x16x32_bf16 v[40:43], a[164:167], a[36:39], v[40:43]
  ds_read_b64_tr_b16 a[220:221], v5 offset:17120
  v_fma_f32 v34, v34, s32, v91
  v_mfma_f32_16x16x32_bf16 v[40:43], a[168:171], a[56:59], v[40:43]
  ds_read_b64_tr_b16 a[222:223], v6 offset:17120
  v_fma_f32 v35, v35, s32, v91
  v_mfma_f32_16x16x32_bf16 v[40:43], a[172:175], a[76:79], v[40:43]
  v_exp_f32 v34, v34
  v_mfma_f32_16x16x32_bf16 v[40:43], a[176:179], a[96:99], v[40:43]
  ds_read_b128 a[164:167], v4 offset:64
  v_fma_f32 v33, v33, s32, v91
  v_mfma_f32_16x16x32_bf16 v[40:43], a[180:183], a[116:119], v[40:43]
  ds_read_b128 a[176:179], v4 offset:256
  v_fma_f32 v32, v32, s32, v91
  v_mfma_f32_16x16x32_bf16 v[40:43], a[184:187], a[136:139], v[40:43]
  buffer_load_dwordx4 v1, s[16:19], s34 offen nt lds
  v_fma_f32 v37, v37, s32, v92
  v_mfma_f32_16x16x32_bf16 v[40:43], a[188:191], a[156:159], v[40:43]
  s_waitcnt lgkmcnt(5)
  s_add_u32 m0, s29, 96288
  v_exp_f32 v32, v32
  v_mfma_f32_16x16x32_bf16 v[96:99], v[44:47], a[192:195], v[96:99]
  v_exp_f32 v35, v35
  v_mfma_f32_16x16x32_bf16 v[100:103], v[48:51], a[192:195], v[100:103]
  v_exp_f32 v33, v33
  v_mfma_f32_16x16x32_bf16 v[104:107], v[52:55], a[192:195], v[104:107]
  ds_read_b128 a[188:191], v4 offset:448
  v_cvt_pk_bf16_f32 v73, v34, v35
  v_mfma_f32_16x16x32_bf16 v[108:111], v[56:59], a[192:195], v[108:111]
  ds_read_b128 a[180:183], v4 offset:320
  v_cvt_pk_bf16_f32 v72, v32, v33
  v_mfma_f32_16x16x32_bf16 v[112:115], v[60:63], a[192:195], v[112:115]
  ds_write_b64 v7, v[72:73] offset:1024
  v_mfma_f32_16x16x32_bf16 v[132:135], v[60:63], a[196:199], v[132:135]
  v_exp_f32 v37, v37
  v_mfma_f32_16x16x32_bf16 v[128:131], v[56:59], a[196:199], v[128:131]
  ds_read_b128 a[168:171], v4 offset:128
  v_fma_f32 v36, v36, s32, v92
  v_mfma_f32_16x16x32_bf16 v[124:127], v[52:55], a[196:199], v[124:127]
  buffer_load_dwordx4 v1, s[16:19], s34 offen offset:1024 nt lds
  v_fma_f32 v39, v39, s32, v92
  v_mfma_f32_16x16x32_bf16 v[120:123], v[48:51], a[196:199], v[120:123]
  s_add_u32 m0, s29, 96320
  v_exp_f32 v39, v39
  v_mfma_f32_16x16x32_bf16 v[116:119], v[44:47], a[196:199], v[116:119]
  v_exp_f32 v36, v36
  v_mfma_f32_16x16x32_bf16 v[136:139], v[44:47], a[200:203], v[136:139]
  ds_read_b128 a[172:175], v4 offset:192
  v_cvt_pk_bf16_f32 v76, v36, v37
  v_mfma_f32_16x16x32_bf16 v[140:143], v[48:51], a[200:203], v[140:143]
  ds_read_b128 a[184:187], v4 offset:384
  v_fma_f32 v38, v38, s32, v92
  v_mfma_f32_16x16x32_bf16 v[144:147], v[52:55], a[200:203], v[144:147]
  v_exp_f32 v38, v38
  v_mfma_f32_16x16x32_bf16 v[148:151], v[56:59], a[200:203], v[148:151]
  ds_read_b128 a[160:163], v4 offset:0
  v_cvt_pk_bf16_f32 v77, v38, v39
  v_mfma_f32_16x16x32_bf16 v[152:155], v[60:63], a[200:203], v[152:155]
  ds_write_b64 v7, v[76:77] offset:1536
  v_mfma_f32_16x16x32_bf16 v[172:175], v[60:63], a[204:207], v[172:175]
  v_fma_f32 v43, v43, s32, v93
  v_fma_f32 v42, v42, s32, v93
  v_mfma_f32_16x16x32_bf16 v[168:171], v[56:59], a[204:207], v[168:171]
  buffer_load_dwordx4 v1, s[16:19], s34 offen offset:2048 nt lds
  v_fma_f32 v40, v40, s32, v93
  v_mfma_f32_16x16x32_bf16 v[164:167], v[52:55], a[204:207], v[164:167]
  s_add_u32 m0, s29, 96352
  v_exp_f32 v43, v43
  v_mfma_f32_16x16x32_bf16 v[160:163], v[48:51], a[204:207], v[160:163]
  v_exp_f32 v42, v42
  v_mfma_f32_16x16x32_bf16 v[156:159], v[44:47], a[204:207], v[156:159]
  v_exp_f32 v40, v40
  v_mfma_f32_16x16x32_bf16 v[176:179], v[44:47], a[208:211], v[176:179]
  v_fma_f32 v41, v41, s32, v93
  v_cvt_pk_bf16_f32 v81, v42, v43
  v_mfma_f32_16x16x32_bf16 v[180:183], v[48:51], a[208:211], v[180:183]
  v_exp_f32 v41, v41
  v_mfma_f32_16x16x32_bf16 v[184:187], v[52:55], a[208:211], v[184:187]
  v_cvt_pk_bf16_f32 v80, v40, v41
  v_add_f32 v84, v84, v24
  v_mfma_f32_16x16x32_bf16 v[188:191], v[56:59], a[208:211], v[188:191]
  ds_write_b64 v7, v[80:81] offset:2048
  v_mfma_f32_16x16x32_bf16 v[192:195], v[60:63], a[208:211], v[192:195]
  v_add_f32 v86, v86, v32
  v_add_f32 v88, v88, v40
  v_mfma_f32_16x16x32_bf16 v[212:215], v[60:63], a[212:215], v[212:215]
  buffer_load_dwordx4 v1, s[16:19], s34 offen offset:3072 nt lds
  v_add_f32 v86, v86, v33
  v_mfma_f32_16x16x32_bf16 v[208:211], v[56:59], a[212:215], v[208:211]
  v_add_f32 v87, v87, v36
  v_add_f32 v84, v84, v25
  v_mfma_f32_16x16x32_bf16 v[204:207], v[52:55], a[212:215], v[204:207]
  v_add_f32 v84, v84, v26
  v_add_f32 v85, v85, v28
  v_mfma_f32_16x16x32_bf16 v[200:203], v[48:51], a[212:215], v[200:203]
  v_add_f32 v85, v85, v29
  v_add_f32 v85, v85, v30
  v_mfma_f32_16x16x32_bf16 v[196:199], v[44:47], a[212:215], v[196:199]
  v_add_f32 v85, v85, v31
  v_add_f32 v88, v88, v41
  v_mfma_f32_16x16x32_bf16 v[216:219], v[44:47], a[216:219], v[216:219]
  v_add_f32 v87, v87, v37
  v_add_f32 v87, v87, v38
  v_mfma_f32_16x16x32_bf16 v[220:223], v[48:51], a[216:219], v[220:223]
  v_add_f32 v84, v84, v27
  v_add_f32 v86, v86, v34
  v_mfma_f32_16x16x32_bf16 v[224:227], v[52:55], a[216:219], v[224:227]
  v_add_f32 v86, v86, v35
  v_add_f32 v88, v88, v42
  v_mfma_f32_16x16x32_bf16 v[228:231], v[56:59], a[216:219], v[228:231]
  v_add_f32 v88, v88, v43
  v_add_f32 v87, v87, v39
  v_mfma_f32_16x16x32_bf16 v[232:235], v[60:63], a[216:219], v[232:235]
  s_waitcnt lgkmcnt(0)
  v_mfma_f32_16x16x32_bf16 v[252:255], v[60:63], a[220:223], v[252:255]
  s_waitcnt vmcnt(6) lgkmcnt(0)
  s_barrier
  v_mfma_f32_16x16x32_bf16 v[248:251], v[56:59], a[220:223], v[248:251]
  v_mfma_f32_16x16x32_bf16 v[244:247], v[52:55], a[220:223], v[244:247]
  v_mfma_f32_16x16x32_bf16 v[240:243], v[48:51], a[220:223], v[240:243]
  v_mfma_f32_16x16x32_bf16 v[236:239], v[44:47], a[220:223], v[236:239]
L_preloop:
  s_mov_b32 s37, 6
L_loop0:
  v_mfma_f32_16x16x32_bf16 v[24:27], a[160:163], a[0:3], 0
  s_add_u32 s33, s33, 16384
  global_load_dword v13, v12, s[40:41]
  s_add_u32 m0, s29, 0
  v_mfma_f32_16x16x32_bf16 v[24:27], a[164:167], a[20:23], v[24:27]
  s_add_u32 s34, s34, 16384
  ds_read_b64_tr_b16 a[192:193], v5 offset:33792
  s_sub_u32 s37, s37, 1
  v_mfma_f32_16x16x32_bf16 v[24:27], a[168:171], a[40:43], v[24:27]
  ds_read_b64_tr_b16 a[194:195], v6 offset:33792
  v_mfma_f32_16x16x32_bf16 v[24:27], a[172:175], a[60:63], v[24:27]
  ds_read_b64 v[66:67], v8 offset:0
  v_mfma_f32_16x16x32_bf16 v[24:27], a[176:179], a[80:83], v[24:27]
  buffer_load_dwordx4 v1, s[12:15], s33 offen nt lds
  s_add_u32 m0, s29, 32
  v_mfma_f32_16x16x32_bf16 v[24:27], a[180:183], a[100:103], v[24:27]
  ds_read_b64 v[70:71], v8 offset:512
  v_mfma_f32_16x16x32_bf16 v[24:27], a[184:187], a[120:123], v[24:27]
  ds_read_b64 v[74:75], v8 offset:1024
  v_mfma_f32_16x16x32_bf16 v[24:27], a[188:191], a[140:143], v[24:27]
  ds_read_b64 v[78:79], v8 offset:1536
  v_mfma_f32_16x16x32_bf16 v[28:31], a[188:191], a[144:147], 0
  ds_read_b64 v[82:83], v8 offset:2048
  v_mfma_f32_16x16x32_bf16 v[28:31], a[184:187], a[124:127], v[28:31]
  ds_read_b64_tr_b16 a[196:197], v5 offset:33824
  v_mfma_f32_16x16x32_bf16 v[28:31], a[180:183], a[104:107], v[28:31]
  ds_read_b64_tr_b16 a[198:199], v6 offset:33824
  v_mfma_f32_16x16x32_bf16 v[28:31], a[176:179], a[84:87], v[28:31]
  buffer_load_dwordx4 v1, s[12:15], s33 offen offset:1024 nt lds
  v_fma_f32 v24, v24, s32, v89
  v_mfma_f32_16x16x32_bf16 v[28:31], a[172:175], a[64:67], v[28:31]
  s_add_u32 m0, s29, 64
  ds_read_b64_tr_b16 a[200:201], v5 offset:33856
  v_fma_f32 v25, v25, s32, v89
  v_mfma_f32_16x16x32_bf16 v[28:31], a[168:171], a[44:47], v[28:31]
  ds_read_b64_tr_b16 a[202:203], v6 offset:33856
  v_fma_f32 v26, v26, s32, v89
  v_mfma_f32_16x16x32_bf16 v[28:31], a[164:167], a[24:27], v[28:31]
  ds_read_b64_tr_b16 a[204:205], v5 offset:33888
  v_fma_f32 v27, v27, s32, v89
  v_mfma_f32_16x16x32_bf16 v[28:31], a[160:163], a[4:7], v[28:31]
  v_exp_f32 v24, v24
  v_mfma_f32_16x16x32_bf16 v[32:35], a[160:163], a[8:11], 0
  v_exp_f32 v25, v25
  v_mfma_f32_16x16x32_bf16 v[32:35], a[164:167], a[28:31], v[32:35]
  v_exp_f32 v26, v26
  v_mfma_f32_16x16x32_bf16 v[32:35], a[168:171], a[48:51], v[32:35]
  v_exp_f32 v27, v27
  v_mfma_f32_16x16x32_bf16 v[32:35], a[172:175], a[68:71], v[32:35]
  ds_read_b64_tr_b16 a[206:207], v6 offset:33888
  v_cvt_pk_bf16_f32 v44, v24, v25
  v_mfma_f32_16x16x32_bf16 v[32:35], a[176:179], a[88:91], v[32:35]
  buffer_load_dwordx4 v1, s[12:15], s33 offen offset:2048 nt lds
  v_cvt_pk_bf16_f32 v45, v26, v27
  v_mfma_f32_16x16x32_bf16 v[32:35], a[180:183], a[108:111], v[32:35]
  s_add_u32 m0, s29, 96
  ds_write_b64 v7, v[44:45] offset:10240
  v_mfma_f32_16x16x32_bf16 v[32:35], a[184:187], a[128:131], v[32:35]
  ds_read_b64_tr_b16 a[208:209], v5 offset:33920
  v_fma_f32 v28, v28, s32, v90
  v_mfma_f32_16x16x32_bf16 v[32:35], a[188:191], a[148:151], v[32:35]
  ds_read_b64_tr_b16 a[210:211], v6 offset:33920
  v_fma_f32 v29, v29, s32, v90
  v_mfma_f32_16x16x32_bf16 v[36:39], a[188:191], a[152:155], 0
  ds_read_b64_tr_b16 a[212:213], v5 offset:33952
  v_fma_f32 v30, v30, s32, v90
  v_mfma_f32_16x16x32_bf16 v[36:39], a[184:187], a[132:135], v[36:39]
  ds_read_b64_tr_b16 a[214:215], v6 offset:33952
  v_fma_f32 v31, v31, s32, v90
  v_mfma_f32_16x16x32_bf16 v[36:39], a[180:183], a[112:115], v[36:39]
  v_exp_f32 v28, v28
  v_mfma_f32_16x16x32_bf16 v[36:39], a[176:179], a[92:95], v[36:39]
  v_exp_f32 v29, v29
  v_mfma_f32_16x16x32_bf16 v[36:39], a[172:175], a[72:75], v[36:39]
  v_exp_f32 v30, v30
  v_mfma_f32_16x16x32_bf16 v[36:39], a[168:171], a[52:55], v[36:39]
  buffer_load_dwordx4 v1, s[12:15], s33 offen offset:3072 nt lds
  v_cvt_pk_bf16_f32 v48, v28, v29
  v_mfma_f32_16x16x32_bf16 v[36:39], a[164:167], a[32:35], v[36:39]
  s_add_u32 m0, s29, 113152
  v_exp_f32 v31, v31
  v_mfma_f32_16x16x32_bf16 v[36:39], a[160:163], a[12:15], v[36:39]
  s_add_u32 s33, s33, 16384
  ds_read_b64_tr_b16 a[216:217], v5 offset:33984
  v_cvt_pk_bf16_f32 v49, v30, v31
  v_mfma_f32_16x16x32_bf16 v[40:43], a[160:163], a[16:19], 0
  ds_write_b64 v7, v[48:49] offset:10752
  v_mfma_f32_16x16x32_bf16 v[40:43], a[164:167], a[36:39], v[40:43]
  ds_read_b64_tr_b16 a[218:219], v6 offset:33984
  v_fma_f32 v32, v32, s32, v91
  v_mfma_f32_16x16x32_bf16 v[40:43], a[168:171], a[56:59], v[40:43]
  ds_read_b64_tr_b16 a[220:221], v5 offset:34016
  v_fma_f32 v33, v33, s32, v91
  v_mfma_f32_16x16x32_bf16 v[40:43], a[172:175], a[76:79], v[40:43]
  ds_read_b64_tr_b16 a[222:223], v6 offset:34016
  v_fma_f32 v34, v34, s32, v91
  v_mfma_f32_16x16x32_bf16 v[40:43], a[176:179], a[96:99], v[40:43]
  ds_read_b128 a[160:163], v4 offset:16896
  v_fma_f32 v35, v35, s32, v91
  v_mfma_f32_16x16x32_bf16 v[40:43], a[180:183], a[116:119], v[40:43]
  v_exp_f32 v32, v32
  v_mfma_f32_16x16x32_bf16 v[40:43], a[184:187], a[136:139], v[40:43]
  buffer_load_dwordx4 v1, s[16:19], s34 offen nt lds
  v_fma_f32 v36, v36, s32, v92
  v_mfma_f32_16x16x32_bf16 v[40:43], a[188:191], a[156:159], v[40:43]
  s_waitcnt lgkmcnt(5)
  s_add_u32 m0, s29, 113184
  v_exp_f32 v33, v33
  v_mfma_f32_16x16x32_bf16 v[96:99], v[64:67], a[192:195], v[96:99]
  v_exp_f32 v34, v34
  v_mfma_f32_16x16x32_bf16 v[100:103], v[68:71], a[192:195], v[100:103]
  v_exp_f32 v35, v35
  v_mfma_f32_16x16x32_bf16 v[104:107], v[72:75], a[192:195], v[104:107]
  ds_read_b128 a[164:167], v4 offset:16960
  v_cvt_pk_bf16_f32 v52, v32, v33
  v_mfma_f32_16x16x32_bf16 v[108:111], v[76:79], a[192:195], v[108:111]
  ds_read_b128 a[168:171], v4 offset:17024
  v_cvt_pk_bf16_f32 v53, v34, v35
  v_mfma_f32_16x16x32_bf16 v[112:115], v[80:83], a[192:195], v[112:115]
  ds_write_b64 v7, v[52:53] offset:11264
  v_mfma_f32_16x16x32_bf16 v[132:135], v[80:83], a[196:199], v[132:135]
  ds_read_b128 a[172:175], v4 offset:17088
  v_fma_f32 v37, v37, s32, v92
  v_mfma_f32_16x16x32_bf16 v[128:131], v[76:79], a[196:199], v[128:131]
  ds_read_b128 a[176:179], v4 offset:17152
  v_fma_f32 v38, v38, s32, v92
  v_mfma_f32_16x16x32_bf16 v[124:127], v[72:75], a[196:199], v[124:127]
  buffer_load_dwordx4 v1, s[16:19], s34 offen offset:1024 nt lds
  v_fma_f32 v39, v39, s32, v92
  v_mfma_f32_16x16x32_bf16 v[120:123], v[68:71], a[196:199], v[120:123]
  s_add_u32 m0, s29, 113216
  v_exp_f32 v36, v36
  v_mfma_f32_16x16x32_bf16 v[116:119], v[64:67], a[196:199], v[116:119]
  v_exp_f32 v37, v37
  v_mfma_f32_16x16x32_bf16 v[136:139], v[64:67], a[200:203], v[136:139]
  v_exp_f32 v38, v38
  v_mfma_f32_16x16x32_bf16 v[140:143], v[68:71], a[200:203], v[140:143]
  v_exp_f32 v39, v39
  v_mfma_f32_16x16x32_bf16 v[144:147], v[72:75], a[200:203], v[144:147]
  ds_read_b128 a[180:183], v4 offset:17216
  v_cvt_pk_bf16_f32 v56, v36, v37
  v_mfma_f32_16x16x32_bf16 v[148:151], v[76:79], a[200:203], v[148:151]
  ds_read_b128 a[184:187], v4 offset:17280
  v_cvt_pk_bf16_f32 v57, v38, v39
  v_mfma_f32_16x16x32_bf16 v[152:155], v[80:83], a[200:203], v[152:155]
  ds_write_b64 v7, v[56:57] offset:11776
  v_mfma_f32_16x16x32_bf16 v[172:175], v[80:83], a[204:207], v[172:175]
  ds_read_b128 a[188:191], v4 offset:17344
  v_fma_f32 v40, v40, s32, v93
  v_mfma_f32_16x16x32_bf16 v[168:171], v[76:79], a[204:207], v[168:171]
  buffer_load_dwordx4 v1, s[16:19], s34 offen offset:2048 nt lds
  v_fma_f32 v41, v41, s32, v93
  v_mfma_f32_16x16x32_bf16 v[164:167], v[72:75], a[204:207], v[164:167]
  s_add_u32 m0, s29, 113248
  v_fma_f32 v42, v42, s32, v93
  v_fma_f32 v43, v43, s32, v93
  v_mfma_f32_16x16x32_bf16 v[160:163], v[68:71], a[204:207], v[160:163]
  v_exp_f32 v40, v40
  v_mfma_f32_16x16x32_bf16 v[156:159], v[64:67], a[204:207], v[156:159]
  v_exp_f32 v41, v41
  v_mfma_f32_16x16x32_bf16 v[176:179], v[64:67], a[208:211], v[176:179]
  v_exp_f32 v42, v42
  v_mfma_f32_16x16x32_bf16 v[180:183], v[68:71], a[208:211], v[180:183]
  v_exp_f32 v43, v43
  v_mfma_f32_16x16x32_bf16 v[184:187], v[72:75], a[208:211], v[184:187]
  v_cvt_pk_bf16_f32 v60, v40, v41
  v_cvt_pk_bf16_f32 v61, v42, v43
  v_mfma_f32_16x16x32_bf16 v[188:191], v[76:79], a[208:211], v[188:191]
  ds_write_b64 v7, v[60:61] offset:12288
  v_mfma_f32_16x16x32_bf16 v[192:195], v[80:83], a[208:211], v[192:195]
  v_add_f32 v84, v84, v24
  v_add_f32 v84, v84, v25
  v_mfma_f32_16x16x32_bf16 v[212:215], v[80:83], a[212:215], v[212:215]
  buffer_load_dwordx4 v1, s[16:19], s34 offen offset:3072 nt lds
  v_add_f32 v84, v84, v26
  v_mfma_f32_16x16x32_bf16 v[208:211], v[76:79], a[212:215], v[208:211]
  s_add_u32 m0, s29, 16896
  v_add_f32 v84, v84, v27
  v_add_f32 v85, v85, v28
  v_mfma_f32_16x16x32_bf16 v[204:207], v[72:75], a[212:215], v[204:207]
  s_add_u32 s34, s34, 16384
  v_add_f32 v85, v85, v29
  v_add_f32 v85, v85, v30
  v_mfma_f32_16x16x32_bf16 v[200:203], v[68:71], a[212:215], v[200:203]
  v_add_f32 v85, v85, v31
  v_add_f32 v86, v86, v32
  v_mfma_f32_16x16x32_bf16 v[196:199], v[64:67], a[212:215], v[196:199]
  s_waitcnt lgkmcnt(1)
  v_add_f32 v86, v86, v33
  v_add_f32 v86, v86, v34
  v_mfma_f32_16x16x32_bf16 v[216:219], v[64:67], a[216:219], v[216:219]
  v_add_f32 v86, v86, v35
  v_add_f32 v87, v87, v36
  v_mfma_f32_16x16x32_bf16 v[220:223], v[68:71], a[216:219], v[220:223]
  v_add_f32 v87, v87, v37
  v_add_f32 v87, v87, v38
  v_mfma_f32_16x16x32_bf16 v[224:227], v[72:75], a[216:219], v[224:227]
  v_add_f32 v87, v87, v39
  v_add_f32 v88, v88, v40
  v_mfma_f32_16x16x32_bf16 v[228:231], v[76:79], a[216:219], v[228:231]
  v_add_f32 v88, v88, v41
  v_add_f32 v88, v88, v42
  v_mfma_f32_16x16x32_bf16 v[232:235], v[80:83], a[216:219], v[232:235]
  v_add_f32 v88, v88, v43
  v_mfma_f32_16x16x32_bf16 v[252:255], v[80:83], a[220:223], v[252:255]
  s_waitcnt vmcnt(5) lgkmcnt(0)
  s_barrier
  v_mfma_f32_16x16x32_bf16 v[248:251], v[76:79], a[220:223], v[248:251]
  ds_read_b64_tr_b16 a[192:193], v5 offset:50688
  v_mfma_f32_16x16x32_bf16 v[244:247], v[72:75], a[220:223], v[244:247]
  ds_read_b64_tr_b16 a[194:195], v6 offset:50688
  v_mfma_f32_16x16x32_bf16 v[240:243], v[68:71], a[220:223], v[240:243]
  ds_read_b64 v[46:47], v8 offset:10240
  v_mfma_f32_16x16x32_bf16 v[236:239], v[64:67], a[220:223], v[236:239]
  ds_read_b64 v[50:51], v8 offset:10752
  v_mfma_f32_16x16x32_bf16 v[24:27], a[160:163], a[0:3], 0
  ds_read_b64 v[54:55], v8 offset:11264
  v_mfma_f32_16x16x32_bf16 v[24:27], a[164:167], a[20:23], v[24:27]
  ds_read_b64 v[58:59], v8 offset:11776
  v_mfma_f32_16x16x32_bf16 v[24:27], a[168:171], a[40:43], v[24:27]
  buffer_load_dwordx4 v1, s[12:15], s33 offen nt lds
  s_add_u32 m0, s29, 16928
  v_mfma_f32_16x16x32_bf16 v[24:27], a[172:175], a[60:63], v[24:27]
  ds_read_b64 v[62:63], v8 offset:12288
  v_mfma_f32_16x16x32_bf16 v[24:27], a[176:179], a[80:83], v[24:27]
  ds_read_b64_tr_b16 a[196:197], v5 offset:50720
  v_mfma_f32_16x16x32_bf16 v[24:27], a[180:183], a[100:103], v[24:27]
  ds_read_b64_tr_b16 a[198:199], v6 offset:50720
  v_mfma_f32_16x16x32_bf16 v[24:27], a[184:187], a[120:123], v[24:27]
  ds_read_b64_tr_b16 a[200:201], v5 offset:50752
  v_mfma_f32_16x16x32_bf16 v[24:27], a[188:191], a[140:143], v[24:27]
  ds_read_b64_tr_b16 a[202:203], v6 offset:50752
  v_mfma_f32_16x16x32_bf16 v[28:31], a[188:191], a[144:147], 0
  ds_read_b64_tr_b16 a[204:205], v5 offset:50784
  v_mfma_f32_16x16x32_bf16 v[28:31], a[184:187], a[124:127], v[28:31]
  ds_read_b64_tr_b16 a[206:207], v6 offset:50784
  v_mfma_f32_16x16x32_bf16 v[28:31], a[180:183], a[104:107], v[28:31]
  ds_read_b64_tr_b16 a[208:209], v5 offset:50816
  v_mfma_f32_16x16x32_bf16 v[28:31], a[176:179], a[84:87], v[28:31]
  buffer_load_dwordx4 v1, s[12:15], s33 offen offset:1024 nt lds
  v_fma_f32 v24, v24, s32, v89
  v_mfma_f32_16x16x32_bf16 v[28:31], a[172:175], a[64:67], v[28:31]
  s_add_u32 m0, s29, 16960
  ds_read_b64_tr_b16 a[210:211], v6 offset:50816
  v_fma_f32 v25, v25, s32, v89
  v_mfma_f32_16x16x32_bf16 v[28:31], a[168:171], a[44:47], v[28:31]
  ds_read_b64_tr_b16 a[212:213], v5 offset:50848
  v_fma_f32 v26, v26, s32, v89
  v_mfma_f32_16x16x32_bf16 v[28:31], a[164:167], a[24:27], v[28:31]
  ds_read_b64_tr_b16 a[214:215], v6 offset:50848
  v_fma_f32 v27, v27, s32, v89
  v_mfma_f32_16x16x32_bf16 v[28:31], a[160:163], a[4:7], v[28:31]
  v_exp_f32 v24, v24
  v_mfma_f32_16x16x32_bf16 v[32:35], a[160:163], a[8:11], 0
  v_exp_f32 v25, v25
  v_mfma_f32_16x16x32_bf16 v[32:35], a[164:167], a[28:31], v[32:35]
  v_exp_f32 v26, v26
  v_mfma_f32_16x16x32_bf16 v[32:35], a[168:171], a[48:51], v[32:35]
  v_exp_f32 v27, v27
  v_mfma_f32_16x16x32_bf16 v[32:35], a[172:175], a[68:71], v[32:35]
  ds_read_b64_tr_b16 a[216:217], v5 offset:50880
  v_cvt_pk_bf16_f32 v64, v24, v25
  v_mfma_f32_16x16x32_bf16 v[32:35], a[176:179], a[88:91], v[32:35]
  buffer_load_dwordx4 v1, s[12:15], s33 offen offset:2048 nt lds
  v_cvt_pk_bf16_f32 v65, v26, v27
  v_mfma_f32_16x16x32_bf16 v[32:35], a[180:183], a[108:111], v[32:35]
  s_add_u32 m0, s29, 16992
  ds_write_b64 v7, v[64:65] offset:0
  v_mfma_f32_16x16x32_bf16 v[32:35], a[184:187], a[128:131], v[32:35]
  ds_read_b64_tr_b16 a[218:219], v6 offset:50880
  v_fma_f32 v28, v28, s32, v90
  v_mfma_f32_16x16x32_bf16 v[32:35], a[188:191], a[148:151], v[32:35]
  ds_read_b64_tr_b16 a[220:221], v5 offset:50912
  v_fma_f32 v29, v29, s32, v90
  v_mfma_f32_16x16x32_bf16 v[36:39], a[188:191], a[152:155], 0
  ds_read_b64_tr_b16 a[222:223], v6 offset:50912
  v_fma_f32 v30, v30, s32, v90
  v_mfma_f32_16x16x32_bf16 v[36:39], a[184:187], a[132:135], v[36:39]
  v_fma_f32 v31, v31, s32, v90
  v_add_f32 v84, v84, v24
  v_mfma_f32_16x16x32_bf16 v[36:39], a[180:183], a[112:115], v[36:39]
  v_exp_f32 v28, v28
  v_mfma_f32_16x16x32_bf16 v[36:39], a[176:179], a[92:95], v[36:39]
  v_exp_f32 v29, v29
  v_mfma_f32_16x16x32_bf16 v[36:39], a[172:175], a[72:75], v[36:39]
  v_exp_f32 v30, v30
  v_mfma_f32_16x16x32_bf16 v[36:39], a[168:171], a[52:55], v[36:39]
  buffer_load_dwordx4 v1, s[12:15], s33 offen offset:3072 nt lds
  v_cvt_pk_bf16_f32 v68, v28, v29
  v_mfma_f32_16x16x32_bf16 v[36:39], a[164:167], a[32:35], v[36:39]
  s_add_u32 m0, s29, 130048
  v_exp_f32 v31, v31
  v_mfma_f32_16x16x32_bf16 v[36:39], a[160:163], a[12:15], v[36:39]
  s_add_u32 s33, s33, 16384
  v_cvt_pk_bf16_f32 v69, v30, v31
  v_fma_f32 v32, v32, s32, v91
  v_mfma_f32_16x16x32_bf16 v[40:43], a[160:163], a[16:19], 0
  ds_write_b64 v7, v[68:69] offset:512
  v_mfma_f32_16x16x32_bf16 v[40:43], a[164:167], a[36:39], v[40:43]
  ds_read_b128 a[160:163], v4 offset:33792
  v_fma_f32 v33, v33, s32, v91
  v_mfma_f32_16x16x32_bf16 v[40:43], a[168:171], a[56:59], v[40:43]
  ds_read_b128 a[164:167], v4 offset:33856
  v_fma_f32 v34, v34, s32, v91
  v_mfma_f32_16x16x32_bf16 v[40:43], a[172:175], a[76:79], v[40:43]
  ds_read_b128 a[168:171], v4 offset:33920
  v_fma_f32 v35, v35, s32, v91
  v_mfma_f32_16x16x32_bf16 v[40:43], a[176:179], a[96:99], v[40:43]
  v_exp_f32 v32, v32
  v_mfma_f32_16x16x32_bf16 v[40:43], a[180:183], a[116:119], v[40:43]
  v_exp_f32 v33, v33
  v_mfma_f32_16x16x32_bf16 v[40:43], a[184:187], a[136:139], v[40:43]
  buffer_load_dwordx4 v1, s[16:19], s34 offen nt lds
  v_cvt_pk_bf16_f32 v72, v32, v33
  v_mfma_f32_16x16x32_bf16 v[40:43], a[188:191], a[156:159], v[40:43]
  s_waitcnt lgkmcnt(4)
  s_add_u32 m0, s29, 130080
  v_exp_f32 v34, v34
  v_mfma_f32_16x16x32_bf16 v[96:99], v[44:47], a[192:195], v[96:99]
  v_exp_f32 v35, v35
  v_mfma_f32_16x16x32_bf16 v[100:103], v[48:51], a[192:195], v[100:103]
  ds_read_b128 a[172:175], v4 offset:33984
  v_cvt_pk_bf16_f32 v73, v34, v35
  v_mfma_f32_16x16x32_bf16 v[104:107], v[52:55], a[192:195], v[104:107]
  ds_write_b64 v7, v[72:73] offset:1024
  v_mfma_f32_16x16x32_bf16 v[108:111], v[56:59], a[192:195], v[108:111]
  ds_read_b128 a[176:179], v4 offset:34048
  v_fma_f32 v36, v36, s32, v92
  v_mfma_f32_16x16x32_bf16 v[112:115], v[60:63], a[192:195], v[112:115]
  ds_read_b128 a[180:183], v4 offset:34112
  v_fma_f32 v37, v37, s32, v92
  v_mfma_f32_16x16x32_bf16 v[132:135], v[60:63], a[196:199], v[132:135]
  ds_read_b128 a[184:187], v4 offset:34176
  v_fma_f32 v38, v38, s32, v92
  v_mfma_f32_16x16x32_bf16 v[128:131], v[56:59], a[196:199], v[128:131]
  ds_read_b128 a[188:191], v4 offset:34240
  v_fma_f32 v39, v39, s32, v92
  v_mfma_f32_16x16x32_bf16 v[124:127], v[52:55], a[196:199], v[124:127]
  buffer_load_dwordx4 v1, s[16:19], s34 offen offset:1024 nt lds
  v_fma_f32 v40, v40, s32, v93
  v_mfma_f32_16x16x32_bf16 v[120:123], v[48:51], a[196:199], v[120:123]
  s_add_u32 m0, s29, 130112
  v_exp_f32 v36, v36
  v_mfma_f32_16x16x32_bf16 v[116:119], v[44:47], a[196:199], v[116:119]
  v_exp_f32 v37, v37
  v_mfma_f32_16x16x32_bf16 v[136:139], v[44:47], a[200:203], v[136:139]
  v_exp_f32 v38, v38
  v_mfma_f32_16x16x32_bf16 v[140:143], v[48:51], a[200:203], v[140:143]
  v_exp_f32 v39, v39
  v_mfma_f32_16x16x32_bf16 v[144:147], v[52:55], a[200:203], v[144:147]
  v_cvt_pk_bf16_f32 v76, v36, v37
  v_cvt_pk_bf16_f32 v77, v38, v39
  v_mfma_f32_16x16x32_bf16 v[148:151], v[56:59], a[200:203], v[148:151]
  ds_write_b64 v7, v[76:77] offset:1536
  v_mfma_f32_16x16x32_bf16 v[152:155], v[60:63], a[200:203], v[152:155]
  v_fma_f32 v41, v41, s32, v93
  v_fma_f32 v42, v42, s32, v93
  v_mfma_f32_16x16x32_bf16 v[172:175], v[60:63], a[204:207], v[172:175]
  v_fma_f32 v43, v43, s32, v93
  v_add_f32 v84, v84, v25
  v_mfma_f32_16x16x32_bf16 v[168:171], v[56:59], a[204:207], v[168:171]
  buffer_load_dwordx4 v1, s[16:19], s34 offen offset:2048 nt lds
  v_add_f32 v84, v84, v26
  v_mfma_f32_16x16x32_bf16 v[164:167], v[52:55], a[204:207], v[164:167]
  s_add_u32 m0, s29, 130144
  v_exp_f32 v40, v40
  v_mfma_f32_16x16x32_bf16 v[160:163], v[48:51], a[204:207], v[160:163]
  v_exp_f32 v41, v41
  v_mfma_f32_16x16x32_bf16 v[156:159], v[44:47], a[204:207], v[156:159]
  v_exp_f32 v42, v42
  v_mfma_f32_16x16x32_bf16 v[176:179], v[44:47], a[208:211], v[176:179]
  v_exp_f32 v43, v43
  v_mfma_f32_16x16x32_bf16 v[180:183], v[48:51], a[208:211], v[180:183]
  v_cvt_pk_bf16_f32 v80, v40, v41
  v_cvt_pk_bf16_f32 v81, v42, v43
  v_mfma_f32_16x16x32_bf16 v[184:187], v[52:55], a[208:211], v[184:187]
  ds_write_b64 v7, v[80:81] offset:2048
  v_mfma_f32_16x16x32_bf16 v[188:191], v[56:59], a[208:211], v[188:191]
  v_add_f32 v84, v84, v27
  v_add_f32 v85, v85, v28
  v_mfma_f32_16x16x32_bf16 v[192:195], v[60:63], a[208:211], v[192:195]
  v_add_f32 v85, v85, v29
  v_add_f32 v85, v85, v30
  v_mfma_f32_16x16x32_bf16 v[212:215], v[60:63], a[212:215], v[212:215]
  buffer_load_dwordx4 v1, s[16:19], s34 offen offset:3072 nt lds
  v_add_f32 v85, v85, v31
  v_mfma_f32_16x16x32_bf16 v[208:211], v[56:59], a[212:215], v[208:211]
  s_add_u32 m0, s29, 33792
  v_add_f32 v86, v86, v32
  v_add_f32 v86, v86, v33
  v_mfma_f32_16x16x32_bf16 v[204:207], v[52:55], a[212:215], v[204:207]
  s_add_u32 s34, s34, 16384
  v_add_f32 v86, v86, v34
  v_add_f32 v86, v86, v35
  v_mfma_f32_16x16x32_bf16 v[200:203], v[48:51], a[212:215], v[200:203]
  v_add_f32 v87, v87, v36
  v_add_f32 v87, v87, v37
  v_mfma_f32_16x16x32_bf16 v[196:199], v[44:47], a[212:215], v[196:199]
  v_add_f32 v87, v87, v38
  v_add_f32 v87, v87, v39
  v_mfma_f32_16x16x32_bf16 v[216:219], v[44:47], a[216:219], v[216:219]
  v_add_f32 v88, v88, v40
  v_add_f32 v88, v88, v41
  v_mfma_f32_16x16x32_bf16 v[220:223], v[48:51], a[216:219], v[220:223]
  v_add_f32 v88, v88, v42
  v_add_f32 v88, v88, v43
  v_mfma_f32_16x16x32_bf16 v[224:227], v[52:55], a[216:219], v[224:227]
  v_mfma_f32_16x16x32_bf16 v[228:231], v[56:59], a[216:219], v[228:231]
  v_mfma_f32_16x16x32_bf16 v[232:235], v[60:63], a[216:219], v[232:235]
  v_mfma_f32_16x16x32_bf16 v[252:255], v[60:63], a[220:223], v[252:255]
  s_waitcnt vmcnt(5) lgkmcnt(0)
  s_barrier
  v_mfma_f32_16x16x32_bf16 v[248:251], v[56:59], a[220:223], v[248:251]
  ds_read_b64_tr_b16 a[192:193], v5 offset:0
  v_mfma_f32_16x16x32_bf16 v[244:247], v[52:55], a[220:223], v[244:247]
  ds_read_b64_tr_b16 a[194:195], v6 offset:0
  v_mfma_f32_16x16x32_bf16 v[240:243], v[48:51], a[220:223], v[240:243]
  ds_read_b64 v[66:67], v8 offset:0
  v_mfma_f32_16x16x32_bf16 v[236:239], v[44:47], a[220:223], v[236:239]
  ds_read_b64 v[70:71], v8 offset:512
  v_mfma_f32_16x16x32_bf16 v[24:27], a[160:163], a[0:3], 0
  ds_read_b64 v[74:75], v8 offset:1024
  v_mfma_f32_16x16x32_bf16 v[24:27], a[164:167], a[20:23], v[24:27]
  ds_read_b64 v[78:79], v8 offset:1536
  v_mfma_f32_16x16x32_bf16 v[24:27], a[168:171], a[40:43], v[24:27]
  buffer_load_dwordx4 v1, s[12:15], s33 offen nt lds
  s_add_u32 m0, s29, 33824
  v_mfma_f32_16x16x32_bf16 v[24:27], a[172:175], a[60:63], v[24:27]
  ds_read_b64 v[82:83], v8 offset:2048
  v_mfma_f32_16x16x32_bf16 v[24:27], a[176:179], a[80:83], v[24:27]
  ds_read_b64_tr_b16 a[196:197], v5 offset:32
  v_mfma_f32_16x16x32_bf16 v[24:27], a[180:183], a[100:103], v[24:27]
  ds_read_b64_tr_b16 a[198:199], v6 offset:32
  v_mfma_f32_16x16x32_bf16 v[24:27], a[184:187], a[120:123], v[24:27]
  ds_read_b64_tr_b16 a[200:201], v5 offset:64
  v_mfma_f32_16x16x32_bf16 v[24:27], a[188:191], a[140:143], v[24:27]
  ds_read_b64_tr_b16 a[202:203], v6 offset:64
  v_mfma_f32_16x16x32_bf16 v[28:31], a[188:191], a[144:147], 0
  ds_read_b64_tr_b16 a[204:205], v5 offset:96
  v_mfma_f32_16x16x32_bf16 v[28:31], a[184:187], a[124:127], v[28:31]
  ds_read_b64_tr_b16 a[206:207], v6 offset:96
  v_mfma_f32_16x16x32_bf16 v[28:31], a[180:183], a[104:107], v[28:31]
  ds_read_b64_tr_b16 a[208:209], v5 offset:128
  v_mfma_f32_16x16x32_bf16 v[28:31], a[176:179], a[84:87], v[28:31]
  buffer_load_dwordx4 v1, s[12:15], s33 offen offset:1024 nt lds
  v_fma_f32 v24, v24, s32, v89
  v_mfma_f32_16x16x32_bf16 v[28:31], a[172:175], a[64:67], v[28:31]
  s_add_u32 m0, s29, 33856
  ds_read_b64_tr_b16 a[210:211], v6 offset:128
  v_fma_f32 v25, v25, s32, v89
  v_mfma_f32_16x16x32_bf16 v[28:31], a[168:171], a[44:47], v[28:31]
  ds_read_b64_tr_b16 a[212:213], v5 offset:160
  v_fma_f32 v26, v26, s32, v89
  v_mfma_f32_16x16x32_bf16 v[28:31], a[164:167], a[24:27], v[28:31]
  ds_read_b64_tr_b16 a[214:215], v6 offset:160
  v_fma_f32 v27, v27, s32, v89
  v_mfma_f32_16x16x32_bf16 v[28:31], a[160:163], a[4:7], v[28:31]
  v_exp_f32 v24, v24
  v_mfma_f32_16x16x32_bf16 v[32:35], a[160:163], a[8:11], 0
  v_exp_f32 v25, v25
  v_mfma_f32_16x16x32_bf16 v[32:35], a[164:167], a[28:31], v[32:35]
  v_exp_f32 v26, v26
  v_mfma_f32_16x16x32_bf16 v[32:35], a[168:171], a[48:51], v[32:35]
  v_exp_f32 v27, v27
  v_mfma_f32_16x16x32_bf16 v[32:35], a[172:175], a[68:71], v[32:35]
  ds_read_b64_tr_b16 a[216:217], v5 offset:192
  v_cvt_pk_bf16_f32 v44, v24, v25
  v_mfma_f32_16x16x32_bf16 v[32:35], a[176:179], a[88:91], v[32:35]
  buffer_load_dwordx4 v1, s[12:15], s33 offen offset:2048 nt lds
  v_cvt_pk_bf16_f32 v45, v26, v27
  v_mfma_f32_16x16x32_bf16 v[32:35], a[180:183], a[108:111], v[32:35]
  s_add_u32 m0, s29, 33888
  ds_write_b64 v7, v[44:45] offset:10240
  v_mfma_f32_16x16x32_bf16 v[32:35], a[184:187], a[128:131], v[32:35]
  ds_read_b64_tr_b16 a[218:219], v6 offset:192
  v_fma_f32 v28, v28, s32, v90
  v_mfma_f32_16x16x32_bf16 v[32:35], a[188:191], a[148:151], v[32:35]
  ds_read_b64_tr_b16 a[220:221], v5 offset:224
  v_fma_f32 v29, v29, s32, v90
  v_mfma_f32_16x16x32_bf16 v[36:39], a[188:191], a[152:155], 0
  ds_read_b64_tr_b16 a[222:223], v6 offset:224
  v_fma_f32 v30, v30, s32, v90
  v_mfma_f32_16x16x32_bf16 v[36:39], a[184:187], a[132:135], v[36:39]
  v_fma_f32 v31, v31, s32, v90
  v_add_f32 v84, v84, v24
  v_mfma_f32_16x16x32_bf16 v[36:39], a[180:183], a[112:115], v[36:39]
  v_exp_f32 v28, v28
  v_mfma_f32_16x16x32_bf16 v[36:39], a[176:179], a[92:95], v[36:39]
  v_exp_f32 v29, v29
  v_mfma_f32_16x16x32_bf16 v[36:39], a[172:175], a[72:75], v[36:39]
  v_exp_f32 v30, v30
  v_mfma_f32_16x16x32_bf16 v[36:39], a[168:171], a[52:55], v[36:39]
  buffer_load_dwordx4 v1, s[12:15], s33 offen offset:3072 nt lds
  v_cvt_pk_bf16_f32 v48, v28, v29
  v_mfma_f32_16x16x32_bf16 v[36:39], a[164:167], a[32:35], v[36:39]
  s_add_u32 m0, s29, 146944
  v_exp_f32 v31, v31
  v_mfma_f32_16x16x32_bf16 v[36:39], a[160:163], a[12:15], v[36:39]
  s_add_u32 s33, s33, 16384
  v_cvt_pk_bf16_f32 v49, v30, v31
  v_fma_f32 v32, v32, s32, v91
  v_mfma_f32_16x16x32_bf16 v[40:43], a[160:163], a[16:19], 0
  ds_write_b64 v7, v[48:49] offset:10752
  v_mfma_f32_16x16x32_bf16 v[40:43], a[164:167], a[36:39], v[40:43]
  ds_read_b128 a[160:163], v4 offset:50688
  v_fma_f32 v33, v33, s32, v91
  v_mfma_f32_16x16x32_bf16 v[40:43], a[168:171], a[56:59], v[40:43]
  ds_read_b128 a[164:167], v4 offset:50752
  v_fma_f32 v34, v34, s32, v91
  v_mfma_f32_16x16x32_bf16 v[40:43], a[172:175], a[76:79], v[40:43]
  ds_read_b128 a[168:171], v4 offset:50816
  v_fma_f32 v35, v35, s32, v91
  v_mfma_f32_16x16x32_bf16 v[40:43], a[176:179], a[96:99], v[40:43]
  v_exp_f32 v32, v32
  v_mfma_f32_16x16x32_bf16 v[40:43], a[180:183], a[116:119], v[40:43]
  v_exp_f32 v33, v33
  v_mfma_f32_16x16x32_bf16 v[40:43], a[184:187], a[136:139], v[40:43]
  buffer_load_dwordx4 v1, s[16:19], s34 offen nt lds
  v_cvt_pk_bf16_f32 v52, v32, v33
  v_mfma_f32_16x16x32_bf16 v[40:43], a[188:191], a[156:159], v[40:43]
  s_waitcnt lgkmcnt(4)
  s_add_u32 m0, s29, 146976
  v_exp_f32 v34, v34
  v_mfma_f32_16x16x32_bf16 v[96:99], v[64:67], a[192:195], v[96:99]
  v_exp_f32 v35, v35
  v_mfma_f32_16x16x32_bf16 v[100:103], v[68:71], a[192:195], v[100:103]
  ds_read_b128 a[172:175], v4 offset:50880
  v_cvt_pk_bf16_f32 v53, v34, v35
  v_mfma_f32_16x16x32_bf16 v[104:107], v[72:75], a[192:195], v[104:107]
  ds_write_b64 v7, v[52:53] offset:11264
  v_mfma_f32_16x16x32_bf16 v[108:111], v[76:79], a[192:195], v[108:111]
  ds_read_b128 a[176:179], v4 offset:50944
  v_fma_f32 v36, v36, s32, v92
  v_mfma_f32_16x16x32_bf16 v[112:115], v[80:83], a[192:195], v[112:115]
  ds_read_b128 a[180:183], v4 offset:51008
  v_fma_f32 v37, v37, s32, v92
  v_mfma_f32_16x16x32_bf16 v[132:135], v[80:83], a[196:199], v[132:135]
  ds_read_b128 a[184:187], v4 offset:51072
  v_fma_f32 v38, v38, s32, v92
  v_mfma_f32_16x16x32_bf16 v[128:131], v[76:79], a[196:199], v[128:131]
  ds_read_b128 a[188:191], v4 offset:51136
  v_fma_f32 v39, v39, s32, v92
  v_mfma_f32_16x16x32_bf16 v[124:127], v[72:75], a[196:199], v[124:127]
  buffer_load_dwordx4 v1, s[16:19], s34 offen offset:1024 nt lds
  v_fma_f32 v40, v40, s32, v93
  v_mfma_f32_16x16x32_bf16 v[120:123], v[68:71], a[196:199], v[120:123]
  s_add_u32 m0, s29, 147008
  v_exp_f32 v36, v36
  v_mfma_f32_16x16x32_bf16 v[116:119], v[64:67], a[196:199], v[116:119]
  v_exp_f32 v37, v37
  v_mfma_f32_16x16x32_bf16 v[136:139], v[64:67], a[200:203], v[136:139]
  v_exp_f32 v38, v38
  v_mfma_f32_16x16x32_bf16 v[140:143], v[68:71], a[200:203], v[140:143]
  v_exp_f32 v39, v39
  v_mfma_f32_16x16x32_bf16 v[144:147], v[72:75], a[200:203], v[144:147]
  v_cvt_pk_bf16_f32 v56, v36, v37
  v_cvt_pk_bf16_f32 v57, v38, v39
  v_mfma_f32_16x16x32_bf16 v[148:151], v[76:79], a[200:203], v[148:151]
  ds_write_b64 v7, v[56:57] offset:11776
  v_mfma_f32_16x16x32_bf16 v[152:155], v[80:83], a[200:203], v[152:155]
  v_fma_f32 v41, v41, s32, v93
  v_fma_f32 v42, v42, s32, v93
  v_mfma_f32_16x16x32_bf16 v[172:175], v[80:83], a[204:207], v[172:175]
  v_fma_f32 v43, v43, s32, v93
  v_add_f32 v84, v84, v25
  v_mfma_f32_16x16x32_bf16 v[168:171], v[76:79], a[204:207], v[168:171]
  buffer_load_dwordx4 v1, s[16:19], s34 offen offset:2048 nt lds
  v_add_f32 v84, v84, v26
  v_mfma_f32_16x16x32_bf16 v[164:167], v[72:75], a[204:207], v[164:167]
  s_add_u32 m0, s29, 147040
  v_exp_f32 v40, v40
  v_mfma_f32_16x16x32_bf16 v[160:163], v[68:71], a[204:207], v[160:163]
  v_exp_f32 v41, v41
  v_mfma_f32_16x16x32_bf16 v[156:159], v[64:67], a[204:207], v[156:159]
  v_exp_f32 v42, v42
  v_mfma_f32_16x16x32_bf16 v[176:179], v[64:67], a[208:211], v[176:179]
  v_exp_f32 v43, v43
  v_mfma_f32_16x16x32_bf16 v[180:183], v[68:71], a[208:211], v[180:183]
  v_cvt_pk_bf16_f32 v60, v40, v41
  v_cvt_pk_bf16_f32 v61, v42, v43
  v_mfma_f32_16x16x32_bf16 v[184:187], v[72:75], a[208:211], v[184:187]
  ds_write_b64 v7, v[60:61] offset:12288
  v_mfma_f32_16x16x32_bf16 v[188:191], v[76:79], a[208:211], v[188:191]
  v_add_f32 v84, v84, v27
  v_add_f32 v85, v85, v28
  v_mfma_f32_16x16x32_bf16 v[192:195], v[80:83], a[208:211], v[192:195]
  v_add_f32 v85, v85, v29
  v_add_f32 v85, v85, v30
  v_mfma_f32_16x16x32_bf16 v[212:215], v[80:83], a[212:215], v[212:215]
  buffer_load_dwordx4 v1, s[16:19], s34 offen offset:3072 nt lds
  v_add_f32 v85, v85, v31
  v_mfma_f32_16x16x32_bf16 v[208:211], v[76:79], a[212:215], v[208:211]
  s_add_u32 m0, s29, 50688
  v_add_f32 v86, v86, v32
  v_add_f32 v86, v86, v33
  v_mfma_f32_16x16x32_bf16 v[204:207], v[72:75], a[212:215], v[204:207]
  s_add_u32 s34, s34, 16384
  v_add_f32 v86, v86, v34
  v_add_f32 v86, v86, v35
  v_mfma_f32_16x16x32_bf16 v[200:203], v[68:71], a[212:215], v[200:203]
  v_add_f32 v87, v87, v36
  v_add_f32 v87, v87, v37
  v_mfma_f32_16x16x32_bf16 v[196:199], v[64:67], a[212:215], v[196:199]
  v_add_f32 v87, v87, v38
  v_add_f32 v87, v87, v39
  v_mfma_f32_16x16x32_bf16 v[216:219], v[64:67], a[216:219], v[216:219]
  v_add_f32 v88, v88, v40
  v_add_f32 v88, v88, v41
  v_mfma_f32_16x16x32_bf16 v[220:223], v[68:71], a[216:219], v[220:223]
  v_add_f32 v88, v88, v42
  v_add_f32 v88, v88, v43
  v_mfma_f32_16x16x32_bf16 v[224:227], v[72:75], a[216:219], v[224:227]
  v_mfma_f32_16x16x32_bf16 v[228:231], v[76:79], a[216:219], v[228:231]
  v_mfma_f32_16x16x32_bf16 v[232:235], v[80:83], a[216:219], v[232:235]
  v_mfma_f32_16x16x32_bf16 v[252:255], v[80:83], a[220:223], v[252:255]
  s_waitcnt vmcnt(5) lgkmcnt(0)
  s_barrier
  v_mfma_f32_16x16x32_bf16 v[248:251], v[76:79], a[220:223], v[248:251]
  ds_read_b64_tr_b16 a[192:193], v5 offset:16896
  v_mfma_f32_16x16x32_bf16 v[244:247], v[72:75], a[220:223], v[244:247]
  ds_read_b64_tr_b16 a[194:195], v6 offset:16896
  v_mfma_f32_16x16x32_bf16 v[240:243], v[68:71], a[220:223], v[240:243]
  ds_read_b64 v[46:47], v8 offset:10240
  v_mfma_f32_16x16x32_bf16 v[236:239], v[64:67], a[220:223], v[236:239]
  ds_read_b64 v[50:51], v8 offset:10752
  v_mfma_f32_16x16x32_bf16 v[24:27], a[160:163], a[0:3], 0
  ds_read_b64 v[54:55], v8 offset:11264
  v_mfma_f32_16x16x32_bf16 v[24:27], a[164:167], a[20:23], v[24:27]
  ds_read_b64 v[58:59], v8 offset:11776
  v_mfma_f32_16x16x32_bf16 v[24:27], a[168:171], a[40:43], v[24:27]
  buffer_load_dwordx4 v1, s[12:15], s33 offen nt lds
  s_add_u32 m0, s29, 50720
  v_mfma_f32_16x16x32_bf16 v[24:27], a[172:175], a[60:63], v[24:27]
  ds_read_b64 v[62:63], v8 offset:12288
  v_mfma_f32_16x16x32_bf16 v[24:27], a[176:179], a[80:83], v[24:27]
  ds_read_b64_tr_b16 a[196:197], v5 offset:16928
  v_mfma_f32_16x16x32_bf16 v[24:27], a[180:183], a[100:103], v[24:27]
  ds_read_b64_tr_b16 a[198:199], v6 offset:16928
  v_mfma_f32_16x16x32_bf16 v[24:27], a[184:187], a[120:123], v[24:27]
  ds_read_b64_tr_b16 a[200:201], v5 offset:16960
  v_mfma_f32_16x16x32_bf16 v[24:27], a[188:191], a[140:143], v[24:27]
  ds_read_b64_tr_b16 a[202:203], v6 offset:16960
  v_mfma_f32_16x16x32_bf16 v[28:31], a[188:191], a[144:147], 0
  ds_read_b64_tr_b16 a[204:205], v5 offset:16992
  v_mfma_f32_16x16x32_bf16 v[28:31], a[184:187], a[124:127], v[28:31]
  ds_read_b64_tr_b16 a[206:207], v6 offset:16992
  v_mfma_f32_16x16x32_bf16 v[28:31], a[180:183], a[104:107], v[28:31]
  ds_read_b64_tr_b16 a[208:209], v5 offset:17024
  v_mfma_f32_16x16x32_bf16 v[28:31], a[176:179], a[84:87], v[28:31]
  buffer_load_dwordx4 v1, s[12:15], s33 offen offset:1024 nt lds
  v_fma_f32 v24, v24, s32, v89
  v_mfma_f32_16x16x32_bf16 v[28:31], a[172:175], a[64:67], v[28:31]
  s_add_u32 m0, s29, 50752
  ds_read_b64_tr_b16 a[210:211], v6 offset:17024
  v_fma_f32 v25, v25, s32, v89
  v_mfma_f32_16x16x32_bf16 v[28:31], a[168:171], a[44:47], v[28:31]
  ds_read_b64_tr_b16 a[212:213], v5 offset:17056
  v_fma_f32 v26, v26, s32, v89
  v_mfma_f32_16x16x32_bf16 v[28:31], a[164:167], a[24:27], v[28:31]
  ds_read_b64_tr_b16 a[214:215], v6 offset:17056
  v_fma_f32 v27, v27, s32, v89
  v_mfma_f32_16x16x32_bf16 v[28:31], a[160:163], a[4:7], v[28:31]
  v_exp_f32 v24, v24
  v_mfma_f32_16x16x32_bf16 v[32:35], a[160:163], a[8:11], 0
  v_exp_f32 v25, v25
  v_mfma_f32_16x16x32_bf16 v[32:35], a[164:167], a[28:31], v[32:35]
  v_exp_f32 v26, v26
  v_mfma_f32_16x16x32_bf16 v[32:35], a[168:171], a[48:51], v[32:35]
  v_exp_f32 v27, v27
  v_mfma_f32_16x16x32_bf16 v[32:35], a[172:175], a[68:71], v[32:35]
  ds_read_b64_tr_b16 a[216:217], v5 offset:17088
  v_cvt_pk_bf16_f32 v64, v24, v25
  v_mfma_f32_16x16x32_bf16 v[32:35], a[176:179], a[88:91], v[32:35]
  buffer_load_dwordx4 v1, s[12:15], s33 offen offset:2048 nt lds
  v_cvt_pk_bf16_f32 v65, v26, v27
  v_mfma_f32_16x16x32_bf16 v[32:35], a[180:183], a[108:111], v[32:35]
  s_add_u32 m0, s29, 50784
  ds_write_b64 v7, v[64:65] offset:0
  v_mfma_f32_16x16x32_bf16 v[32:35], a[184:187], a[128:131], v[32:35]
  ds_read_b64_tr_b16 a[218:219], v6 offset:17088
  v_fma_f32 v28, v28, s32, v90
  v_mfma_f32_16x16x32_bf16 v[32:35], a[188:191], a[148:151], v[32:35]
  ds_read_b64_tr_b16 a[220:221], v5 offset:17120
  v_fma_f32 v29, v29, s32, v90
  v_mfma_f32_16x16x32_bf16 v[36:39], a[188:191], a[152:155], 0
  ds_read_b64_tr_b16 a[222:223], v6 offset:17120
  v_fma_f32 v30, v30, s32, v90
  v_mfma_f32_16x16x32_bf16 v[36:39], a[184:187], a[132:135], v[36:39]
  v_fma_f32 v31, v31, s32, v90
  v_add_f32 v84, v84, v24
  v_mfma_f32_16x16x32_bf16 v[36:39], a[180:183], a[112:115], v[36:39]
  v_exp_f32 v28, v28
  v_mfma_f32_16x16x32_bf16 v[36:39], a[176:179], a[92:95], v[36:39]
  v_exp_f32 v29, v29
  v_mfma_f32_16x16x32_bf16 v[36:39], a[172:175], a[72:75], v[36:39]
  v_exp_f32 v30, v30
  v_mfma_f32_16x16x32_bf16 v[36:39], a[168:171], a[52:55], v[36:39]
  buffer_load_dwordx4 v1, s[12:15], s33 offen offset:3072 nt lds
  v_cvt_pk_bf16_f32 v68, v28, v29
  v_mfma_f32_16x16x32_bf16 v[36:39], a[164:167], a[32:35], v[36:39]
  s_add_u32 m0, s29, 96256
  v_exp_f32 v31, v31
  v_mfma_f32_16x16x32_bf16 v[36:39], a[160:163], a[12:15], v[36:39]
  v_cvt_pk_bf16_f32 v69, v30, v31
  v_fma_f32 v32, v32, s32, v91
  v_mfma_f32_16x16x32_bf16 v[40:43], a[160:163], a[16:19], 0
  ds_write_b64 v7, v[68:69] offset:512
  v_mfma_f32_16x16x32_bf16 v[40:43], a[164:167], a[36:39], v[40:43]
  ds_read_b128 a[160:163], v4 offset:0
  v_fma_f32 v33, v33, s32, v91
  v_mfma_f32_16x16x32_bf16 v[40:43], a[168:171], a[56:59], v[40:43]
  ds_read_b128 a[164:167], v4 offset:64
  v_fma_f32 v34, v34, s32, v91
  v_mfma_f32_16x16x32_bf16 v[40:43], a[172:175], a[76:79], v[40:43]
  ds_read_b128 a[168:171], v4 offset:128
  v_fma_f32 v35, v35, s32, v91
  v_mfma_f32_16x16x32_bf16 v[40:43], a[176:179], a[96:99], v[40:43]
  v_exp_f32 v32, v32
  v_mfma_f32_16x16x32_bf16 v[40:43], a[180:183], a[116:119], v[40:43]
  v_exp_f32 v33, v33
  v_mfma_f32_16x16x32_bf16 v[40:43], a[184:187], a[136:139], v[40:43]
  buffer_load_dwordx4 v1, s[16:19], s34 offen nt lds
  v_cvt_pk_bf16_f32 v72, v32, v33
  v_mfma_f32_16x16x32_bf16 v[40:43], a[188:191], a[156:159], v[40:43]
  s_waitcnt lgkmcnt(4)
  s_add_u32 m0, s29, 96288
  v_exp_f32 v34, v34
  v_mfma_f32_16x16x32_bf16 v[96:99], v[44:47], a[192:195], v[96:99]
  v_exp_f32 v35, v35
  v_mfma_f32_16x16x32_bf16 v[100:103], v[48:51], a[192:195], v[100:103]
  ds_read_b128 a[172:175], v4 offset:192
  v_cvt_pk_bf16_f32 v73, v34, v35
  v_mfma_f32_16x16x32_bf16 v[104:107], v[52:55], a[192:195], v[104:107]
  ds_write_b64 v7, v[72:73] offset:1024
  v_mfma_f32_16x16x32_bf16 v[108:111], v[56:59], a[192:195], v[108:111]
  ds_read_b128 a[176:179], v4 offset:256
  v_fma_f32 v36, v36, s32, v92
  v_mfma_f32_16x16x32_bf16 v[112:115], v[60:63], a[192:195], v[112:115]
  ds_read_b128 a[180:183], v4 offset:320
  v_fma_f32 v37, v37, s32, v92
  v_mfma_f32_16x16x32_bf16 v[132:135], v[60:63], a[196:199], v[132:135]
  ds_read_b128 a[184:187], v4 offset:384
  v_fma_f32 v38, v38, s32, v92
  v_mfma_f32_16x16x32_bf16 v[128:131], v[56:59], a[196:199], v[128:131]
  ds_read_b128 a[188:191], v4 offset:448
  v_fma_f32 v39, v39, s32, v92
  v_mfma_f32_16x16x32_bf16 v[124:127], v[52:55], a[196:199], v[124:127]
  buffer_load_dwordx4 v1, s[16:19], s34 offen offset:1024 nt lds
  v_fma_f32 v40, v40, s32, v93
  v_mfma_f32_16x16x32_bf16 v[120:123], v[48:51], a[196:199], v[120:123]
  s_add_u32 m0, s29, 96320
  v_exp_f32 v36, v36
  v_mfma_f32_16x16x32_bf16 v[116:119], v[44:47], a[196:199], v[116:119]
  v_exp_f32 v37, v37
  v_mfma_f32_16x16x32_bf16 v[136:139], v[44:47], a[200:203], v[136:139]
  v_exp_f32 v38, v38
  v_mfma_f32_16x16x32_bf16 v[140:143], v[48:51], a[200:203], v[140:143]
  v_exp_f32 v39, v39
  v_mfma_f32_16x16x32_bf16 v[144:147], v[52:55], a[200:203], v[144:147]
  v_cvt_pk_bf16_f32 v76, v36, v37
  v_cvt_pk_bf16_f32 v77, v38, v39
  v_mfma_f32_16x16x32_bf16 v[148:151], v[56:59], a[200:203], v[148:151]
  ds_write_b64 v7, v[76:77] offset:1536
  v_mfma_f32_16x16x32_bf16 v[152:155], v[60:63], a[200:203], v[152:155]
  v_fma_f32 v41, v41, s32, v93
  v_fma_f32 v42, v42, s32, v93
  v_mfma_f32_16x16x32_bf16 v[172:175], v[60:63], a[204:207], v[172:175]
  v_fma_f32 v43, v43, s32, v93
  v_add_f32 v85, v85, v28
  v_mfma_f32_16x16x32_bf16 v[168:171], v[56:59], a[204:207], v[168:171]
  buffer_load_dwordx4 v1, s[16:19], s34 offen offset:2048 nt lds
  v_add_f32 v86, v86, v32
  v_mfma_f32_16x16x32_bf16 v[164:167], v[52:55], a[204:207], v[164:167]
  s_add_u32 m0, s29, 96352
  v_exp_f32 v40, v40
  v_mfma_f32_16x16x32_bf16 v[160:163], v[48:51], a[204:207], v[160:163]
  s_cmp_lg_u32 s37, 4
  v_exp_f32 v41, v41
  v_mfma_f32_16x16x32_bf16 v[156:159], v[44:47], a[204:207], v[156:159]
  v_exp_f32 v42, v42
  v_mfma_f32_16x16x32_bf16 v[176:179], v[44:47], a[208:211], v[176:179]
  v_exp_f32 v43, v43
  v_mfma_f32_16x16x32_bf16 v[180:183], v[48:51], a[208:211], v[180:183]
  v_cvt_pk_bf16_f32 v80, v40, v41
  v_cvt_pk_bf16_f32 v81, v42, v43
  v_mfma_f32_16x16x32_bf16 v[184:187], v[52:55], a[208:211], v[184:187]
  ds_write_b64 v7, v[80:81] offset:2048
  v_mfma_f32_16x16x32_bf16 v[188:191], v[56:59], a[208:211], v[188:191]
  v_add_f32 v87, v87, v36
  v_add_f32 v88, v88, v40
  v_mfma_f32_16x16x32_bf16 v[192:195], v[60:63], a[208:211], v[192:195]
  v_add_f32 v84, v84, v25
  v_add_f32 v85, v85, v29
  v_mfma_f32_16x16x32_bf16 v[212:215], v[60:63], a[212:215], v[212:215]
  buffer_load_dwordx4 v1, s[16:19], s34 offen offset:3072 nt lds
  v_add_f32 v86, v86, v33
  v_mfma_f32_16x16x32_bf16 v[208:211], v[56:59], a[212:215], v[208:211]
  v_add_f32 v87, v87, v37
  v_add_f32 v88, v88, v41
  v_mfma_f32_16x16x32_bf16 v[204:207], v[52:55], a[212:215], v[204:207]
  v_add_f32 v84, v84, v26
  v_add_f32 v85, v85, v30
  v_mfma_f32_16x16x32_bf16 v[200:203], v[48:51], a[212:215], v[200:203]
  v_add_f32 v86, v86, v34
  v_add_f32 v87, v87, v38
  v_mfma_f32_16x16x32_bf16 v[196:199], v[44:47], a[212:215], v[196:199]
  v_add_f32 v88, v88, v42
  v_add_f32 v84, v84, v27
  v_mfma_f32_16x16x32_bf16 v[216:219], v[44:47], a[216:219], v[216:219]
  v_add_f32 v85, v85, v31
  v_add_f32 v86, v86, v35
  v_mfma_f32_16x16x32_bf16 v[220:223], v[48:51], a[216:219], v[220:223]
  v_add_f32 v87, v87, v39
  v_add_f32 v88, v88, v43
  v_mfma_f32_16x16x32_bf16 v[224:227], v[52:55], a[216:219], v[224:227]
  v_mfma_f32_16x16x32_bf16 v[228:231], v[56:59], a[216:219], v[228:231]
  v_mfma_f32_16x16x32_bf16 v[232:235], v[60:63], a[216:219], v[232:235]
  v_mfma_f32_16x16x32_bf16 v[252:255], v[60:63], a[220:223], v[252:255]
  s_waitcnt vmcnt(5) lgkmcnt(0)
  s_barrier
  v_mfma_f32_16x16x32_bf16 v[248:251], v[56:59], a[220:223], v[248:251]
  v_mfma_f32_16x16x32_bf16 v[244:247], v[52:55], a[220:223], v[244:247]
  v_mfma_f32_16x16x32_bf16 v[240:243], v[48:51], a[220:223], v[240:243]
  v_mfma_f32_16x16x32_bf16 v[236:239], v[44:47], a[220:223], v[236:239]
  s_cbranch_scc1 L_loop0
L_loop1:
  v_mfma_f32_16x16x32_bf16 v[24:27], a[160:163], a[0:3], 0
  s_add_u32 s33, s33, 16384
  global_load_dword v13, v12, s[40:41]
  s_add_u32 m0, s29, 0
  v_mfma_f32_16x16x32_bf16 v[24:27], a[164:167], a[20:23], v[24:27]
  s_add_u32 s34, s34, 16384
  ds_read_b64_tr_b16 a[192:193], v5 offset:33792
  s_sub_u32 s37, s37, 1
  v_mfma_f32_16x16x32_bf16 v[24:27], a[168:171], a[40:43], v[24:27]
  ds_read_b64_tr_b16 a[194:195], v6 offset:33792
  v_mfma_f32_16x16x32_bf16 v[24:27], a[172:175], a[60:63], v[24:27]
  ds_read_b64 v[66:67], v8 offset:0
  v_mfma_f32_16x16x32_bf16 v[24:27], a[176:179], a[80:83], v[24:27]
  buffer_load_dwordx4 v1, s[12:15], s33 offen nt lds
  s_add_u32 m0, s29, 32
  v_mfma_f32_16x16x32_bf16 v[24:27], a[180:183], a[100:103], v[24:27]
  ds_read_b64 v[70:71], v8 offset:512
  v_mfma_f32_16x16x32_bf16 v[24:27], a[184:187], a[120:123], v[24:27]
  ds_read_b64 v[74:75], v8 offset:1024
  v_mfma_f32_16x16x32_bf16 v[24:27], a[188:191], a[140:143], v[24:27]
  ds_read_b64 v[78:79], v8 offset:1536
  v_mfma_f32_16x16x32_bf16 v[28:31], a[188:191], a[144:147], 0
  ds_read_b64 v[82:83], v8 offset:2048
  v_mfma_f32_16x16x32_bf16 v[28:31], a[184:187], a[124:127], v[28:31]
  ds_read_b64_tr_b16 a[196:197], v5 offset:33824
  v_mfma_f32_16x16x32_bf16 v[28:31], a[180:183], a[104:107], v[28:31]
  ds_read_b64_tr_b16 a[198:199], v6 offset:33824
  v_mfma_f32_16x16x32_bf16 v[28:31], a[176:179], a[84:87], v[28:31]
  buffer_load_dwordx4 v1, s[12:15], s33 offen offset:1024 nt lds
  v_fma_f32 v24, v24, s32, v89
  v_mfma_f32_16x16x32_bf16 v[28:31], a[172:175], a[64:67], v[28:31]
  s_add_u32 m0, s29, 64
  ds_read_b64_tr_b16 a[200:201], v5 offset:33856
  v_fma_f32 v25, v25, s32, v89
  v_mfma_f32_16x16x32_bf16 v[28:31], a[168:171], a[44:47], v[28:31]
  ds_read_b64_tr_b16 a[202:203], v6 offset:33856
  v_fma_f32 v26, v26, s32, v89
  v_mfma_f32_16x16x32_bf16 v[28:31], a[164:167], a[24:27], v[28:31]
  ds_read_b64_tr_b16 a[204:205], v5 offset:33888
  v_fma_f32 v27, v27, s32, v89
  v_mfma_f32_16x16x32_bf16 v[28:31], a[160:163], a[4:7], v[28:31]
  v_exp_f32 v24, v24
  v_mfma_f32_16x16x32_bf16 v[32:35], a[160:163], a[8:11], 0
  v_exp_f32 v25, v25
  v_mfma_f32_16x16x32_bf16 v[32:35], a[164:167], a[28:31], v[32:35]
  v_exp_f32 v26, v26
  v_mfma_f32_16x16x32_bf16 v[32:35], a[168:171], a[48:51], v[32:35]
  v_exp_f32 v27, v27
  v_mfma_f32_16x16x32_bf16 v[32:35], a[172:175], a[68:71], v[32:35]
  ds_read_b64_tr_b16 a[206:207], v6 offset:33888
  v_cvt_pk_bf16_f32 v44, v24, v25
  v_mfma_f32_16x16x32_bf16 v[32:35], a[176:179], a[88:91], v[32:35]
  buffer_load_dwordx4 v1, s[12:15], s33 offen offset:2048 nt lds
  v_cvt_pk_bf16_f32 v45, v26, v27
  v_mfma_f32_16x16x32_bf16 v[32:35], a[180:183], a[108:111], v[32:35]
  s_add_u32 m0, s29, 96
  ds_write_b64 v7, v[44:45] offset:10240
  v_mfma_f32_16x16x32_bf16 v[32:35], a[184:187], a[128:131], v[32:35]
  ds_read_b64_tr_b16 a[208:209], v5 offset:33920
  v_fma_f32 v28, v28, s32, v90
  v_mfma_f32_16x16x32_bf16 v[32:35], a[188:191], a[148:151], v[32:35]
  ds_read_b64_tr_b16 a[210:211], v6 offset:33920
  v_fma_f32 v29, v29, s32, v90
  v_mfma_f32_16x16x32_bf16 v[36:39], a[188:191], a[152:155], 0
  ds_read_b64_tr_b16 a[212:213], v5 offset:33952
  v_fma_f32 v30, v30, s32, v90
  v_mfma_f32_16x16x32_bf16 v[36:39], a[184:187], a[132:135], v[36:39]
  ds_read_b64_tr_b16 a[214:215], v6 offset:33952
  v_fma_f32 v31, v31, s32, v90
  v_mfma_f32_16x16x32_bf16 v[36:39], a[180:183], a[112:115], v[36:39]
  v_exp_f32 v28, v28
  v_mfma_f32_16x16x32_bf16 v[36:39], a[176:179], a[92:95], v[36:39]
  v_exp_f32 v29, v29
  v_mfma_f32_16x16x32_bf16 v[36:39], a[172:175], a[72:75], v[36:39]
  v_exp_f32 v30, v30
  v_mfma_f32_16x16x32_bf16 v[36:39], a[168:171], a[52:55], v[36:39]
  buffer_load_dwordx4 v1, s[12:15], s33 offen offset:3072 nt lds
  v_cvt_pk_bf16_f32 v48, v28, v29
  v_mfma_f32_16x16x32_bf16 v[36:39], a[164:167], a[32:35], v[36:39]
  s_add_u32 m0, s29, 113152
  v_exp_f32 v31, v31
  v_mfma_f32_16x16x32_bf16 v[36:39], a[160:163], a[12:15], v[36:39]
  s_add_u32 s33, s33, 16384
  ds_read_b64_tr_b16 a[216:217], v5 offset:33984
  v_cvt_pk_bf16_f32 v49, v30, v31
  v_mfma_f32_16x16x32_bf16 v[40:43], a[160:163], a[16:19], 0
  ds_write_b64 v7, v[48:49] offset:10752
  v_mfma_f32_16x16x32_bf16 v[40:43], a[164:167], a[36:39], v[40:43]
  ds_read_b64_tr_b16 a[218:219], v6 offset:33984
  v_fma_f32 v32, v32, s32, v91
  v_mfma_f32_16x16x32_bf16 v[40:43], a[168:171], a[56:59], v[40:43]
  ds_read_b64_tr_b16 a[220:221], v5 offset:34016
  v_fma_f32 v33, v33, s32, v91
  v_mfma_f32_16x16x32_bf16 v[40:43], a[172:175], a[76:79], v[40:43]
  ds_read_b64_tr_b16 a[222:223], v6 offset:34016
  v_fma_f32 v34, v34, s32, v91
  v_mfma_f32_16x16x32_bf16 v[40:43], a[176:179], a[96:99], v[40:43]
  ds_read_b128 a[160:163], v4 offset:16896
  v_fma_f32 v35, v35, s32, v91
  v_mfma_f32_16x16x32_bf16 v[40:43], a[180:183], a[116:119], v[40:43]
  v_exp_f32 v32, v32
  v_mfma_f32_16x16x32_bf16 v[40:43], a[184:187], a[136:139], v[40:43]
  buffer_load_dwordx4 v1, s[16:19], s34 offen nt lds
  v_fma_f32 v36, v36, s32, v92
  v_mfma_f32_16x16x32_bf16 v[40:43], a[188:191], a[156:159], v[40:43]
  s_waitcnt lgkmcnt(5)
  s_add_u32 m0, s29, 113184
  v_exp_f32 v33, v33
  v_mfma_f32_16x16x32_bf16 v[96:99], v[64:67], a[192:195], v[96:99]
  v_exp_f32 v34, v34
  v_mfma_f32_16x16x32_bf16 v[100:103], v[68:71], a[192:195], v[100:103]
  v_exp_f32 v35, v35
  v_mfma_f32_16x16x32_bf16 v[104:107], v[72:75], a[192:195], v[104:107]
  ds_read_b128 a[164:167], v4 offset:16960
  v_cvt_pk_bf16_f32 v52, v32, v33
  v_mfma_f32_16x16x32_bf16 v[108:111], v[76:79], a[192:195], v[108:111]
  ds_read_b128 a[168:171], v4 offset:17024
  v_cvt_pk_bf16_f32 v53, v34, v35
  v_mfma_f32_16x16x32_bf16 v[112:115], v[80:83], a[192:195], v[112:115]
  ds_write_b64 v7, v[52:53] offset:11264
  v_mfma_f32_16x16x32_bf16 v[132:135], v[80:83], a[196:199], v[132:135]
  ds_read_b128 a[172:175], v4 offset:17088
  v_fma_f32 v37, v37, s32, v92
  v_mfma_f32_16x16x32_bf16 v[128:131], v[76:79], a[196:199], v[128:131]
  ds_read_b128 a[176:179], v4 offset:17152
  v_fma_f32 v38, v38, s32, v92
  v_mfma_f32_16x16x32_bf16 v[124:127], v[72:75], a[196:199], v[124:127]
  buffer_load_dwordx4 v1, s[16:19], s34 offen offset:1024 nt lds
  v_fma_f32 v39, v39, s32, v92
  v_mfma_f32_16x16x32_bf16 v[120:123], v[68:71], a[196:199], v[120:123]
  s_add_u32 m0, s29, 113216
  v_exp_f32 v36, v36
  v_mfma_f32_16x16x32_bf16 v[116:119], v[64:67], a[196:199], v[116:119]
  v_exp_f32 v37, v37
  v_mfma_f32_16x16x32_bf16 v[136:139], v[64:67], a[200:203], v[136:139]
  v_exp_f32 v38, v38
  v_mfma_f32_16x16x32_bf16 v[140:143], v[68:71], a[200:203], v[140:143]
  v_exp_f32 v39, v39
  v_mfma_f32_16x16x32_bf16 v[144:147], v[72:75], a[200:203], v[144:147]
  ds_read_b128 a[180:183], v4 offset:17216
  v_cvt_pk_bf16_f32 v56, v36, v37
  v_mfma_f32_16x16x32_bf16 v[148:151], v[76:79], a[200:203], v[148:151]
  ds_read_b128 a[184:187], v4 offset:17280
  v_cvt_pk_bf16_f32 v57, v38, v39
  v_mfma_f32_16x16x32_bf16 v[152:155], v[80:83], a[200:203], v[152:155]
  ds_write_b64 v7, v[56:57] offset:11776
  v_mfma_f32_16x16x32_bf16 v[172:175], v[80:83], a[204:207], v[172:175]
  ds_read_b128 a[188:191], v4 offset:17344
  v_fma_f32 v40, v40, s32, v93
  v_mfma_f32_16x16x32_bf16 v[168:171], v[76:79], a[204:207], v[168:171]
  buffer_load_dwordx4 v1, s[16:19], s34 offen offset:2048 nt lds
  v_fma_f32 v41, v41, s32, v93
  v_mfma_f32_16x16x32_bf16 v[164:167], v[72:75], a[204:207], v[164:167]
  s_add_u32 m0, s29, 113248
  v_fma_f32 v42, v42, s32, v93
  v_fma_f32 v43, v43, s32, v93
  v_mfma_f32_16x16x32_bf16 v[160:163], v[68:71], a[204:207], v[160:163]
  v_exp_f32 v40, v40
  v_mfma_f32_16x16x32_bf16 v[156:159], v[64:67], a[204:207], v[156:159]
  v_exp_f32 v41, v41
  v_mfma_f32_16x16x32_bf16 v[176:179], v[64:67], a[208:211], v[176:179]
  v_exp_f32 v42, v42
  v_mfma_f32_16x16x32_bf16 v[180:183], v[68:71], a[208:211], v[180:183]
  v_exp_f32 v43, v43
  v_mfma_f32_16x16x32_bf16 v[184:187], v[72:75], a[208:211], v[184:187]
  v_cvt_pk_bf16_f32 v60, v40, v41
  v_cvt_pk_bf16_f32 v61, v42, v43
  v_mfma_f32_16x16x32_bf16 v[188:191], v[76:79], a[208:211], v[188:191]
  ds_write_b64 v7, v[60:61] offset:12288
  v_mfma_f32_16x16x32_bf16 v[192:195], v[80:83], a[208:211], v[192:195]
  v_add_f32 v84, v84, v24
  v_add_f32 v84, v84, v25
  v_mfma_f32_16x16x32_bf16 v[212:215], v[80:83], a[212:215], v[212:215]
  buffer_load_dwordx4 v1, s[16:19], s34 offen offset:3072 nt lds
  v_add_f32 v84, v84, v26
  v_mfma_f32_16x16x32_bf16 v[208:211], v[76:79], a[212:215], v[208:211]
  s_add_u32 m0, s29, 16896
  v_add_f32 v84, v84, v27
  v_add_f32 v85, v85, v28
  v_mfma_f32_16x16x32_bf16 v[204:207], v[72:75], a[212:215], v[204:207]
  s_add_u32 s34, s34, 16384
  v_add_f32 v85, v85, v29
  v_add_f32 v85, v85, v30
  v_mfma_f32_16x16x32_bf16 v[200:203], v[68:71], a[212:215], v[200:203]
  v_add_f32 v85, v85, v31
  v_add_f32 v86, v86, v32
  v_mfma_f32_16x16x32_bf16 v[196:199], v[64:67], a[212:215], v[196:199]
  s_waitcnt lgkmcnt(1)
  v_add_f32 v86, v86, v33
  v_add_f32 v86, v86, v34
  v_mfma_f32_16x16x32_bf16 v[216:219], v[64:67], a[216:219], v[216:219]
  v_add_f32 v86, v86, v35
  v_add_f32 v87, v87, v36
  v_mfma_f32_16x16x32_bf16 v[220:223], v[68:71], a[216:219], v[220:223]
  v_add_f32 v87, v87, v37
  v_add_f32 v87, v87, v38
  v_mfma_f32_16x16x32_bf16 v[224:227], v[72:75], a[216:219], v[224:227]
  v_add_f32 v87, v87, v39
  v_add_f32 v88, v88, v40
  v_mfma_f32_16x16x32_bf16 v[228:231], v[76:79], a[216:219], v[228:231]
  v_add_f32 v88, v88, v41
  v_add_f32 v88, v88, v42
  v_mfma_f32_16x16x32_bf16 v[232:235], v[80:83], a[216:219], v[232:235]
  v_add_f32 v88, v88, v43
  v_mfma_f32_16x16x32_bf16 v[252:255], v[80:83], a[220:223], v[252:255]
  s_waitcnt vmcnt(4) lgkmcnt(0)
  s_barrier
  v_mfma_f32_16x16x32_bf16 v[248:251], v[76:79], a[220:223], v[248:251]
  ds_read_b64_tr_b16 a[192:193], v5 offset:50688
  v_mfma_f32_16x16x32_bf16 v[244:247], v[72:75], a[220:223], v[244:247]
  ds_read_b64_tr_b16 a[194:195], v6 offset:50688
  v_mfma_f32_16x16x32_bf16 v[240:243], v[68:71], a[220:223], v[240:243]
  ds_read_b64 v[46:47], v8 offset:10240
  v_mfma_f32_16x16x32_bf16 v[236:239], v[64:67], a[220:223], v[236:239]
  ds_read_b64 v[50:51], v8 offset:10752
  v_mfma_f32_16x16x32_bf16 v[24:27], a[160:163], a[0:3], 0
  ds_read_b64 v[54:55], v8 offset:11264
  v_mfma_f32_16x16x32_bf16 v[24:27], a[164:167], a[20:23], v[24:27]
  ds_read_b64 v[58:59], v8 offset:11776
  v_mfma_f32_16x16x32_bf16 v[24:27], a[168:171], a[40:43], v[24:27]
  buffer_load_dwordx4 v1, s[12:15], s33 offen nt lds
  s_add_u32 m0, s29, 16928
  v_mfma_f32_16x16x32_bf16 v[24:27], a[172:175], a[60:63], v[24:27]
  ds_read_b64 v[62:63], v8 offset:12288
  v_mfma_f32_16x16x32_bf16 v[24:27], a[176:179], a[80:83], v[24:27]
  ds_read_b64_tr_b16 a[196:197], v5 offset:50720
  v_mfma_f32_16x16x32_bf16 v[24:27], a[180:183], a[100:103], v[24:27]
  ds_read_b64_tr_b16 a[198:199], v6 offset:50720
  v_mfma_f32_16x16x32_bf16 v[24:27], a[184:187], a[120:123], v[24:27]
  ds_read_b64_tr_b16 a[200:201], v5 offset:50752
  v_mfma_f32_16x16x32_bf16 v[24:27], a[188:191], a[140:143], v[24:27]
  ds_read_b64_tr_b16 a[202:203], v6 offset:50752
  v_mfma_f32_16x16x32_bf16 v[28:31], a[188:191], a[144:147], 0
  ds_read_b64_tr_b16 a[204:205], v5 offset:50784
  v_mfma_f32_16x16x32_bf16 v[28:31], a[184:187], a[124:127], v[28:31]
  ds_read_b64_tr_b16 a[206:207], v6 offset:50784
  v_mfma_f32_16x16x32_bf16 v[28:31], a[180:183], a[104:107], v[28:31]
  ds_read_b64_tr_b16 a[208:209], v5 offset:50816
  v_mfma_f32_16x16x32_bf16 v[28:31], a[176:179], a[84:87], v[28:31]
  buffer_load_dwordx4 v1, s[12:15], s33 offen offset:1024 nt lds
  v_fma_f32 v24, v24, s32, v89
  v_mfma_f32_16x16x32_bf16 v[28:31], a[172:175], a[64:67], v[28:31]
  s_add_u32 m0, s29, 16960
  ds_read_b64_tr_b16 a[210:211], v6 offset:50816
  v_fma_f32 v25, v25, s32, v89
  v_mfma_f32_16x16x32_bf16 v[28:31], a[168:171], a[44:47], v[28:31]
  ds_read_b64_tr_b16 a[212:213], v5 offset:50848
  v_fma_f32 v26, v26, s32, v89
  v_mfma_f32_16x16x32_bf16 v[28:31], a[164:167], a[24:27], v[28:31]
  ds_read_b64_tr_b16 a[214:215], v6 offset:50848
  v_fma_f32 v27, v27, s32, v89
  v_mfma_f32_16x16x32_bf16 v[28:31], a[160:163], a[4:7], v[28:31]
  v_exp_f32 v24, v24
  v_mfma_f32_16x16x32_bf16 v[32:35], a[160:163], a[8:11], 0
  v_exp_f32 v25, v25
  v_mfma_f32_16x16x32_bf16 v[32:35], a[164:167], a[28:31], v[32:35]
  v_exp_f32 v26, v26
  v_mfma_f32_16x16x32_bf16 v[32:35], a[168:171], a[48:51], v[32:35]
  v_exp_f32 v27, v27
  v_mfma_f32_16x16x32_bf16 v[32:35], a[172:175], a[68:71], v[32:35]
  ds_read_b64_tr_b16 a[216:217], v5 offset:50880
  v_cvt_pk_bf16_f32 v64, v24, v25
  v_mfma_f32_16x16x32_bf16 v[32:35], a[176:179], a[88:91], v[32:35]
  buffer_load_dwordx4 v1, s[12:15], s33 offen offset:2048 nt lds
  v_cvt_pk_bf16_f32 v65, v26, v27
  v_mfma_f32_16x16x32_bf16 v[32:35], a[180:183], a[108:111], v[32:35]
  s_add_u32 m0, s29, 16992
  ds_write_b64 v7, v[64:65] offset:0
  v_mfma_f32_16x16x32_bf16 v[32:35], a[184:187], a[128:131], v[32:35]
  ds_read_b64_tr_b16 a[218:219], v6 offset:50880
  v_fma_f32 v28, v28, s32, v90
  v_mfma_f32_16x16x32_bf16 v[32:35], a[188:191], a[148:151], v[32:35]
  ds_read_b64_tr_b16 a[220:221], v5 offset:50912
  v_fma_f32 v29, v29, s32, v90
  v_mfma_f32_16x16x32_bf16 v[36:39], a[188:191], a[152:155], 0
  ds_read_b64_tr_b16 a[222:223], v6 offset:50912
  v_fma_f32 v30, v30, s32, v90
  v_mfma_f32_16x16x32_bf16 v[36:39], a[184:187], a[132:135], v[36:39]
  v_fma_f32 v31, v31, s32, v90
  v_add_f32 v84, v84, v24
  v_mfma_f32_16x16x32_bf16 v[36:39], a[180:183], a[112:115], v[36:39]
  v_exp_f32 v28, v28
  v_mfma_f32_16x16x32_bf16 v[36:39], a[176:179], a[92:95], v[36:39]
  v_exp_f32 v29, v29
  v_mfma_f32_16x16x32_bf16 v[36:39], a[172:175], a[72:75], v[36:39]
  v_exp_f32 v30, v30
  v_mfma_f32_16x16x32_bf16 v[36:39], a[168:171], a[52:55], v[36:39]
  buffer_load_dwordx4 v1, s[12:15], s33 offen offset:3072 nt lds
  v_cvt_pk_bf16_f32 v68, v28, v29
  v_mfma_f32_16x16x32_bf16 v[36:39], a[164:167], a[32:35], v[36:39]
  s_add_u32 m0, s29, 130048
  v_exp_f32 v31, v31
  v_mfma_f32_16x16x32_bf16 v[36:39], a[160:163], a[12:15], v[36:39]
  s_add_u32 s33, s33, 16384
  v_cvt_pk_bf16_f32 v69, v30, v31
  v_fma_f32 v32, v32, s32, v91
  v_mfma_f32_16x16x32_bf16 v[40:43], a[160:163], a[16:19], 0
  ds_write_b64 v7, v[68:69] offset:512
  v_mfma_f32_16x16x32_bf16 v[40:43], a[164:167], a[36:39], v[40:43]
  ds_read_b128 a[160:163], v4 offset:33792
  v_fma_f32 v33, v33, s32, v91
  v_mfma_f32_16x16x32_bf16 v[40:43], a[168:171], a[56:59], v[40:43]
  ds_read_b128 a[164:167], v4 offset:33856
  v_fma_f32 v34, v34, s32, v91
  v_mfma_f32_16x16x32_bf16 v[40:43], a[172:175], a[76:79], v[40:43]
  ds_read_b128 a[168:171], v4 offset:33920
  v_fma_f32 v35, v35, s32, v91
  v_mfma_f32_16x16x32_bf16 v[40:43], a[176:179], a[96:99], v[40:43]
  v_exp_f32 v32, v32
  v_mfma_f32_16x16x32_bf16 v[40:43], a[180:183], a[116:119], v[40:43]
  v_exp_f32 v33, v33
  v_mfma_f32_16x16x32_bf16 v[40:43], a[184:187], a[136:139], v[40:43]
  buffer_load_dwordx4 v1, s[16:19], s34 offen nt lds
  v_cvt_pk_bf16_f32 v72, v32, v33
  v_mfma_f32_16x16x32_bf16 v[40:43], a[188:191], a[156:159], v[40:43]
  s_waitcnt lgkmcnt(4)
  s_add_u32 m0, s29, 130080
  v_exp_f32 v34, v34
  v_mfma_f32_16x16x32_bf16 v[96:99], v[44:47], a[192:195], v[96:99]
  v_exp_f32 v35, v35
  v_mfma_f32_16x16x32_bf16 v[100:103], v[48:51], a[192:195], v[100:103]
  ds_read_b128 a[172:175], v4 offset:33984
  v_cvt_pk_bf16_f32 v73, v34, v35
  v_mfma_f32_16x16x32_bf16 v[104:107], v[52:55], a[192:195], v[104:107]
  ds_write_b64 v7, v[72:73] offset:1024
  v_mfma_f32_16x16x32_bf16 v[108:111], v[56:59], a[192:195], v[108:111]
  ds_read_b128 a[176:179], v4 offset:34048
  v_fma_f32 v36, v36, s32, v92
  v_mfma_f32_16x16x32_bf16 v[112:115], v[60:63], a[192:195], v[112:115]
  ds_read_b128 a[180:183], v4 offset:34112
  v_fma_f32 v37, v37, s32, v92
  v_mfma_f32_16x16x32_bf16 v[132:135], v[60:63], a[196:199], v[132:135]
  ds_read_b128 a[184:187], v4 offset:34176
  v_fma_f32 v38, v38, s32, v92
  v_mfma_f32_16x16x32_bf16 v[128:131], v[56:59], a[196:199], v[128:131]
  ds_read_b128 a[188:191], v4 offset:34240
  v_fma_f32 v39, v39, s32, v92
  v_mfma_f32_16x16x32_bf16 v[124:127], v[52:55], a[196:199], v[124:127]
  buffer_load_dwordx4 v1, s[16:19], s34 offen offset:1024 nt lds
  v_fma_f32 v40, v40, s32, v93
  v_mfma_f32_16x16x32_bf16 v[120:123], v[48:51], a[196:199], v[120:123]
  s_add_u32 m0, s29, 130112
  v_exp_f32 v36, v36
  v_mfma_f32_16x16x32_bf16 v[116:119], v[44:47], a[196:199], v[116:119]
  v_exp_f32 v37, v37
  v_mfma_f32_16x16x32_bf16 v[136:139], v[44:47], a[200:203], v[136:139]
  v_exp_f32 v38, v38
  v_mfma_f32_16x16x32_bf16 v[140:143], v[48:51], a[200:203], v[140:143]
  v_exp_f32 v39, v39
  v_mfma_f32_16x16x32_bf16 v[144:147], v[52:55], a[200:203], v[144:147]
  v_cvt_pk_bf16_f32 v76, v36, v37
  v_cvt_pk_bf16_f32 v77, v38, v39
  v_mfma_f32_16x16x32_bf16 v[148:151], v[56:59], a[200:203], v[148:151]
  ds_write_b64 v7, v[76:77] offset:1536
  v_mfma_f32_16x16x32_bf16 v[152:155], v[60:63], a[200:203], v[152:155]
  v_fma_f32 v41, v41, s32, v93
  v_fma_f32 v42, v42, s32, v93
  v_mfma_f32_16x16x32_bf16 v[172:175], v[60:63], a[204:207], v[172:175]
  v_fma_f32 v43, v43, s32, v93
  v_add_f32 v84, v84, v25
  v_mfma_f32_16x16x32_bf16 v[168:171], v[56:59], a[204:207], v[168:171]
  buffer_load_dwordx4 v1, s[16:19], s34 offen offset:2048 nt lds
  v_add_f32 v84, v84, v26
  v_mfma_f32_16x16x32_bf16 v[164:167], v[52:55], a[204:207], v[164:167]
  s_add_u32 m0, s29, 130144
  v_exp_f32 v40, v40
  v_mfma_f32_16x16x32_bf16 v[160:163], v[48:51], a[204:207], v[160:163]
  v_exp_f32 v41, v41
  v_mfma_f32_16x16x32_bf16 v[156:159], v[44:47], a[204:207], v[156:159]
  v_exp_f32 v42, v42
  v_mfma_f32_16x16x32_bf16 v[176:179], v[44:47], a[208:211], v[176:179]
  v_exp_f32 v43, v43
  v_mfma_f32_16x16x32_bf16 v[180:183], v[48:51], a[208:211], v[180:183]
  v_cvt_pk_bf16_f32 v80, v40, v41
  v_cvt_pk_bf16_f32 v81, v42, v43
  v_mfma_f32_16x16x32_bf16 v[184:187], v[52:55], a[208:211], v[184:187]
  ds_write_b64 v7, v[80:81] offset:2048
  v_mfma_f32_16x16x32_bf16 v[188:191], v[56:59], a[208:211], v[188:191]
  v_add_f32 v84, v84, v27
  v_add_f32 v85, v85, v28
  v_mfma_f32_16x16x32_bf16 v[192:195], v[60:63], a[208:211], v[192:195]
  v_add_f32 v85, v85, v29
  v_add_f32 v85, v85, v30
  v_mfma_f32_16x16x32_bf16 v[212:215], v[60:63], a[212:215], v[212:215]
  buffer_load_dwordx4 v1, s[16:19], s34 offen offset:3072 nt lds
  v_add_f32 v85, v85, v31
  v_mfma_f32_16x16x32_bf16 v[208:211], v[56:59], a[212:215], v[208:211]
  s_add_u32 m0, s29, 33792
  v_add_f32 v86, v86, v32
  v_add_f32 v86, v86, v33
  v_mfma_f32_16x16x32_bf16 v[204:207], v[52:55], a[212:215], v[204:207]
  s_add_u32 s34, s34, 16384
  v_add_f32 v86, v86, v34
  v_add_f32 v86, v86, v35
  v_mfma_f32_16x16x32_bf16 v[200:203], v[48:51], a[212:215], v[200:203]
  v_add_f32 v87, v87, v36
  v_add_f32 v87, v87, v37
  v_mfma_f32_16x16x32_bf16 v[196:199], v[44:47], a[212:215], v[196:199]
  v_add_f32 v87, v87, v38
  v_add_f32 v87, v87, v39
  v_mfma_f32_16x16x32_bf16 v[216:219], v[44:47], a[216:219], v[216:219]
  v_add_f32 v88, v88, v40
  v_add_f32 v88, v88, v41
  v_mfma_f32_16x16x32_bf16 v[220:223], v[48:51], a[216:219], v[220:223]
  v_add_f32 v88, v88, v42
  v_add_f32 v88, v88, v43
  v_mfma_f32_16x16x32_bf16 v[224:227], v[52:55], a[216:219], v[224:227]
  v_mfma_f32_16x16x32_bf16 v[228:231], v[56:59], a[216:219], v[228:231]
  v_mfma_f32_16x16x32_bf16 v[232:235], v[60:63], a[216:219], v[232:235]
  v_mfma_f32_16x16x32_bf16 v[252:255], v[60:63], a[220:223], v[252:255]
  s_waitcnt vmcnt(4) lgkmcnt(0)
  s_barrier
  v_mfma_f32_16x16x32_bf16 v[248:251], v[56:59], a[220:223], v[248:251]
  ds_read_b64_tr_b16 a[192:193], v5 offset:0
  v_mfma_f32_16x16x32_bf16 v[244:247], v[52:55], a[220:223], v[244:247]
  ds_read_b64_tr_b16 a[194:195], v6 offset:0
  v_mfma_f32_16x16x32_bf16 v[240:243], v[48:51], a[220:223], v[240:243]
  ds_read_b64 v[66:67], v8 offset:0
  v_mfma_f32_16x16x32_bf16 v[236:239], v[44:47], a[220:223], v[236:239]
  ds_read_b64 v[70:71], v8 offset:512
  v_mfma_f32_16x16x32_bf16 v[24:27], a[160:163], a[0:3], 0
  ds_read_b64 v[74:75], v8 offset:1024
  v_mfma_f32_16x16x32_bf16 v[24:27], a[164:167], a[20:23], v[24:27]
  ds_read_b64 v[78:79], v8 offset:1536
  v_mfma_f32_16x16x32_bf16 v[24:27], a[168:171], a[40:43], v[24:27]
  buffer_load_dwordx4 v1, s[12:15], s33 offen nt lds
  s_add_u32 m0, s29, 33824
  v_mfma_f32_16x16x32_bf16 v[24:27], a[172:175], a[60:63], v[24:27]
  ds_read_b64 v[82:83], v8 offset:2048
  v_mfma_f32_16x16x32_bf16 v[24:27], a[176:179], a[80:83], v[24:27]
  ds_read_b64_tr_b16 a[196:197], v5 offset:32
  v_mfma_f32_16x16x32_bf16 v[24:27], a[180:183], a[100:103], v[24:27]
  ds_read_b64_tr_b16 a[198:199], v6 offset:32
  v_mfma_f32_16x16x32_bf16 v[24:27], a[184:187], a[120:123], v[24:27]
  ds_read_b64_tr_b16 a[200:201], v5 offset:64
  v_mfma_f32_16x16x32_bf16 v[24:27], a[188:191], a[140:143], v[24:27]
  ds_read_b64_tr_b16 a[202:203], v6 offset:64
  v_mfma_f32_16x16x32_bf16 v[28:31], a[188:191], a[144:147], 0
  ds_read_b64_tr_b16 a[204:205], v5 offset:96
  v_mfma_f32_16x16x32_bf16 v[28:31], a[184:187], a[124:127], v[28:31]
  ds_read_b64_tr_b16 a[206:207], v6 offset:96
  v_mfma_f32_16x16x32_bf16 v[28:31], a[180:183], a[104:107], v[28:31]
  ds_read_b64_tr_b16 a[208:209], v5 offset:128
  v_mfma_f32_16x16x32_bf16 v[28:31], a[176:179], a[84:87], v[28:31]
  buffer_load_dwordx4 v1, s[12:15], s33 offen offset:1024 nt lds
  v_fma_f32 v24, v24, s32, v89
  v_mfma_f32_16x16x32_bf16 v[28:31], a[172:175], a[64:67], v[28:31]
  s_add_u32 m0, s29, 33856
  ds_read_b64_tr_b16 a[210:211], v6 offset:128
  v_fma_f32 v25, v25, s32, v89
  v_mfma_f32_16x16x32_bf16 v[28:31], a[168:171], a[44:47], v[28:31]
  ds_read_b64_tr_b16 a[212:213], v5 offset:160
  v_fma_f32 v26, v26, s32, v89
  v_mfma_f32_16x16x32_bf16 v[28:31], a[164:167], a[24:27], v[28:31]
  ds_read_b64_tr_b16 a[214:215], v6 offset:160
  v_fma_f32 v27, v27, s32, v89
  v_mfma_f32_16x16x32_bf16 v[28:31], a[160:163], a[4:7], v[28:31]
  v_exp_f32 v24, v24
  v_mfma_f32_16x16x32_bf16 v[32:35], a[160:163], a[8:11], 0
  v_exp_f32 v25, v25
  v_mfma_f32_16x16x32_bf16 v[32:35], a[164:167], a[28:31], v[32:35]
  v_exp_f32 v26, v26
  v_mfma_f32_16x16x32_bf16 v[32:35], a[168:171], a[48:51], v[32:35]
  v_exp_f32 v27, v27
  v_mfma_f32_16x16x32_bf16 v[32:35], a[172:175], a[68:71], v[32:35]
  ds_read_b64_tr_b16 a[216:217], v5 offset:192
  v_cvt_pk_bf16_f32 v44, v24, v25
  v_mfma_f32_16x16x32_bf16 v[32:35], a[176:179], a[88:91], v[32:35]
  buffer_load_dwordx4 v1, s[12:15], s33 offen offset:2048 nt lds
  v_cvt_pk_bf16_f32 v45, v26, v27
  v_mfma_f32_16x16x32_bf16 v[32:35], a[180:183], a[108:111], v[32:35]
  s_add_u32 m0, s29, 33888
  ds_write_b64 v7, v[44:45] offset:10240
  v_mfma_f32_16x16x32_bf16 v[32:35], a[184:187], a[128:131], v[32:35]
  ds_read_b64_tr_b16 a[218:219], v6 offset:192
  v_fma_f32 v28, v28, s32, v90
  v_mfma_f32_16x16x32_bf16 v[32:35], a[188:191], a[148:151], v[32:35]
  ds_read_b64_tr_b16 a[220:221], v5 offset:224
  v_fma_f32 v29, v29, s32, v90
  v_mfma_f32_16x16x32_bf16 v[36:39], a[188:191], a[152:155], 0
  ds_read_b64_tr_b16 a[222:223], v6 offset:224
  v_fma_f32 v30, v30, s32, v90
  v_mfma_f32_16x16x32_bf16 v[36:39], a[184:187], a[132:135], v[36:39]
  v_fma_f32 v31, v31, s32, v90
  v_add_f32 v84, v84, v24
  v_mfma_f32_16x16x32_bf16 v[36:39], a[180:183], a[112:115], v[36:39]
  v_exp_f32 v28, v28
  v_mfma_f32_16x16x32_bf16 v[36:39], a[176:179], a[92:95], v[36:39]
  v_exp_f32 v29, v29
  v_mfma_f32_16x16x32_bf16 v[36:39], a[172:175], a[72:75], v[36:39]
  v_exp_f32 v30, v30
  v_mfma_f32_16x16x32_bf16 v[36:39], a[168:171], a[52:55], v[36:39]
  buffer_load_dwordx4 v1, s[12:15], s33 offen offset:3072 nt lds
  v_cvt_pk_bf16_f32 v48, v28, v29
  v_mfma_f32_16x16x32_bf16 v[36:39], a[164:167], a[32:35], v[36:39]
  s_add_u32 m0, s29, 146944
  v_exp_f32 v31, v31
  v_mfma_f32_16x16x32_bf16 v[36:39], a[160:163], a[12:15], v[36:39]
  s_add_u32 s33, s33, 16384
  v_cvt_pk_bf16_f32 v49, v30, v31
  v_fma_f32 v32, v32, s32, v91
  v_mfma_f32_16x16x32_bf16 v[40:43], a[160:163], a[16:19], 0
  ds_write_b64 v7, v[48:49] offset:10752
  v_mfma_f32_16x16x32_bf16 v[40:43], a[164:167], a[36:39], v[40:43]
  ds_read_b128 a[160:163], v4 offset:50688
  v_fma_f32 v33, v33, s32, v91
  v_mfma_f32_16x16x32_bf16 v[40:43], a[168:171], a[56:59], v[40:43]
  ds_read_b128 a[164:167], v4 offset:50752
  v_fma_f32 v34, v34, s32, v91
  v_mfma_f32_16x16x32_bf16 v[40:43], a[172:175], a[76:79], v[40:43]
  ds_read_b128 a[168:171], v4 offset:50816
  v_fma_f32 v35, v35, s32, v91
  v_mfma_f32_16x16x32_bf16 v[40:43], a[176:179], a[96:99], v[40:43]
  v_exp_f32 v32, v32
  v_mfma_f32_16x16x32_bf16 v[40:43], a[180:183], a[116:119], v[40:43]
  v_exp_f32 v33, v33
  v_mfma_f32_16x16x32_bf16 v[40:43], a[184:187], a[136:139], v[40:43]
  buffer_load_dwordx4 v1, s[16:19], s34 offen nt lds
  v_cvt_pk_bf16_f32 v52, v32, v33
  v_mfma_f32_16x16x32_bf16 v[40:43], a[188:191], a[156:159], v[40:43]
  s_waitcnt lgkmcnt(4)
  s_add_u32 m0, s29, 146976
  v_exp_f32 v34, v34
  v_mfma_f32_16x16x32_bf16 v[96:99], v[64:67], a[192:195], v[96:99]
  v_exp_f32 v35, v35
  v_mfma_f32_16x16x32_bf16 v[100:103], v[68:71], a[192:195], v[100:103]
  ds_read_b128 a[172:175], v4 offset:50880
  v_cvt_pk_bf16_f32 v53, v34, v35
  v_mfma_f32_16x16x32_bf16 v[104:107], v[72:75], a[192:195], v[104:107]
  ds_write_b64 v7, v[52:53] offset:11264
  v_mfma_f32_16x16x32_bf16 v[108:111], v[76:79], a[192:195], v[108:111]
  ds_read_b128 a[176:179], v4 offset:50944
  v_fma_f32 v36, v36, s32, v92
  v_mfma_f32_16x16x32_bf16 v[112:115], v[80:83], a[192:195], v[112:115]
  ds_read_b128 a[180:183], v4 offset:51008
  v_fma_f32 v37, v37, s32, v92
  v_mfma_f32_16x16x32_bf16 v[132:135], v[80:83], a[196:199], v[132:135]
  ds_read_b128 a[184:187], v4 offset:51072
  v_fma_f32 v38, v38, s32, v92
  v_mfma_f32_16x16x32_bf16 v[128:131], v[76:79], a[196:199], v[128:131]
  ds_read_b128 a[188:191], v4 offset:51136
  v_fma_f32 v39, v39, s32, v92
  v_mfma_f32_16x16x32_bf16 v[124:127], v[72:75], a[196:199], v[124:127]
  buffer_load_dwordx4 v1, s[16:19], s34 offen offset:1024 nt lds
  v_fma_f32 v40, v40, s32, v93
  v_mfma_f32_16x16x32_bf16 v[120:123], v[68:71], a[196:199], v[120:123]
  s_add_u32 m0, s29, 147008
  v_exp_f32 v36, v36
  v_mfma_f32_16x16x32_bf16 v[116:119], v[64:67], a[196:199], v[116:119]
  v_exp_f32 v37, v37
  v_mfma_f32_16x16x32_bf16 v[136:139], v[64:67], a[200:203], v[136:139]
  v_exp_f32 v38, v38
  v_mfma_f32_16x16x32_bf16 v[140:143], v[68:71], a[200:203], v[140:143]
  v_exp_f32 v39, v39
  v_mfma_f32_16x16x32_bf16 v[144:147], v[72:75], a[200:203], v[144:147]
  v_cvt_pk_bf16_f32 v56, v36, v37
  v_cvt_pk_bf16_f32 v57, v38, v39
  v_mfma_f32_16x16x32_bf16 v[148:151], v[76:79], a[200:203], v[148:151]
  ds_write_b64 v7, v[56:57] offset:11776
  v_mfma_f32_16x16x32_bf16 v[152:155], v[80:83], a[200:203], v[152:155]
  v_fma_f32 v41, v41, s32, v93
  v_fma_f32 v42, v42, s32, v93
  v_mfma_f32_16x16x32_bf16 v[172:175], v[80:83], a[204:207], v[172:175]
  v_fma_f32 v43, v43, s32, v93
  v_add_f32 v84, v84, v25
  v_mfma_f32_16x16x32_bf16 v[168:171], v[76:79], a[204:207], v[168:171]
  buffer_load_dwordx4 v1, s[16:19], s34 offen offset:2048 nt lds
  v_add_f32 v84, v84, v26
  v_mfma_f32_16x16x32_bf16 v[164:167], v[72:75], a[204:207], v[164:167]
  s_add_u32 m0, s29, 147040
  v_exp_f32 v40, v40
  v_mfma_f32_16x16x32_bf16 v[160:163], v[68:71], a[204:207], v[160:163]
  v_exp_f32 v41, v41
  v_mfma_f32_16x16x32_bf16 v[156:159], v[64:67], a[204:207], v[156:159]
  v_exp_f32 v42, v42
  v_mfma_f32_16x16x32_bf16 v[176:179], v[64:67], a[208:211], v[176:179]
  v_exp_f32 v43, v43
  v_mfma_f32_16x16x32_bf16 v[180:183], v[68:71], a[208:211], v[180:183]
  v_cvt_pk_bf16_f32 v60, v40, v41
  v_cvt_pk_bf16_f32 v61, v42, v43
  v_mfma_f32_16x16x32_bf16 v[184:187], v[72:75], a[208:211], v[184:187]
  ds_write_b64 v7, v[60:61] offset:12288
  v_mfma_f32_16x16x32_bf16 v[188:191], v[76:79], a[208:211], v[188:191]
  v_add_f32 v84, v84, v27
  v_add_f32 v85, v85, v28
  v_mfma_f32_16x16x32_bf16 v[192:195], v[80:83], a[208:211], v[192:195]
  v_add_f32 v85, v85, v29
  v_add_f32 v85, v85, v30
  v_mfma_f32_16x16x32_bf16 v[212:215], v[80:83], a[212:215], v[212:215]
  buffer_load_dwordx4 v1, s[16:19], s34 offen offset:3072 nt lds
  v_add_f32 v85, v85, v31
  v_mfma_f32_16x16x32_bf16 v[208:211], v[76:79], a[212:215], v[208:211]
  s_add_u32 m0, s29, 50688
  v_add_f32 v86, v86, v32
  v_add_f32 v86, v86, v33
  v_mfma_f32_16x16x32_bf16 v[204:207], v[72:75], a[212:215], v[204:207]
  s_add_u32 s34, s34, 16384
  v_add_f32 v86, v86, v34
  v_add_f32 v86, v86, v35
  v_mfma_f32_16x16x32_bf16 v[200:203], v[68:71], a[212:215], v[200:203]
  v_add_f32 v87, v87, v36
  v_add_f32 v87, v87, v37
  v_mfma_f32_16x16x32_bf16 v[196:199], v[64:67], a[212:215], v[196:199]
  v_add_f32 v87, v87, v38
  v_add_f32 v87, v87, v39
  v_mfma_f32_16x16x32_bf16 v[216:219], v[64:67], a[216:219], v[216:219]
  v_add_f32 v88, v88, v40
  v_add_f32 v88, v88, v41
  v_mfma_f32_16x16x32_bf16 v[220:223], v[68:71], a[216:219], v[220:223]
  v_add_f32 v88, v88, v42
  v_add_f32 v88, v88, v43
  v_mfma_f32_16x16x32_bf16 v[224:227], v[72:75], a[216:219], v[224:227]
  v_mfma_f32_16x16x32_bf16 v[228:231], v[76:79], a[216:219], v[228:231]
  v_mfma_f32_16x16x32_bf16 v[232:235], v[80:83], a[216:219], v[232:235]
  v_mfma_f32_16x16x32_bf16 v[252:255], v[80:83], a[220:223], v[252:255]
  s_waitcnt vmcnt(4) lgkmcnt(0)
  s_barrier
  v_mfma_f32_16x16x32_bf16 v[248:251], v[76:79], a[220:223], v[248:251]
  ds_read_b64_tr_b16 a[192:193], v5 offset:16896
  v_mfma_f32_16x16x32_bf16 v[244:247], v[72:75], a[220:223], v[244:247]
  ds_read_b64_tr_b16 a[194:195], v6 offset:16896
  v_mfma_f32_16x16x32_bf16 v[240:243], v[68:71], a[220:223], v[240:243]
  ds_read_b64 v[46:47], v8 offset:10240
  v_mfma_f32_16x16x32_bf16 v[236:239], v[64:67], a[220:223], v[236:239]
  ds_read_b64 v[50:51], v8 offset:10752
  v_mfma_f32_16x16x32_bf16 v[24:27], a[160:163], a[0:3], 0
  ds_read_b64 v[54:55], v8 offset:11264
  v_mfma_f32_16x16x32_bf16 v[24:27], a[164:167], a[20:23], v[24:27]
  ds_read_b64 v[58:59], v8 offset:11776
  v_mfma_f32_16x16x32_bf16 v[24:27], a[168:171], a[40:43], v[24:27]
  buffer_load_dwordx4 v1, s[12:15], s33 offen nt lds
  s_add_u32 m0, s29, 50720
  v_mfma_f32_16x16x32_bf16 v[24:27], a[172:175], a[60:63], v[24:27]
  ds_read_b64 v[62:63], v8 offset:12288
  v_mfma_f32_16x16x32_bf16 v[24:27], a[176:179], a[80:83], v[24:27]
  ds_read_b64_tr_b16 a[196:197], v5 offset:16928
  v_mfma_f32_16x16x32_bf16 v[24:27], a[180:183], a[100:103], v[24:27]
  ds_read_b64_tr_b16 a[198:199], v6 offset:16928
  v_mfma_f32_16x16x32_bf16 v[24:27], a[184:187], a[120:123], v[24:27]
  ds_read_b64_tr_b16 a[200:201], v5 offset:16960
  v_mfma_f32_16x16x32_bf16 v[24:27], a[188:191], a[140:143], v[24:27]
  ds_read_b64_tr_b16 a[202:203], v6 offset:16960
  v_mfma_f32_16x16x32_bf16 v[28:31], a[188:191], a[144:147], 0
  ds_read_b64_tr_b16 a[204:205], v5 offset:16992
  v_mfma_f32_16x16x32_bf16 v[28:31], a[184:187], a[124:127], v[28:31]
  ds_read_b64_tr_b16 a[206:207], v6 offset:16992
  v_mfma_f32_16x16x32_bf16 v[28:31], a[180:183], a[104:107], v[28:31]
  ds_read_b64_tr_b16 a[208:209], v5 offset:17024
  v_mfma_f32_16x16x32_bf16 v[28:31], a[176:179], a[84:87], v[28:31]
  buffer_load_dwordx4 v1, s[12:15], s33 offen offset:1024 nt lds
  v_fma_f32 v24, v24, s32, v89
  v_mfma_f32_16x16x32_bf16 v[28:31], a[172:175], a[64:67], v[28:31]
  s_add_u32 m0, s29, 50752
  ds_read_b64_tr_b16 a[210:211], v6 offset:17024
  v_fma_f32 v25, v25, s32, v89
  v_mfma_f32_16x16x32_bf16 v[28:31], a[168:171], a[44:47], v[28:31]
  ds_read_b64_tr_b16 a[212:213], v5 offset:17056
  v_fma_f32 v26, v26, s32, v89
  v_mfma_f32_16x16x32_bf16 v[28:31], a[164:167], a[24:27], v[28:31]
  ds_read_b64_tr_b16 a[214:215], v6 offset:17056
  v_fma_f32 v27, v27, s32, v89
  v_mfma_f32_16x16x32_bf16 v[28:31], a[160:163], a[4:7], v[28:31]
  v_exp_f32 v24, v24
  v_mfma_f32_16x16x32_bf16 v[32:35], a[160:163], a[8:11], 0
  v_exp_f32 v25, v25
  v_mfma_f32_16x16x32_bf16 v[32:35], a[164:167], a[28:31], v[32:35]
  v_exp_f32 v26, v26
  v_mfma_f32_16x16x32_bf16 v[32:35], a[168:171], a[48:51], v[32:35]
  v_exp_f32 v27, v27
  v_mfma_f32_16x16x32_bf16 v[32:35], a[172:175], a[68:71], v[32:35]
  ds_read_b64_tr_b16 a[216:217], v5 offset:17088
  v_cvt_pk_bf16_f32 v64, v24, v25
  v_mfma_f32_16x16x32_bf16 v[32:35], a[176:179], a[88:91], v[32:35]
  buffer_load_dwordx4 v1, s[12:15], s33 offen offset:2048 nt lds
  v_cvt_pk_bf16_f32 v65, v26, v27
  v_mfma_f32_16x16x32_bf16 v[32:35], a[180:183], a[108:111], v[32:35]
  s_add_u32 m0, s29, 50784
  ds_write_b64 v7, v[64:65] offset:0
  v_mfma_f32_16x16x32_bf16 v[32:35], a[184:187], a[128:131], v[32:35]
  ds_read_b64_tr_b16 a[218:219], v6 offset:17088
  v_fma_f32 v28, v28, s32, v90
  v_mfma_f32_16x16x32_bf16 v[32:35], a[188:191], a[148:151], v[32:35]
  ds_read_b64_tr_b16 a[220:221], v5 offset:17120
  v_fma_f32 v29, v29, s32, v90
  v_mfma_f32_16x16x32_bf16 v[36:39], a[188:191], a[152:155], 0
  ds_read_b64_tr_b16 a[222:223], v6 offset:17120
  v_fma_f32 v30, v30, s32, v90
  v_mfma_f32_16x16x32_bf16 v[36:39], a[184:187], a[132:135], v[36:39]
  v_fma_f32 v31, v31, s32, v90
  v_add_f32 v84, v84, v24
  v_mfma_f32_16x16x32_bf16 v[36:39], a[180:183], a[112:115], v[36:39]
  v_exp_f32 v28, v28
  v_mfma_f32_16x16x32_bf16 v[36:39], a[176:179], a[92:95], v[36:39]
  v_exp_f32 v29, v29
  v_mfma_f32_16x16x32_bf16 v[36:39], a[172:175], a[72:75], v[36:39]
  v_exp_f32 v30, v30
  v_mfma_f32_16x16x32_bf16 v[36:39], a[168:171], a[52:55], v[36:39]
  buffer_load_dwordx4 v1, s[12:15], s33 offen offset:3072 nt lds
  v_cvt_pk_bf16_f32 v68, v28, v29
  v_mfma_f32_16x16x32_bf16 v[36:39], a[164:167], a[32:35], v[36:39]
  s_add_u32 m0, s29, 96256
  v_exp_f32 v31, v31
  v_mfma_f32_16x16x32_bf16 v[36:39], a[160:163], a[12:15], v[36:39]
  v_cvt_pk_bf16_f32 v69, v30, v31
  v_fma_f32 v32, v32, s32, v91
  v_mfma_f32_16x16x32_bf16 v[40:43], a[160:163], a[16:19], 0
  ds_write_b64 v7, v[68:69] offset:512
  v_mfma_f32_16x16x32_bf16 v[40:43], a[164:167], a[36:39], v[40:43]
  ds_read_b128 a[160:163], v4 offset:0
  v_fma_f32 v33, v33, s32, v91
  v_mfma_f32_16x16x32_bf16 v[40:43], a[168:171], a[56:59], v[40:43]
  ds_read_b128 a[164:167], v4 offset:64
  v_fma_f32 v34, v34, s32, v91
  v_mfma_f32_16x16x32_bf16 v[40:43], a[172:175], a[76:79], v[40:43]
  ds_read_b128 a[168:171], v4 offset:128
  v_fma_f32 v35, v35, s32, v91
  v_mfma_f32_16x16x32_bf16 v[40:43], a[176:179], a[96:99], v[40:43]
  v_exp_f32 v32, v32
  v_mfma_f32_16x16x32_bf16 v[40:43], a[180:183], a[116:119], v[40:43]
  v_exp_f32 v33, v33
  v_mfma_f32_16x16x32_bf16 v[40:43], a[184:187], a[136:139], v[40:43]
  buffer_load_dwordx4 v1, s[16:19], s34 offen nt lds
  v_cvt_pk_bf16_f32 v72, v32, v33
  v_mfma_f32_16x16x32_bf16 v[40:43], a[188:191], a[156:159], v[40:43]
  s_waitcnt lgkmcnt(4)
  s_add_u32 m0, s29, 96288
  v_exp_f32 v34, v34
  v_mfma_f32_16x16x32_bf16 v[96:99], v[44:47], a[192:195], v[96:99]
  v_exp_f32 v35, v35
  v_mfma_f32_16x16x32_bf16 v[100:103], v[48:51], a[192:195], v[100:103]
  ds_read_b128 a[172:175], v4 offset:192
  v_cvt_pk_bf16_f32 v73, v34, v35
  v_mfma_f32_16x16x32_bf16 v[104:107], v[52:55], a[192:195], v[104:107]
  ds_write_b64 v7, v[72:73] offset:1024
  v_mfma_f32_16x16x32_bf16 v[108:111], v[56:59], a[192:195], v[108:111]
  ds_read_b128 a[176:179], v4 offset:256
  v_fma_f32 v36, v36, s32, v92
  v_mfma_f32_16x16x32_bf16 v[112:115], v[60:63], a[192:195], v[112:115]
  ds_read_b128 a[180:183], v4 offset:320
  v_fma_f32 v37, v37, s32, v92
  v_mfma_f32_16x16x32_bf16 v[132:135], v[60:63], a[196:199], v[132:135]
  ds_read_b128 a[184:187], v4 offset:384
  v_fma_f32 v38, v38, s32, v92
  v_mfma_f32_16x16x32_bf16 v[128:131], v[56:59], a[196:199], v[128:131]
  ds_read_b128 a[188:191], v4 offset:448
  v_fma_f32 v39, v39, s32, v92
  v_mfma_f32_16x16x32_bf16 v[124:127], v[52:55], a[196:199], v[124:127]
  buffer_load_dwordx4 v1, s[16:19], s34 offen offset:1024 nt lds
  v_fma_f32 v40, v40, s32, v93
  v_mfma_f32_16x16x32_bf16 v[120:123], v[48:51], a[196:199], v[120:123]
  s_add_u32 m0, s29, 96320
  v_exp_f32 v36, v36
  v_mfma_f32_16x16x32_bf16 v[116:119], v[44:47], a[196:199], v[116:119]
  v_exp_f32 v37, v37
  v_mfma_f32_16x16x32_bf16 v[136:139], v[44:47], a[200:203], v[136:139]
  v_exp_f32 v38, v38
  v_mfma_f32_16x16x32_bf16 v[140:143], v[48:51], a[200:203], v[140:143]
  v_exp_f32 v39, v39
  v_mfma_f32_16x16x32_bf16 v[144:147], v[52:55], a[200:203], v[144:147]
  v_cvt_pk_bf16_f32 v76, v36, v37
  v_cvt_pk_bf16_f32 v77, v38, v39
  v_mfma_f32_16x16x32_bf16 v[148:151], v[56:59], a[200:203], v[148:151]
  ds_write_b64 v7, v[76:77] offset:1536
  v_mfma_f32_16x16x32_bf16 v[152:155], v[60:63], a[200:203], v[152:155]
  v_fma_f32 v41, v41, s32, v93
  v_fma_f32 v42, v42, s32, v93
  v_mfma_f32_16x16x32_bf16 v[172:175], v[60:63], a[204:207], v[172:175]
  v_fma_f32 v43, v43, s32, v93
  v_add_f32 v85, v85, v28
  v_mfma_f32_16x16x32_bf16 v[168:171], v[56:59], a[204:207], v[168:171]
  buffer_load_dwordx4 v1, s[16:19], s34 offen offset:2048 nt lds
  v_add_f32 v86, v86, v32
  v_mfma_f32_16x16x32_bf16 v[164:167], v[52:55], a[204:207], v[164:167]
  s_add_u32 m0, s29, 96352
  v_exp_f32 v40, v40
  v_mfma_f32_16x16x32_bf16 v[160:163], v[48:51], a[204:207], v[160:163]
  s_cmp_lg_u32 s37, 0
  v_exp_f32 v41, v41
  v_mfma_f32_16x16x32_bf16 v[156:159], v[44:47], a[204:207], v[156:159]
  v_exp_f32 v42, v42
  v_mfma_f32_16x16x32_bf16 v[176:179], v[44:47], a[208:211], v[176:179]
  v_exp_f32 v43, v43
  v_mfma_f32_16x16x32_bf16 v[180:183], v[48:51], a[208:211], v[180:183]
  v_cvt_pk_bf16_f32 v80, v40, v41
  v_cvt_pk_bf16_f32 v81, v42, v43
  v_mfma_f32_16x16x32_bf16 v[184:187], v[52:55], a[208:211], v[184:187]
  ds_write_b64 v7, v[80:81] offset:2048
  v_mfma_f32_16x16x32_bf16 v[188:191], v[56:59], a[208:211], v[188:191]
  v_add_f32 v87, v87, v36
  v_add_f32 v88, v88, v40
  v_mfma_f32_16x16x32_bf16 v[192:195], v[60:63], a[208:211], v[192:195]
  v_add_f32 v84, v84, v25
  v_add_f32 v85, v85, v29
  v_mfma_f32_16x16x32_bf16 v[212:215], v[60:63], a[212:215], v[212:215]
  buffer_load_dwordx4 v1, s[16:19], s34 offen offset:3072 nt lds
  v_add_f32 v86, v86, v33
  v_mfma_f32_16x16x32_bf16 v[208:211], v[56:59], a[212:215], v[208:211]
  v_add_f32 v87, v87, v37
  v_add_f32 v88, v88, v41
  v_mfma_f32_16x16x32_bf16 v[204:207], v[52:55], a[212:215], v[204:207]
  v_add_f32 v84, v84, v26
  v_add_f32 v85, v85, v30
  v_mfma_f32_16x16x32_bf16 v[200:203], v[48:51], a[212:215], v[200:203]
  v_add_f32 v86, v86, v34
  v_add_f32 v87, v87, v38
  v_mfma_f32_16x16x32_bf16 v[196:199], v[44:47], a[212:215], v[196:199]
  v_add_f32 v88, v88, v42
  v_add_f32 v84, v84, v27
  v_mfma_f32_16x16x32_bf16 v[216:219], v[44:47], a[216:219], v[216:219]
  v_add_f32 v85, v85, v31
  v_add_f32 v86, v86, v35
  v_mfma_f32_16x16x32_bf16 v[220:223], v[48:51], a[216:219], v[220:223]
  v_add_f32 v87, v87, v39
  v_add_f32 v88, v88, v43
  v_mfma_f32_16x16x32_bf16 v[224:227], v[52:55], a[216:219], v[224:227]
  v_mfma_f32_16x16x32_bf16 v[228:231], v[56:59], a[216:219], v[228:231]
  v_mfma_f32_16x16x32_bf16 v[232:235], v[60:63], a[216:219], v[232:235]
  v_mfma_f32_16x16x32_bf16 v[252:255], v[60:63], a[220:223], v[252:255]
  s_waitcnt vmcnt(4) lgkmcnt(0)
  s_barrier
  v_mfma_f32_16x16x32_bf16 v[248:251], v[56:59], a[220:223], v[248:251]
  v_mfma_f32_16x16x32_bf16 v[244:247], v[52:55], a[220:223], v[244:247]
  v_mfma_f32_16x16x32_bf16 v[240:243], v[48:51], a[220:223], v[240:243]
  v_mfma_f32_16x16x32_bf16 v[236:239], v[44:47], a[220:223], v[236:239]
  s_cbranch_scc1 L_loop1
L_post:
  v_mfma_f32_16x16x32_bf16 v[24:27], a[160:163], a[0:3], 0
  s_mov_b32 s35, 0
  ds_read_b64 v[66:67], v8 offset:0
  v_mov_b32 v10, 0
  v_mfma_f32_16x16x32_bf16 v[24:27], a[164:167], a[20:23], v[24:27]
  s_add_u32 m0, s31, 0
  ds_read_b64_tr_b16 a[194:195], v6 offset:33792
  v_lshlrev_b32 v9, 7, v0
  v_mfma_f32_16x16x32_bf16 v[24:27], a[168:171], a[40:43], v[24:27]
  s_lshl_b32 s54, s61, 2
  buffer_load_dwordx4 v23, s[20:23], s35 offen lds
  v_min_u32 v9, 28544, v9
  v_mfma_f32_16x16x32_bf16 v[24:27], a[172:175], a[60:63], v[24:27]
  s_add_u32 m0, s31, 1024
  ds_read_b64_tr_b16 a[192:193], v5 offset:33792
  v_and_b32 v3, 63, v0
  v_mfma_f32_16x16x32_bf16 v[24:27], a[176:179], a[80:83], v[24:27]
  s_mov_b32 s35, 7168
  ds_read_b64 v[70:71], v8 offset:512
  v_lshlrev_b32 v3, 4, v3
  v_mfma_f32_16x16x32_bf16 v[24:27], a[180:183], a[100:103], v[24:27]
  s_mov_b32 s34, 491520
  ds_read_b64 v[74:75], v8 offset:1024
  v_and_b32 v17, 2, v0
  v_mfma_f32_16x16x32_bf16 v[24:27], a[184:187], a[120:123], v[24:27]
  s_mul_i32 s43, s60, 143360
  buffer_load_dword v14, v10, s[4:7], s54 offen sc1
  v_bfe_u32 v18, v0, 2, 4
  v_mfma_f32_16x16x32_bf16 v[24:27], a[188:191], a[140:143], v[24:27]
  s_mul_i32 s42, s28, 35840
  ds_read_b64 v[78:79], v8 offset:1536
  v_lshlrev_b32 v17, 2, v17
  v_mfma_f32_16x16x32_bf16 v[28:31], a[188:191], a[144:147], 0
  s_add_u32 s42, s42, s43
  ds_read_b64_tr_b16 a[198:199], v6 offset:33824
  v_xor_b32 v17, v17, v18
  v_mfma_f32_16x16x32_bf16 v[28:31], a[184:187], a[124:127], v[28:31]
  ds_read_b64 v[82:83], v8 offset:2048
  v_fma_f32 v27, v27, s32, v89
  v_mfma_f32_16x16x32_bf16 v[28:31], a[180:183], a[104:107], v[28:31]
  v_exp_f32 v27, v27
  v_mfma_f32_16x16x32_bf16 v[28:31], a[176:179], a[84:87], v[28:31]
  buffer_load_dwordx4 v23, s[20:23], s35 offen lds
  v_fma_f32 v24, v24, s32, v89
  v_mfma_f32_16x16x32_bf16 v[28:31], a[172:175], a[64:67], v[28:31]
  s_add_u32 m0, s31, 2048
  ds_read_b64_tr_b16 a[196:197], v5 offset:33824
  v_fma_f32 v25, v25, s32, v89
  v_mfma_f32_16x16x32_bf16 v[28:31], a[168:171], a[44:47], v[28:31]
  s_mov_b32 s35, 14336
  v_exp_f32 v25, v25
  v_mfma_f32_16x16x32_bf16 v[28:31], a[164:167], a[24:27], v[28:31]
  ds_read_b64_tr_b16 a[200:201], v5 offset:33856
  v_fma_f32 v26, v26, s32, v89
  v_mfma_f32_16x16x32_bf16 v[28:31], a[160:163], a[4:7], v[28:31]
  v_exp_f32 v26, v26
  v_mfma_f32_16x16x32_bf16 v[32:35], a[160:163], a[8:11], 0
  v_exp_f32 v24, v24
  v_mfma_f32_16x16x32_bf16 v[32:35], a[164:167], a[28:31], v[32:35]
  ds_read_b64_tr_b16 a[202:203], v6 offset:33856
  v_cvt_pk_bf16_f32 v44, v24, v25
  v_mfma_f32_16x16x32_bf16 v[32:35], a[168:171], a[48:51], v[32:35]
  ds_read_b64_tr_b16 a[206:207], v6 offset:33888
  v_cvt_pk_bf16_f32 v45, v26, v27
  v_mfma_f32_16x16x32_bf16 v[32:35], a[172:175], a[68:71], v[32:35]
  ds_write_b64 v7, v[44:45] offset:10240
  v_mfma_f32_16x16x32_bf16 v[32:35], a[176:179], a[88:91], v[32:35]
  buffer_load_dwordx4 v23, s[20:23], s35 offen lds
  v_fma_f32 v28, v28, s32, v90
  v_mfma_f32_16x16x32_bf16 v[32:35], a[180:183], a[108:111], v[32:35]
  s_add_u32 m0, s31, 3072
  ds_read_b64_tr_b16 a[204:205], v5 offset:33888
  v_fma_f32 v29, v29, s32, v90
  v_mfma_f32_16x16x32_bf16 v[32:35], a[184:187], a[128:131], v[32:35]
  s_mov_b32 s35, 21504
  ds_read_b64_tr_b16 a[210:211], v6 offset:33920
  v_fma_f32 v30, v30, s32, v90
  v_mfma_f32_16x16x32_bf16 v[32:35], a[188:191], a[148:151], v[32:35]
  v_exp_f32 v30, v30
  v_mfma_f32_16x16x32_bf16 v[36:39], a[188:191], a[152:155], 0
  v_exp_f32 v28, v28
  v_mfma_f32_16x16x32_bf16 v[36:39], a[184:187], a[132:135], v[36:39]
  ds_read_b64_tr_b16 a[208:209], v5 offset:33920
  v_fma_f32 v31, v31, s32, v90
  v_mfma_f32_16x16x32_bf16 v[36:39], a[180:183], a[112:115], v[36:39]
  v_exp_f32 v31, v31
  v_mfma_f32_16x16x32_bf16 v[36:39], a[176:179], a[92:95], v[36:39]
  v_exp_f32 v29, v29
  v_mfma_f32_16x16x32_bf16 v[36:39], a[172:175], a[72:75], v[36:39]
  ds_read_b64_tr_b16 a[214:215], v6 offset:33952
  v_cvt_pk_bf16_f32 v48, v28, v29
  v_mfma_f32_16x16x32_bf16 v[36:39], a[168:171], a[52:55], v[36:39]
  buffer_load_dwordx4 v23, s[20:23], s35 offen lds
  v_cvt_pk_bf16_f32 v49, v30, v31
  v_mfma_f32_16x16x32_bf16 v[36:39], a[164:167], a[32:35], v[36:39]
  s_add_u32 m0, s29, 113152
  ds_write_b64 v7, v[48:49] offset:10752
  v_mfma_f32_16x16x32_bf16 v[36:39], a[160:163], a[12:15], v[36:39]
  s_mov_b32 s35, 114688
  ds_read_b64_tr_b16 a[212:213], v5 offset:33952
  v_fma_f32 v33, v33, s32, v91
  v_mfma_f32_16x16x32_bf16 v[40:43], a[160:163], a[16:19], 0
  ds_read_b64_tr_b16 a[218:219], v6 offset:33984
  v_fma_f32 v35, v35, s32, v91
  v_mfma_f32_16x16x32_bf16 v[40:43], a[164:167], a[36:39], v[40:43]
  v_exp_f32 v35, v35
  v_mfma_f32_16x16x32_bf16 v[40:43], a[168:171], a[56:59], v[40:43]
  ds_read_b64_tr_b16 a[216:217], v5 offset:33984
  v_fma_f32 v34, v34, s32, v91
  v_mfma_f32_16x16x32_bf16 v[40:43], a[172:175], a[76:79], v[40:43]
  v_exp_f32 v33, v33
  v_mfma_f32_16x16x32_bf16 v[40:43], a[176:179], a[96:99], v[40:43]
  ds_read_b64_tr_b16 a[220:221], v5 offset:34016
  v_fma_f32 v32, v32, s32, v91
  v_mfma_f32_16x16x32_bf16 v[40:43], a[180:183], a[116:119], v[40:43]
  v_exp_f32 v32, v32
  v_mfma_f32_16x16x32_bf16 v[40:43], a[184:187], a[136:139], v[40:43]
  buffer_load_dwordx4 v1, s[16:19], s34 offen nt lds
  v_cvt_pk_bf16_f32 v52, v32, v33
  v_mfma_f32_16x16x32_bf16 v[40:43], a[188:191], a[156:159], v[40:43]
  s_waitcnt lgkmcnt(3)
  s_add_u32 m0, s29, 113184
  v_exp_f32 v34, v34
  v_mfma_f32_16x16x32_bf16 v[96:99], v[64:67], a[192:195], v[96:99]
  ds_read_b64_tr_b16 a[222:223], v6 offset:34016
  v_cvt_pk_bf16_f32 v53, v34, v35
  v_mfma_f32_16x16x32_bf16 v[100:103], v[68:71], a[192:195], v[100:103]
  ds_write_b64 v7, v[52:53] offset:11264
  v_mfma_f32_16x16x32_bf16 v[104:107], v[72:75], a[192:195], v[104:107]
  ds_read_b128 a[160:163], v4 offset:16896
  v_fma_f32 v36, v36, s32, v92
  v_mfma_f32_16x16x32_bf16 v[108:111], v[76:79], a[192:195], v[108:111]
  ds_read_b128 a[188:191], v4 offset:17344
  v_fma_f32 v39, v39, s32, v92
  v_mfma_f32_16x16x32_bf16 v[112:115], v[80:83], a[192:195], v[112:115]
  ds_read_b128 a[164:167], v4 offset:16960
  v_fma_f32 v37, v37, s32, v92
  v_mfma_f32_16x16x32_bf16 v[132:135], v[80:83], a[196:199], v[132:135]
  v_exp_f32 v39, v39
  v_mfma_f32_16x16x32_bf16 v[128:131], v[76:79], a[196:199], v[128:131]
  v_exp_f32 v37, v37
  v_mfma_f32_16x16x32_bf16 v[124:127], v[72:75], a[196:199], v[124:127]
  buffer_load_dwordx4 v1, s[16:19], s34 offen offset:1024 nt lds
  v_fma_f32 v38, v38, s32, v92
  v_mfma_f32_16x16x32_bf16 v[120:123], v[68:71], a[196:199], v[120:123]
  s_add_u32 m0, s29, 113216
  v_exp_f32 v38, v38
  v_mfma_f32_16x16x32_bf16 v[116:119], v[64:67], a[196:199], v[116:119]
  ds_read_b128 a[180:183], v4 offset:17216
  v_cvt_pk_bf16_f32 v57, v38, v39
  v_mfma_f32_16x16x32_bf16 v[136:139], v[64:67], a[200:203], v[136:139]
  v_exp_f32 v36, v36
  v_mfma_f32_16x16x32_bf16 v[140:143], v[68:71], a[200:203], v[140:143]
  ds_read_b128 a[168:171], v4 offset:17024
  v_cvt_pk_bf16_f32 v56, v36, v37
  v_mfma_f32_16x16x32_bf16 v[144:147], v[72:75], a[200:203], v[144:147]
  ds_write_b64 v7, v[56:57] offset:11776
  v_mfma_f32_16x16x32_bf16 v[148:151], v[76:79], a[200:203], v[148:151]
  ds_read_b128 a[172:175], v4 offset:17088
  v_fma_f32 v40, v40, s32, v93
  v_mfma_f32_16x16x32_bf16 v[152:155], v[80:83], a[200:203], v[152:155]
  ds_read_b128 a[184:187], v4 offset:17280
  v_fma_f32 v43, v43, s32, v93
  v_mfma_f32_16x16x32_bf16 v[172:175], v[80:83], a[204:207], v[172:175]
  v_exp_f32 v43, v43
  v_mfma_f32_16x16x32_bf16 v[168:171], v[76:79], a[204:207], v[168:171]
  buffer_load_dwordx4 v1, s[16:19], s34 offen offset:2048 nt lds
  v_fma_f32 v41, v41, s32, v93
  v_mfma_f32_16x16x32_bf16 v[164:167], v[72:75], a[204:207], v[164:167]
  s_add_u32 m0, s29, 113248
  v_exp_f32 v41, v41
  v_mfma_f32_16x16x32_bf16 v[160:163], v[68:71], a[204:207], v[160:163]
  ds_read_b128 a[176:179], v4 offset:17152
  v_fma_f32 v42, v42, s32, v93
  v_mfma_f32_16x16x32_bf16 v[156:159], v[64:67], a[204:207], v[156:159]
  v_exp_f32 v42, v42
  v_mfma_f32_16x16x32_bf16 v[176:179], v[64:67], a[208:211], v[176:179]
  v_cvt_pk_bf16_f32 v61, v42, v43
  v_add_f32 v84, v84, v24
  v_mfma_f32_16x16x32_bf16 v[180:183], v[68:71], a[208:211], v[180:183]
  v_exp_f32 v40, v40
  v_mfma_f32_16x16x32_bf16 v[184:187], v[72:75], a[208:211], v[184:187]
  v_cvt_pk_bf16_f32 v60, v40, v41
  v_add_f32 v84, v84, v25
  v_mfma_f32_16x16x32_bf16 v[188:191], v[76:79], a[208:211], v[188:191]
  ds_write_b64 v7, v[60:61] offset:12288
  v_mfma_f32_16x16x32_bf16 v[192:195], v[80:83], a[208:211], v[192:195]
  v_add_f32 v84, v84, v26
  v_add_f32 v84, v84, v27
  v_mfma_f32_16x16x32_bf16 v[212:215], v[80:83], a[212:215], v[212:215]
  buffer_load_dwordx4 v1, s[16:19], s34 offen offset:3072 nt lds
  v_add_f32 v85, v85, v28
  v_mfma_f32_16x16x32_bf16 v[208:211], v[76:79], a[212:215], v[208:211]
  s_add_u32 m0, s31, 16896
  v_add_f32 v85, v85, v29
  v_add_f32 v85, v85, v30
  v_mfma_f32_16x16x32_bf16 v[204:207], v[72:75], a[212:215], v[204:207]
  s_mov_b32 s34, 507904
  v_add_f32 v85, v85, v31
  v_add_f32 v86, v86, v32
  v_mfma_f32_16x16x32_bf16 v[200:203], v[68:71], a[212:215], v[200:203]
  v_add_f32 v86, v86, v33
  v_add_f32 v86, v86, v34
  v_mfma_f32_16x16x32_bf16 v[196:199], v[64:67], a[212:215], v[196:199]
  s_waitcnt lgkmcnt(1)
  v_add_f32 v86, v86, v35
  v_add_f32 v87, v87, v36
  v_mfma_f32_16x16x32_bf16 v[216:219], v[64:67], a[216:219], v[216:219]
  v_add_f32 v87, v87, v37
  v_add_f32 v87, v87, v38
  v_mfma_f32_16x16x32_bf16 v[220:223], v[68:71], a[216:219], v[220:223]
  v_add_f32 v87, v87, v39
  v_add_f32 v88, v88, v40
  v_mfma_f32_16x16x32_bf16 v[224:227], v[72:75], a[216:219], v[224:227]
  v_add_f32 v88, v88, v41
  v_add_f32 v88, v88, v42
  v_mfma_f32_16x16x32_bf16 v[228:231], v[76:79], a[216:219], v[228:231]
  v_add_f32 v88, v88, v43
  v_and_b32 v18, 3, v0
  v_mfma_f32_16x16x32_bf16 v[232:235], v[80:83], a[216:219], v[232:235]
  v_lshl_add_u32 v17, v18, 4, v17
  v_lshl_add_u32 v17, v17, 3, s31
  v_mfma_f32_16x16x32_bf16 v[252:255], v[80:83], a[220:223], v[252:255]
  s_waitcnt vmcnt(4) lgkmcnt(0)
  v_xor_b32 v18, 4096, v17
  v_add_u32 v17, 77824, v17
  v_mfma_f32_16x16x32_bf16 v[248:251], v[76:79], a[220:223], v[248:251]
  s_barrier
  ds_read_b64 v[46:47], v8 offset:10240
  v_add_u32 v18, 77824, v18
  v_mfma_f32_16x16x32_bf16 v[244:247], v[72:75], a[220:223], v[244:247]
  ds_read_b64_tr_b16 a[194:195], v6 offset:50688
  v_and_b32 v95, 15, v0
  v_mfma_f32_16x16x32_bf16 v[240:243], v[68:71], a[220:223], v[240:243]
  ds_read_b64 v[50:51], v8 offset:10752
  v_lshlrev_b32 v95, 6, v95
  v_mfma_f32_16x16x32_bf16 v[236:239], v[64:67], a[220:223], v[236:239]
  ds_read_b64_tr_b16 a[192:193], v5 offset:50688
  v_mfma_f32_16x16x32_bf16 v[24:27], a[160:163], a[0:3], 0
  ds_read_b64 v[54:55], v8 offset:11264
  v_mfma_f32_16x16x32_bf16 v[24:27], a[164:167], a[20:23], v[24:27]
  ds_read_b64 v[58:59], v8 offset:11776
  v_mfma_f32_16x16x32_bf16 v[24:27], a[168:171], a[40:43], v[24:27]
  buffer_load_dwordx4 v23, s[20:23], s35 offen lds
  s_mov_b32 s35, 121856
  v_mfma_f32_16x16x32_bf16 v[24:27], a[172:175], a[60:63], v[24:27]
  s_add_u32 m0, s31, 17920
  ds_read_b64 v[62:63], v8 offset:12288
  v_mfma_f32_16x16x32_bf16 v[24:27], a[176:179], a[80:83], v[24:27]
  ds_read_b64_tr_b16 a[198:199], v6 offset:50720
  v_mfma_f32_16x16x32_bf16 v[24:27], a[180:183], a[100:103], v[24:27]
  ds_read_b64_tr_b16 a[196:197], v5 offset:50720
  v_mfma_f32_16x16x32_bf16 v[24:27], a[184:187], a[120:123], v[24:27]
  ds_read_b64_tr_b16 a[200:201], v5 offset:50752
  v_mfma_f32_16x16x32_bf16 v[24:27], a[188:191], a[140:143], v[24:27]
  ds_read_b64_tr_b16 a[202:203], v6 offset:50752
  v_mfma_f32_16x16x32_bf16 v[28:31], a[188:191], a[144:147], 0
  ds_read_b64_tr_b16 a[204:205], v5 offset:50784
  v_mfma_f32_16x16x32_bf16 v[28:31], a[184:187], a[124:127], v[28:31]
  ds_read_b64_tr_b16 a[206:207], v6 offset:50784
  v_mfma_f32_16x16x32_bf16 v[28:31], a[180:183], a[104:107], v[28:31]
  ds_read_b64_tr_b16 a[210:211], v6 offset:50816
  v_mfma_f32_16x16x32_bf16 v[28:31], a[176:179], a[84:87], v[28:31]
  buffer_load_dwordx4 v23, s[20:23], s35 offen lds
  v_fma_f32 v27, v27, s32, v89
  v_mfma_f32_16x16x32_bf16 v[28:31], a[172:175], a[64:67], v[28:31]
  s_mov_b32 s35, 129024
  ds_read_b64_tr_b16 a[208:209], v5 offset:50816
  v_fma_f32 v26, v26, s32, v89
  v_mfma_f32_16x16x32_bf16 v[28:31], a[168:171], a[44:47], v[28:31]
  s_add_u32 m0, s31, 18944
  ds_read_b64_tr_b16 a[214:215], v6 offset:50848
  v_fma_f32 v24, v24, s32, v89
  v_mfma_f32_16x16x32_bf16 v[28:31], a[164:167], a[24:27], v[28:31]
  v_exp_f32 v26, v26
  v_mfma_f32_16x16x32_bf16 v[28:31], a[160:163], a[4:7], v[28:31]
  v_exp_f32 v27, v27
  v_mfma_f32_16x16x32_bf16 v[32:35], a[160:163], a[8:11], 0
  ds_read_b64_tr_b16 a[212:213], v5 offset:50848
  v_cvt_pk_bf16_f32 v65, v26, v27
  v_mfma_f32_16x16x32_bf16 v[32:35], a[164:167], a[28:31], v[32:35]
  v_exp_f32 v24, v24
  v_mfma_f32_16x16x32_bf16 v[32:35], a[168:171], a[48:51], v[32:35]
  s_waitcnt vmcnt(9)
  ds_read_b64_tr_b16 a[216:217], v5 offset:50880
  v_fma_f32 v25, v25, s32, v89
  v_mfma_f32_16x16x32_bf16 v[32:35], a[172:175], a[68:71], v[32:35]
  v_exp_f32 v25, v25
  v_mfma_f32_16x16x32_bf16 v[32:35], a[176:179], a[88:91], v[32:35]
  buffer_load_dwordx4 v23, s[20:23], s35 offen lds
  v_cvt_pk_bf16_f32 v64, v24, v25
  v_mfma_f32_16x16x32_bf16 v[32:35], a[180:183], a[108:111], v[32:35]
  s_add_u32 m0, s31, 19968
  ds_write_b64 v7, v[64:65] offset:0
  v_mfma_f32_16x16x32_bf16 v[32:35], a[184:187], a[128:131], v[32:35]
  s_mov_b32 s35, 136192
  ds_read_b64_tr_b16 a[218:219], v6 offset:50880
  v_fma_f32 v28, v28, s32, v90
  v_mfma_f32_16x16x32_bf16 v[32:35], a[188:191], a[148:151], v[32:35]
  ds_read_b64_tr_b16 a[222:223], v6 offset:50912
  v_fma_f32 v29, v29, s32, v90
  v_mfma_f32_16x16x32_bf16 v[36:39], a[188:191], a[152:155], 0
  ds_read_b64_tr_b16 a[220:221], v5 offset:50912
  v_fma_f32 v30, v30, s32, v90
  v_mfma_f32_16x16x32_bf16 v[36:39], a[184:187], a[132:135], v[36:39]
  v_exp_f32 v28, v28
  v_mfma_f32_16x16x32_bf16 v[36:39], a[180:183], a[112:115], v[36:39]
  v_exp_f32 v30, v30
  v_mfma_f32_16x16x32_bf16 v[36:39], a[176:179], a[92:95], v[36:39]
  v_fma_f32 v31, v31, s32, v90
  v_fma_f32 v34, v34, s32, v91
  v_mfma_f32_16x16x32_bf16 v[36:39], a[172:175], a[72:75], v[36:39]
  v_exp_f32 v31, v31
  v_mfma_f32_16x16x32_bf16 v[36:39], a[168:171], a[52:55], v[36:39]
  buffer_load_dwordx4 v23, s[20:23], s35 offen lds
  v_cvt_pk_bf16_f32 v69, v30, v31
  v_mfma_f32_16x16x32_bf16 v[36:39], a[164:167], a[32:35], v[36:39]
  s_add_u32 m0, s29, 130048
  v_exp_f32 v29, v29
  v_mfma_f32_16x16x32_bf16 v[36:39], a[160:163], a[12:15], v[36:39]
  s_mul_i32 s35, s39, 28672
  v_cvt_pk_bf16_f32 v68, v28, v29
  v_fma_f32 v33, v33, s32, v91
  v_mfma_f32_16x16x32_bf16 v[40:43], a[160:163], a[16:19], 0
  ds_write_b64 v7, v[68:69] offset:512
  v_mfma_f32_16x16x32_bf16 v[40:43], a[164:167], a[36:39], v[40:43]
  ds_read_b128 a[160:163], v4 offset:33792
  v_fma_f32 v32, v32, s32, v91
  v_mfma_f32_16x16x32_bf16 v[40:43], a[168:171], a[56:59], v[40:43]
  v_exp_f32 v33, v33
  v_mfma_f32_16x16x32_bf16 v[40:43], a[172:175], a[76:79], v[40:43]
  v_exp_f32 v32, v32
  v_mfma_f32_16x16x32_bf16 v[40:43], a[176:179], a[96:99], v[40:43]
  ds_read_b128 a[164:167], v4 offset:33856
  v_fma_f32 v35, v35, s32, v91
  v_mfma_f32_16x16x32_bf16 v[40:43], a[180:183], a[116:119], v[40:43]
  v_exp_f32 v35, v35
  v_mfma_f32_16x16x32_bf16 v[40:43], a[184:187], a[136:139], v[40:43]
  buffer_load_dwordx4 v1, s[16:19], s34 offen nt lds
  v_cvt_pk_bf16_f32 v72, v32, v33
  v_mfma_f32_16x16x32_bf16 v[40:43], a[188:191], a[156:159], v[40:43]
  s_waitcnt lgkmcnt(3)
  s_add_u32 m0, s29, 130080
  v_exp_f32 v34, v34
  v_mfma_f32_16x16x32_bf16 v[96:99], v[44:47], a[192:195], v[96:99]
  ds_read_b128 a[184:187], v4 offset:34176
  v_cvt_pk_bf16_f32 v73, v34, v35
  v_mfma_f32_16x16x32_bf16 v[100:103], v[48:51], a[192:195], v[100:103]
  ds_write_b64 v7, v[72:73] offset:1024
  v_mfma_f32_16x16x32_bf16 v[104:107], v[52:55], a[192:195], v[104:107]
  ds_read_b128 a[188:191], v4 offset:34240
  v_fma_f32 v36, v36, s32, v92
  v_mfma_f32_16x16x32_bf16 v[108:111], v[56:59], a[192:195], v[108:111]
  v_exp_f32 v36, v36
  v_mfma_f32_16x16x32_bf16 v[112:115], v[60:63], a[192:195], v[112:115]
  ds_read_b128 a[168:171], v4 offset:33920
  v_fma_f32 v38, v38, s32, v92
  v_mfma_f32_16x16x32_bf16 v[132:135], v[60:63], a[196:199], v[132:135]
  v_exp_f32 v38, v38
  v_mfma_f32_16x16x32_bf16 v[128:131], v[56:59], a[196:199], v[128:131]
  ds_read_b128 a[180:183], v4 offset:34112
  v_fma_f32 v39, v39, s32, v92
  v_mfma_f32_16x16x32_bf16 v[124:127], v[52:55], a[196:199], v[124:127]
  buffer_load_dwordx4 v1, s[16:19], s34 offen offset:1024 nt lds
  v_fma_f32 v37, v37, s32, v92
  v_mfma_f32_16x16x32_bf16 v[120:123], v[48:51], a[196:199], v[120:123]
  s_add_u32 m0, s29, 130112
  v_exp_f32 v39, v39
  v_mfma_f32_16x16x32_bf16 v[116:119], v[44:47], a[196:199], v[116:119]
  ds_read_b128 a[176:179], v4 offset:34048
  v_cvt_pk_bf16_f32 v77, v38, v39
  v_mfma_f32_16x16x32_bf16 v[136:139], v[44:47], a[200:203], v[136:139]
  v_exp_f32 v37, v37
  v_mfma_f32_16x16x32_bf16 v[140:143], v[48:51], a[200:203], v[140:143]
  ds_read_b128 a[172:175], v4 offset:33984
  v_cvt_pk_bf16_f32 v76, v36, v37
  v_mfma_f32_16x16x32_bf16 v[144:147], v[52:55], a[200:203], v[144:147]
  ds_write_b64 v7, v[76:77] offset:1536
  v_mfma_f32_16x16x32_bf16 v[148:151], v[56:59], a[200:203], v[148:151]
  v_fma_f32 v40, v40, s32, v93
  v_fma_f32 v43, v43, s32, v93
  v_mfma_f32_16x16x32_bf16 v[152:155], v[60:63], a[200:203], v[152:155]
  v_exp_f32 v43, v43
  v_mfma_f32_16x16x32_bf16 v[172:175], v[60:63], a[204:207], v[172:175]
  v_exp_f32 v40, v40
  v_mfma_f32_16x16x32_bf16 v[168:171], v[56:59], a[204:207], v[168:171]
  buffer_load_dwordx4 v1, s[16:19], s34 offen offset:2048 nt lds
  v_fma_f32 v42, v42, s32, v93
  v_mfma_f32_16x16x32_bf16 v[164:167], v[52:55], a[204:207], v[164:167]
  s_add_u32 m0, s29, 130144
  v_exp_f32 v42, v42
  v_mfma_f32_16x16x32_bf16 v[160:163], v[48:51], a[204:207], v[160:163]
  v_fma_f32 v41, v41, s32, v93
  v_cvt_pk_bf16_f32 v81, v42, v43
  v_mfma_f32_16x16x32_bf16 v[156:159], v[44:47], a[204:207], v[156:159]
  v_exp_f32 v41, v41
  v_mfma_f32_16x16x32_bf16 v[176:179], v[44:47], a[208:211], v[176:179]
  v_cvt_pk_bf16_f32 v80, v40, v41
  v_add_f32 v84, v84, v24
  v_mfma_f32_16x16x32_bf16 v[180:183], v[48:51], a[208:211], v[180:183]
  ds_write_b64 v7, v[80:81] offset:2048
  v_mfma_f32_16x16x32_bf16 v[184:187], v[52:55], a[208:211], v[184:187]
  v_add_f32 v84, v84, v25
  v_add_f32 v84, v84, v26
  v_mfma_f32_16x16x32_bf16 v[188:191], v[56:59], a[208:211], v[188:191]
  v_add_f32 v84, v84, v27
  v_add_f32 v85, v85, v28
  v_mfma_f32_16x16x32_bf16 v[192:195], v[60:63], a[208:211], v[192:195]
  v_add_f32 v85, v85, v29
  v_add_f32 v85, v85, v30
  v_mfma_f32_16x16x32_bf16 v[212:215], v[60:63], a[212:215], v[212:215]
  buffer_load_dwordx4 v1, s[16:19], s34 offen offset:3072 nt lds
  v_add_f32 v85, v85, v31
  v_mfma_f32_16x16x32_bf16 v[208:211], v[56:59], a[212:215], v[208:211]
  s_add_u32 m0, s31, 33792
  v_add_f32 v86, v86, v32
  v_add_f32 v86, v86, v33
  v_mfma_f32_16x16x32_bf16 v[204:207], v[52:55], a[212:215], v[204:207]
  v_add_f32 v86, v86, v34
  v_add_f32 v86, v86, v35
  v_mfma_f32_16x16x32_bf16 v[200:203], v[48:51], a[212:215], v[200:203]
  v_add_f32 v87, v87, v36
  v_add_f32 v87, v87, v37
  v_mfma_f32_16x16x32_bf16 v[196:199], v[44:47], a[212:215], v[196:199]
  v_add_f32 v87, v87, v38
  v_add_f32 v87, v87, v39
  v_mfma_f32_16x16x32_bf16 v[216:219], v[44:47], a[216:219], v[216:219]
  v_add_f32 v88, v88, v40
  v_add_f32 v88, v88, v41
  v_mfma_f32_16x16x32_bf16 v[220:223], v[48:51], a[216:219], v[220:223]
  v_add_f32 v88, v88, v42
  v_add_f32 v88, v88, v43
  v_mfma_f32_16x16x32_bf16 v[224:227], v[52:55], a[216:219], v[224:227]
  v_cmp_gt_u32 vcc, 1, v14
  v_and_b32 v11, 48, v0
  v_mfma_f32_16x16x32_bf16 v[228:231], v[56:59], a[216:219], v[228:231]
  s_cbranch_vccnz L_spin_arm
L_back_arm:
  v_and_b32 v10, 32, v0
  v_lshlrev_b32 v10, 2, v10
  v_mfma_f32_16x16x32_bf16 v[232:235], v[60:63], a[216:219], v[232:235]
  s_mul_i32 s54, s49, 16896
  v_xor_b32 v10, v10, v3
  v_lshrrev_b32 v10, 1, v10
  v_mfma_f32_16x16x32_bf16 v[252:255], v[60:63], a[220:223], v[252:255]
  s_waitcnt vmcnt(4) lgkmcnt(0)
  v_add_u32 v10, s31, v10
  v_add_u32 v10, 77824, v10
  v_mfma_f32_16x16x32_bf16 v[248:251], v[56:59], a[220:223], v[248:251]
  s_barrier
  ds_read_b64_tr_b16 a[192:193], v5 offset:0
  v_add_u32 v95, v95, v11
  v_mfma_f32_16x16x32_bf16 v[244:247], v[52:55], a[220:223], v[244:247]
  s_add_u32 s54, s54, 0
  ds_read_b64 v[70:71], v8 offset:512
  v_add_u32 v21, s54, v19
  v_mfma_f32_16x16x32_bf16 v[240:243], v[48:51], a[220:223], v[240:243]
  s_sub_u32 s54, 16896, s54
  ds_read_b64 v[66:67], v8 offset:0
  v_add_u32 v22, s54, v19
  v_mfma_f32_16x16x32_bf16 v[236:239], v[44:47], a[220:223], v[236:239]
  s_mul_i32 s54, s49, 16896
  ds_read_b64 v[74:75], v8 offset:1024
  v_and_b32 v11, 0xfffffd3f, v16
  v_mfma_f32_16x16x32_bf16 v[24:27], a[160:163], a[0:3], 0
  s_add_u32 s54, s54, 0
  buffer_load_dword v13, v9, s[20:23], s35 offen
  s_mov_b32 s35, 128
  v_mfma_f32_16x16x32_bf16 v[24:27], a[164:167], a[20:23], v[24:27]
  ds_read_b64_tr_b16 a[194:195], v6 offset:0
  v_mfma_f32_16x16x32_bf16 v[24:27], a[168:171], a[40:43], v[24:27]
  ds_read_b64 v[78:79], v8 offset:1536
  v_mfma_f32_16x16x32_bf16 v[24:27], a[172:175], a[60:63], v[24:27]
  buffer_load_dwordx4 v23, s[20:23], s35 offen lds
  s_add_u32 m0, s31, 34816
  v_mfma_f32_16x16x32_bf16 v[24:27], a[176:179], a[80:83], v[24:27]
  s_mov_b32 s35, 7296
  ds_read_b64 v[82:83], v8 offset:2048
  v_mfma_f32_16x16x32_bf16 v[24:27], a[180:183], a[100:103], v[24:27]
  ds_read_b64_tr_b16 a[196:197], v5 offset:32
  v_mfma_f32_16x16x32_bf16 v[24:27], a[184:187], a[120:123], v[24:27]
  ds_read_b64_tr_b16 a[198:199], v6 offset:32
  v_mfma_f32_16x16x32_bf16 v[24:27], a[188:191], a[140:143], v[24:27]
  ds_read_b64_tr_b16 a[200:201], v5 offset:64
  v_mfma_f32_16x16x32_bf16 v[28:31], a[188:191], a[144:147], 0
  ds_read_b64_tr_b16 a[202:203], v6 offset:64
  v_mfma_f32_16x16x32_bf16 v[28:31], a[184:187], a[124:127], v[28:31]
  ds_read_b64_tr_b16 a[206:207], v6 offset:96
  v_mfma_f32_16x16x32_bf16 v[28:31], a[180:183], a[104:107], v[28:31]
  s_lshl_b32 s50, s28, 11
  ds_read_b64_tr_b16 a[204:205], v5 offset:96
  v_fma_f32 v26, v26, s32, v89
  v_mfma_f32_16x16x32_bf16 v[28:31], a[176:179], a[84:87], v[28:31]
  s_add_u32 s50, s50, 2293760
  buffer_load_dwordx4 v23, s[20:23], s35 offen lds
  v_fma_f32 v25, v25, s32, v89
  v_mfma_f32_16x16x32_bf16 v[28:31], a[172:175], a[64:67], v[28:31]
  s_add_u32 m0, s31, 35840
  ds_read_b64_tr_b16 a[210:211], v6 offset:128
  v_fma_f32 v24, v24, s32, v89
  v_mfma_f32_16x16x32_bf16 v[28:31], a[168:171], a[44:47], v[28:31]
  s_mov_b32 s35, 14464
  v_exp_f32 v26, v26
  v_mfma_f32_16x16x32_bf16 v[28:31], a[164:167], a[24:27], v[28:31]
  s_lshl_b32 s51, s60, 7
  v_exp_f32 v24, v24
  v_mfma_f32_16x16x32_bf16 v[28:31], a[160:163], a[4:7], v[28:31]
  s_add_u32 s51, s51, s50
  v_exp_f32 v25, v25
  v_mfma_f32_16x16x32_bf16 v[32:35], a[160:163], a[8:11], 0
  s_lshr_b32 s46, s28, 1
  ds_read_b64_tr_b16 a[208:209], v5 offset:128
  v_fma_f32 v27, v27, s32, v89
  v_mfma_f32_16x16x32_bf16 v[32:35], a[164:167], a[28:31], v[32:35]
  s_mul_i32 s46, s46, 80
  ds_read_b64_tr_b16 a[214:215], v6 offset:160
  v_cvt_pk_bf16_f32 v44, v24, v25
  v_mfma_f32_16x16x32_bf16 v[32:35], a[168:171], a[48:51], v[32:35]
  s_mul_i32 s47, s39, 160
  v_exp_f32 v27, v27
  v_mfma_f32_16x16x32_bf16 v[32:35], a[172:175], a[68:71], v[32:35]
  s_add_u32 s46, s46, s47
  ds_read_b64_tr_b16 a[212:213], v5 offset:160
  v_cvt_pk_bf16_f32 v45, v26, v27
  v_mfma_f32_16x16x32_bf16 v[32:35], a[176:179], a[88:91], v[32:35]
  s_lshr_b32 s47, s61, 3
  buffer_load_dwordx4 v23, s[20:23], s35 offen lds
  v_fma_f32 v31, v31, s32, v90
  v_mfma_f32_16x16x32_bf16 v[32:35], a[180:183], a[108:111], v[32:35]
  s_mov_b32 s35, 21632
  ds_write_b64 v7, v[44:45] offset:10240
  v_mfma_f32_16x16x32_bf16 v[32:35], a[184:187], a[128:131], v[32:35]
  s_add_u32 m0, s31, 36864
  ds_read_b64_tr_b16 a[218:219], v6 offset:192
  v_fma_f32 v30, v30, s32, v90
  v_mfma_f32_16x16x32_bf16 v[32:35], a[188:191], a[148:151], v[32:35]
  s_mul_i32 s47, s47, 896
  ds_read_b64_tr_b16 a[216:217], v5 offset:192
  v_fma_f32 v28, v28, s32, v90
  v_mfma_f32_16x16x32_bf16 v[36:39], a[188:191], a[152:155], 0
  s_mul_i32 s46, s46, 1792
  v_exp_f32 v28, v28
  v_mfma_f32_16x16x32_bf16 v[36:39], a[184:187], a[132:135], v[36:39]
  s_add_u32 s46, s46, s47
  v_exp_f32 v31, v31
  v_mfma_f32_16x16x32_bf16 v[36:39], a[180:183], a[112:115], v[36:39]
  s_lshl_b32 s47, s49, 6
  v_exp_f32 v30, v30
  v_mfma_f32_16x16x32_bf16 v[36:39], a[176:179], a[92:95], v[36:39]
  s_add_u32 s46, s46, s47
  ds_read_b64_tr_b16 a[222:223], v6 offset:224
  v_fma_f32 v29, v29, s32, v90
  v_mfma_f32_16x16x32_bf16 v[36:39], a[172:175], a[72:75], v[36:39]
  s_mul_i32 s47, s60, 52
  v_exp_f32 v29, v29
  v_mfma_f32_16x16x32_bf16 v[36:39], a[168:171], a[52:55], v[36:39]
  s_lshr_b32 s47, s47, 8
  buffer_load_dwordx4 v23, s[20:23], s35 offen lds
  v_cvt_pk_bf16_f32 v48, v28, v29
  v_mfma_f32_16x16x32_bf16 v[36:39], a[164:167], a[32:35], v[36:39]
  s_mov_b32 s35, 114816
  ds_read_b64_tr_b16 a[220:221], v5 offset:224
  v_cvt_pk_bf16_f32 v49, v30, v31
  v_mfma_f32_16x16x32_bf16 v[36:39], a[160:163], a[12:15], v[36:39]
  s_add_u32 m0, s31, 50688
  ds_write_b64 v7, v[48:49] offset:10752
  v_mfma_f32_16x16x32_bf16 v[40:43], a[160:163], a[16:19], 0
  s_lshl_b32 s52, s60, 10
  ds_read_b128 a[160:163], v4 offset:50688
  v_fma_f32 v32, v32, s32, v91
  v_mfma_f32_16x16x32_bf16 v[40:43], a[164:167], a[36:39], v[40:43]
  s_add_u32 s45, s60, 1
  ds_read_b128 a[164:167], v4 offset:50752
  v_fma_f32 v35, v35, s32, v91
  v_mfma_f32_16x16x32_bf16 v[40:43], a[168:171], a[56:59], v[40:43]
  s_lshr_b32 s45, s45, 4
  v_exp_f32 v32, v32
  v_mfma_f32_16x16x32_bf16 v[40:43], a[172:175], a[76:79], v[40:43]
  s_mul_i32 s53, s60, 28672
  ds_read_b128 a[172:175], v4 offset:50880
  v_fma_f32 v34, v34, s32, v91
  v_mfma_f32_16x16x32_bf16 v[40:43], a[176:179], a[96:99], v[40:43]
  s_mul_i32 s47, s47, -143232
  v_exp_f32 v34, v34
  v_mfma_f32_16x16x32_bf16 v[40:43], a[180:183], a[116:119], v[40:43]
  s_add_u32 s53, s53, s47
  v_exp_f32 v35, v35
  v_mfma_f32_16x16x32_bf16 v[40:43], a[184:187], a[136:139], v[40:43]
  s_add_u32 s53, s53, s46
  ds_read_b128 a[180:183], v4 offset:51008
  v_fma_f32 v33, v33, s32, v91
  v_mfma_f32_16x16x32_bf16 v[40:43], a[188:191], a[156:159], v[40:43]
  s_waitcnt lgkmcnt(4)
  s_mul_i32 s44, s28, 35840
  v_exp_f32 v33, v33
  v_mfma_f32_16x16x32_bf16 v[96:99], v[64:67], a[192:195], v[96:99]
  s_add_u32 s52, s52, s44
  ds_read_b128 a[188:191], v4 offset:51136
  v_cvt_pk_bf16_f32 v52, v32, v33
  v_mfma_f32_16x16x32_bf16 v[100:103], v[68:71], a[192:195], v[100:103]
  s_lshl_b32 s45, s45, 30
  ds_read_b128 a[184:187], v4 offset:51072
  v_cvt_pk_bf16_f32 v53, v34, v35
  v_mfma_f32_16x16x32_bf16 v[104:107], v[72:75], a[192:195], v[104:107]
  s_add_u32 s52, s52, s45
  ds_write_b64 v7, v[52:53] offset:11264
  v_mfma_f32_16x16x32_bf16 v[108:111], v[76:79], a[192:195], v[108:111]
  s_add_u32 s53, s53, s45
  ds_read_b128 a[176:179], v4 offset:50944
  v_fma_f32 v37, v37, s32, v92
  v_mfma_f32_16x16x32_bf16 v[112:115], v[80:83], a[192:195], v[112:115]
  s_mov_b32 s48, s52
  v_exp_f32 v37, v37
  v_mfma_f32_16x16x32_bf16 v[132:135], v[80:83], a[196:199], v[132:135]
  ds_read_b128 a[168:171], v4 offset:50816
  v_fma_f32 v38, v38, s32, v92
  v_mfma_f32_16x16x32_bf16 v[128:131], v[76:79], a[196:199], v[128:131]
  ds_read_b64_tr_b16 a[224:225], v21 offset:0
  v_fma_f32 v36, v36, s32, v92
  v_mfma_f32_16x16x32_bf16 v[124:127], v[72:75], a[196:199], v[124:127]
  v_exp_f32 v38, v38
  v_mfma_f32_16x16x32_bf16 v[120:123], v[68:71], a[196:199], v[120:123]
  v_exp_f32 v36, v36
  v_mfma_f32_16x16x32_bf16 v[116:119], v[64:67], a[196:199], v[116:119]
  ds_read_b64_tr_b16 a[234:235], v21 offset:10240
  v_cvt_pk_bf16_f32 v56, v36, v37
  v_mfma_f32_16x16x32_bf16 v[136:139], v[64:67], a[200:203], v[136:139]
  ds_read_b64_tr_b16 a[238:239], v21 offset:14336
  v_fma_f32 v39, v39, s32, v92
  v_mfma_f32_16x16x32_bf16 v[140:143], v[68:71], a[200:203], v[140:143]
  v_exp_f32 v39, v39
  v_mfma_f32_16x16x32_bf16 v[144:147], v[72:75], a[200:203], v[144:147]
  ds_read_b64_tr_b16 a[240:241], v22 offset:0
  v_cvt_pk_bf16_f32 v57, v38, v39
  v_mfma_f32_16x16x32_bf16 v[148:151], v[76:79], a[200:203], v[148:151]
  ds_write_b64 v7, v[56:57] offset:11776
  v_mfma_f32_16x16x32_bf16 v[152:155], v[80:83], a[200:203], v[152:155]
  ds_read_b64_tr_b16 a[236:237], v21 offset:12288
  v_fma_f32 v41, v41, s32, v93
  v_mfma_f32_16x16x32_bf16 v[172:175], v[80:83], a[204:207], v[172:175]
  ds_read_b64_tr_b16 a[226:227], v21 offset:2048
  v_fma_f32 v40, v40, s32, v93
  v_mfma_f32_16x16x32_bf16 v[168:171], v[76:79], a[204:207], v[168:171]
  ds_read_b64_tr_b16 a[244:245], v22 offset:4096
  v_fma_f32 v43, v43, s32, v93
  v_mfma_f32_16x16x32_bf16 v[164:167], v[72:75], a[204:207], v[164:167]
  v_exp_f32 v41, v41
  v_mfma_f32_16x16x32_bf16 v[160:163], v[68:71], a[204:207], v[160:163]
  ds_read_b64_tr_b16 a[242:243], v22 offset:2048
  v_fma_f32 v42, v42, s32, v93
  v_mfma_f32_16x16x32_bf16 v[156:159], v[64:67], a[204:207], v[156:159]
  v_exp_f32 v43, v43
  v_mfma_f32_16x16x32_bf16 v[176:179], v[64:67], a[208:211], v[176:179]
  v_exp_f32 v40, v40
  v_mfma_f32_16x16x32_bf16 v[180:183], v[68:71], a[208:211], v[180:183]
  v_exp_f32 v42, v42
  v_mfma_f32_16x16x32_bf16 v[184:187], v[72:75], a[208:211], v[184:187]
  ds_read_b64_tr_b16 a[248:249], v22 offset:8192
  v_cvt_pk_bf16_f32 v61, v42, v43
  v_mfma_f32_16x16x32_bf16 v[188:191], v[76:79], a[208:211], v[188:191]
  ds_read_b64_tr_b16 a[250:251], v22 offset:10240
  v_cvt_pk_bf16_f32 v60, v40, v41
  v_mfma_f32_16x16x32_bf16 v[192:195], v[80:83], a[208:211], v[192:195]
  ds_write_b64 v7, v[60:61] offset:12288
  v_mfma_f32_16x16x32_bf16 v[212:215], v[80:83], a[212:215], v[212:215]
  ds_read_b64_tr_b16 a[252:253], v22 offset:12288
  v_add_f32 v84, v84, v24
  v_mfma_f32_16x16x32_bf16 v[208:211], v[76:79], a[212:215], v[208:211]
  ds_read_b64_tr_b16 a[230:231], v21 offset:6144
  v_add_f32 v84, v84, v25
  v_mfma_f32_16x16x32_bf16 v[204:207], v[72:75], a[212:215], v[204:207]
  ds_read_b64_tr_b16 a[228:229], v21 offset:4096
  v_add_f32 v84, v84, v26
  v_mfma_f32_16x16x32_bf16 v[200:203], v[68:71], a[212:215], v[200:203]
  ds_read_b64_tr_b16 a[232:233], v21 offset:8192
  v_add_f32 v84, v84, v27
  v_mfma_f32_16x16x32_bf16 v[196:199], v[64:67], a[212:215], v[196:199]
  ds_read_b64_tr_b16 a[254:255], v22 offset:14336
  v_add_f32 v85, v85, v28
  v_mfma_f32_16x16x32_bf16 v[216:219], v[64:67], a[216:219], v[216:219]
  ds_read_b64_tr_b16 a[246:247], v22 offset:6144
  v_add_f32 v85, v85, v29
  v_mfma_f32_16x16x32_bf16 v[220:223], v[68:71], a[216:219], v[220:223]
  v_add_f32 v85, v85, v30
  v_add_f32 v85, v85, v31
  v_mfma_f32_16x16x32_bf16 v[224:227], v[72:75], a[216:219], v[224:227]
  v_add_f32 v86, v86, v32
  v_add_f32 v86, v86, v33
  v_mfma_f32_16x16x32_bf16 v[228:231], v[76:79], a[216:219], v[228:231]
  v_add_f32 v86, v86, v34
  v_add_f32 v86, v86, v35
  v_mfma_f32_16x16x32_bf16 v[232:235], v[80:83], a[216:219], v[232:235]
  v_add_f32 v87, v87, v36
  v_add_f32 v87, v87, v37
  v_mfma_f32_16x16x32_bf16 v[252:255], v[80:83], a[220:223], v[252:255]
  s_waitcnt lgkmcnt(6)
  v_add_f32 v87, v87, v38
  v_add_f32 v87, v87, v39
  v_mfma_f32_16x16x32_bf16 v[248:251], v[76:79], a[220:223], v[248:251]
  s_barrier
  ds_read_b64_tr_b16 a[192:193], v5 offset:16896
  v_add_f32 v88, v88, v40
  v_mfma_f32_16x16x32_bf16 v[244:247], v[72:75], a[220:223], v[244:247]
  ds_read_b64_tr_b16 a[194:195], v6 offset:16896
  v_add_f32 v88, v88, v41
  v_mfma_f32_16x16x32_bf16 v[240:243], v[68:71], a[220:223], v[240:243]
  ds_read_b64 v[46:47], v8 offset:10240
  v_add_f32 v88, v88, v42
  v_mfma_f32_16x16x32_bf16 v[236:239], v[64:67], a[220:223], v[236:239]
  ds_read_b64 v[50:51], v8 offset:10752
  v_add_f32 v88, v88, v43
  v_mfma_f32_16x16x32_bf16 v[24:27], a[160:163], a[0:3], 0
  ds_read_b64 v[54:55], v8 offset:11264
  v_add_u32 v21, s54, v20
  v_mfma_f32_16x16x32_bf16 v[24:27], a[164:167], a[20:23], v[24:27]
  s_sub_u32 s54, 16896, s54
  ds_read_b64 v[58:59], v8 offset:11776
  v_add_u32 v22, s54, v20
  v_mfma_f32_16x16x32_bf16 v[24:27], a[168:171], a[40:43], v[24:27]
  s_mul_i32 s54, s49, 16896
  buffer_load_dwordx4 v23, s[20:23], s35 offen lds
  s_mov_b32 s35, 121984
  v_mfma_f32_16x16x32_bf16 v[24:27], a[172:175], a[60:63], v[24:27]
  s_add_u32 m0, s31, 51712
  ds_read_b64 v[62:63], v8 offset:12288
  s_add_u32 s54, s54, 33792
  v_mfma_f32_16x16x32_bf16 v[24:27], a[176:179], a[80:83], v[24:27]
  ds_read_b64_tr_b16 a[198:199], v6 offset:16928
  v_mfma_f32_16x16x32_bf16 v[24:27], a[180:183], a[100:103], v[24:27]
  ds_read_b64_tr_b16 a[196:197], v5 offset:16928
  v_mfma_f32_16x16x32_bf16 v[24:27], a[184:187], a[120:123], v[24:27]
  ds_read_b64_tr_b16 a[200:201], v5 offset:16960
  v_mfma_f32_16x16x32_bf16 v[24:27], a[188:191], a[140:143], v[24:27]
  ds_read_b64_tr_b16 a[202:203], v6 offset:16960
  v_mfma_f32_16x16x32_bf16 v[28:31], a[188:191], a[144:147], 0
  ds_read_b64_tr_b16 a[204:205], v5 offset:16992
  v_mfma_f32_16x16x32_bf16 v[28:31], a[184:187], a[124:127], v[28:31]
  ds_read_b64_tr_b16 a[206:207], v6 offset:16992
  v_mfma_f32_16x16x32_bf16 v[28:31], a[180:183], a[104:107], v[28:31]
  ds_read_b64_tr_b16 a[208:209], v5 offset:17024
  v_mfma_f32_16x16x32_bf16 v[28:31], a[176:179], a[84:87], v[28:31]
  buffer_load_dwordx4 v23, s[20:23], s35 offen lds
  v_fma_f32 v26, v26, s32, v89
  v_mfma_f32_16x16x32_bf16 v[28:31], a[172:175], a[64:67], v[28:31]
  s_add_u32 m0, s31, 52736
  ds_read_b64_tr_b16 a[210:211], v6 offset:17024
  v_fma_f32 v27, v27, s32, v89
  v_mfma_f32_16x16x32_bf16 v[28:31], a[168:171], a[44:47], v[28:31]
  s_mov_b32 s35, 129152
  v_exp_f32 v27, v27
  v_mfma_f32_16x16x32_bf16 v[28:31], a[164:167], a[24:27], v[28:31]
  v_exp_f32 v26, v26
  v_mfma_f32_16x16x32_bf16 v[28:31], a[160:163], a[4:7], v[28:31]
  ds_read_b64_tr_b16 a[214:215], v6 offset:17056
  v_fma_f32 v24, v24, s32, v89
  v_mfma_f32_16x16x32_bf16 v[32:35], a[160:163], a[8:11], 0
  v_exp_f32 v24, v24
  v_mfma_f32_16x16x32_bf16 v[32:35], a[164:167], a[28:31], v[32:35]
  ds_read_b64_tr_b16 a[212:213], v5 offset:17056
  v_fma_f32 v25, v25, s32, v89
  v_mfma_f32_16x16x32_bf16 v[32:35], a[168:171], a[48:51], v[32:35]
  v_exp_f32 v25, v25
  v_mfma_f32_16x16x32_bf16 v[32:35], a[172:175], a[68:71], v[32:35]
  ds_read_b64_tr_b16 a[218:219], v6 offset:17088
  v_cvt_pk_bf16_f32 v64, v24, v25
  v_mfma_f32_16x16x32_bf16 v[32:35], a[176:179], a[88:91], v[32:35]
  buffer_load_dwordx4 v23, s[20:23], s35 offen lds
  v_cvt_pk_bf16_f32 v65, v26, v27
  v_mfma_f32_16x16x32_bf16 v[32:35], a[180:183], a[108:111], v[32:35]
  s_add_u32 m0, s31, 53760
  ds_write_b64 v7, v[64:65] offset:0
  v_mfma_f32_16x16x32_bf16 v[32:35], a[184:187], a[128:131], v[32:35]
  s_mov_b32 s35, 136320
  ds_read_b64_tr_b16 a[216:217], v5 offset:17088
  v_fma_f32 v31, v31, s32, v90
  v_mfma_f32_16x16x32_bf16 v[32:35], a[188:191], a[148:151], v[32:35]
  v_exp_f32 v31, v31
  v_mfma_f32_16x16x32_bf16 v[36:39], a[188:191], a[152:155], 0
  ds_read_b64_tr_b16 a[222:223], v6 offset:17120
  v_fma_f32 v28, v28, s32, v90
  v_mfma_f32_16x16x32_bf16 v[36:39], a[184:187], a[132:135], v[36:39]
  ds_read_b64_tr_b16 a[220:221], v5 offset:17120
  v_fma_f32 v30, v30, s32, v90
  v_mfma_f32_16x16x32_bf16 v[36:39], a[180:183], a[112:115], v[36:39]
  v_exp_f32 v30, v30
  v_mfma_f32_16x16x32_bf16 v[36:39], a[176:179], a[92:95], v[36:39]
  v_fma_f32 v29, v29, s32, v90
  v_cvt_pk_bf16_f32 v69, v30, v31
  v_mfma_f32_16x16x32_bf16 v[36:39], a[172:175], a[72:75], v[36:39]
  v_exp_f32 v29, v29
  v_mfma_f32_16x16x32_bf16 v[36:39], a[168:171], a[52:55], v[36:39]
  buffer_load_dwordx4 v23, s[20:23], s35 offen lds
  v_fma_f32 v33, v33, s32, v91
  v_mfma_f32_16x16x32_bf16 v[36:39], a[164:167], a[32:35], v[36:39]
  s_mov_b32 s35, 256
  v_exp_f32 v28, v28
  v_mfma_f32_16x16x32_bf16 v[36:39], a[160:163], a[12:15], v[36:39]
  s_add_u32 m0, s31, 0
  v_cvt_pk_bf16_f32 v68, v28, v29
  v_fma_f32 v34, v34, s32, v91
  v_mfma_f32_16x16x32_bf16 v[40:43], a[160:163], a[16:19], 0
  ds_write_b64 v7, v[68:69] offset:512
  v_mfma_f32_16x16x32_bf16 v[40:43], a[164:167], a[36:39], v[40:43]
  v_fma_f32 v35, v35, s32, v91
  v_fma_f32 v32, v32, s32, v91
  v_mfma_f32_16x16x32_bf16 v[40:43], a[168:171], a[56:59], v[40:43]
  v_exp_f32 v35, v35
  v_mfma_f32_16x16x32_bf16 v[40:43], a[172:175], a[76:79], v[40:43]
  v_exp_f32 v33, v33
  v_mfma_f32_16x16x32_bf16 v[40:43], a[176:179], a[96:99], v[40:43]
  v_exp_f32 v32, v32
  v_mfma_f32_16x16x32_bf16 v[40:43], a[180:183], a[116:119], v[40:43]
  v_exp_f32 v34, v34
  v_mfma_f32_16x16x32_bf16 v[40:43], a[184:187], a[136:139], v[40:43]
  v_cvt_pk_bf16_f32 v72, v32, v33
  v_cvt_pk_bf16_f32 v73, v34, v35
  v_mfma_f32_16x16x32_bf16 v[40:43], a[188:191], a[156:159], v[40:43]
  s_waitcnt lgkmcnt(1)
  ds_write_b64 v7, v[72:73] offset:1024
  v_mfma_f32_16x16x32_bf16 v[96:99], v[44:47], a[192:195], v[96:99]
  s_waitcnt vmcnt(9)
  v_fma_f32 v36, v36, s32, v92
  s_barrier
  v_mfma_f32_16x16x32_bf16 v[100:103], v[48:51], a[192:195], v[100:103]
  v_exp_f32 v36, v36
  v_mfma_f32_16x16x32_bf16 v[104:107], v[52:55], a[192:195], v[104:107]
  ds_read_b64_tr_b16 a[172:173], v5 offset:33888
  v_fma_f32 v39, v39, s32, v92
  v_mfma_f32_16x16x32_bf16 v[108:111], v[56:59], a[192:195], v[108:111]
  ds_read_b64_tr_b16 a[168:169], v5 offset:33856
  v_fma_f32 v37, v37, s32, v92
  v_mfma_f32_16x16x32_bf16 v[112:115], v[60:63], a[192:195], v[112:115]
  v_exp_f32 v39, v39
  v_mfma_f32_16x16x32_bf16 v[132:135], v[60:63], a[196:199], v[132:135]
  ds_read_b64_tr_b16 a[186:187], v6 offset:33984
  v_fma_f32 v38, v38, s32, v92
  v_mfma_f32_16x16x32_bf16 v[128:131], v[56:59], a[196:199], v[128:131]
  v_exp_f32 v38, v38
  v_mfma_f32_16x16x32_bf16 v[124:127], v[52:55], a[196:199], v[124:127]
  ds_read_b64_tr_b16 a[166:167], v6 offset:33824
  v_cvt_pk_bf16_f32 v77, v38, v39
  v_mfma_f32_16x16x32_bf16 v[120:123], v[48:51], a[196:199], v[120:123]
  v_exp_f32 v37, v37
  v_mfma_f32_16x16x32_bf16 v[116:119], v[44:47], a[196:199], v[116:119]
  ds_read_b64_tr_b16 a[176:177], v5 offset:33920
  v_cvt_pk_bf16_f32 v76, v36, v37
  v_mfma_f32_16x16x32_bf16 v[136:139], v[44:47], a[200:203], v[136:139]
  ds_write_b64 v7, v[76:77] offset:1536
  v_mfma_f32_16x16x32_bf16 v[140:143], v[48:51], a[200:203], v[140:143]
  ds_read_b64_tr_b16 a[190:191], v6 offset:34016
  v_fma_f32 v41, v41, s32, v93
  v_mfma_f32_16x16x32_bf16 v[144:147], v[52:55], a[200:203], v[144:147]
  v_exp_f32 v41, v41
  v_mfma_f32_16x16x32_bf16 v[148:151], v[56:59], a[200:203], v[148:151]
  ds_read_b64_tr_b16 a[178:179], v6 offset:33920
  v_fma_f32 v43, v43, s32, v93
  v_mfma_f32_16x16x32_bf16 v[152:155], v[60:63], a[200:203], v[152:155]
  v_exp_f32 v43, v43
  v_mfma_f32_16x16x32_bf16 v[172:175], v[60:63], a[204:207], v[172:175]
  ds_read_b64_tr_b16 a[180:181], v5 offset:33952
  v_fma_f32 v40, v40, s32, v93
  v_mfma_f32_16x16x32_bf16 v[168:171], v[56:59], a[204:207], v[168:171]
  v_exp_f32 v40, v40
  v_mfma_f32_16x16x32_bf16 v[164:167], v[52:55], a[204:207], v[164:167]
  ds_read_b64_tr_b16 a[162:163], v6 offset:33792
  v_cvt_pk_bf16_f32 v80, v40, v41
  v_mfma_f32_16x16x32_bf16 v[160:163], v[48:51], a[204:207], v[160:163]
  ds_read_b64_tr_b16 a[188:189], v5 offset:34016
  v_fma_f32 v42, v42, s32, v93
  v_mfma_f32_16x16x32_bf16 v[156:159], v[44:47], a[204:207], v[156:159]
  v_exp_f32 v42, v42
  v_mfma_f32_16x16x32_bf16 v[176:179], v[44:47], a[208:211], v[176:179]
  ds_read_b64_tr_b16 a[164:165], v5 offset:33824
  v_cvt_pk_bf16_f32 v81, v42, v43
  v_mfma_f32_16x16x32_bf16 v[180:183], v[48:51], a[208:211], v[180:183]
  ds_read_b64_tr_b16 a[160:161], v5 offset:33792
  v_add_f32 v84, v84, v24
  v_mfma_f32_16x16x32_bf16 v[184:187], v[52:55], a[208:211], v[184:187]
  ds_read_b64_tr_b16 a[170:171], v6 offset:33856
  v_add_f32 v84, v84, v25
  v_mfma_f32_16x16x32_bf16 v[188:191], v[56:59], a[208:211], v[188:191]
  ds_read_b64_tr_b16 a[174:175], v6 offset:33888
  v_add_f32 v84, v84, v26
  v_mfma_f32_16x16x32_bf16 v[192:195], v[60:63], a[208:211], v[192:195]
  ds_read_b64_tr_b16 a[182:183], v6 offset:33952
  v_add_f32 v84, v84, v27
  v_mfma_f32_16x16x32_bf16 v[212:215], v[60:63], a[212:215], v[212:215]
  ds_write_b64 v7, v[80:81] offset:2048
  v_mfma_f32_16x16x32_bf16 v[208:211], v[56:59], a[212:215], v[208:211]
  ds_read_b64_tr_b16 a[184:185], v5 offset:33984
  v_add_f32 v87, v87, v36
  v_mfma_f32_16x16x32_bf16 v[204:207], v[52:55], a[212:215], v[204:207]
  ds_read_b64_tr_b16 a[202:203], v21 offset:10240
  v_add_f32 v87, v87, v37
  v_mfma_f32_16x16x32_bf16 v[200:203], v[48:51], a[212:215], v[200:203]
  ds_read_b64_tr_b16 a[210:211], v22 offset:2048
  v_add_f32 v85, v85, v28
  v_mfma_f32_16x16x32_bf16 v[196:199], v[44:47], a[212:215], v[196:199]
  ds_read_b64_tr_b16 a[196:197], v21 offset:4096
  v_add_f32 v87, v87, v38
  v_mfma_f32_16x16x32_bf16 v[216:219], v[44:47], a[216:219], v[216:219]
  ds_read_b64_tr_b16 a[204:205], v21 offset:12288
  v_add_f32 v85, v85, v29
  v_mfma_f32_16x16x32_bf16 v[220:223], v[48:51], a[216:219], v[220:223]
  ds_read_b64_tr_b16 a[212:213], v22 offset:4096
  v_add_f32 v85, v85, v30
  v_mfma_f32_16x16x32_bf16 v[224:227], v[52:55], a[216:219], v[224:227]
  s_waitcnt lgkmcnt(5)
  ds_read_b64_tr_b16 a[206:207], v21 offset:14336
  s_barrier
  v_mfma_f32_16x16x32_bf16 v[228:231], v[56:59], a[216:219], v[228:231]
  ds_read_b64 v[66:67], v8 offset:0
  v_add_f32 v88, v88, v40
  v_mfma_f32_16x16x32_bf16 v[232:235], v[60:63], a[216:219], v[232:235]
  ds_read_b64 v[70:71], v8 offset:512
  v_add_f32 v87, v87, v39
  v_mfma_f32_16x16x32_bf16 v[252:255], v[60:63], a[220:223], v[252:255]
  ds_read_b64_tr_b16 a[216:217], v22 offset:8192
  v_add_f32 v86, v86, v32
  v_mfma_f32_16x16x32_bf16 v[248:251], v[56:59], a[220:223], v[248:251]
  ds_read_b64_tr_b16 a[214:215], v22 offset:6144
  v_add_f32 v88, v88, v41
  v_mfma_f32_16x16x32_bf16 v[244:247], v[52:55], a[220:223], v[244:247]
  ds_read_b64_tr_b16 a[192:193], v21 offset:0
  v_add_f32 v88, v88, v42
  v_mfma_f32_16x16x32_bf16 v[240:243], v[48:51], a[220:223], v[240:243]
  ds_read_b64_tr_b16 a[208:209], v22 offset:0
  v_add_f32 v88, v88, v43
  v_mfma_f32_16x16x32_bf16 v[236:239], v[44:47], a[220:223], v[236:239]
  s_waitcnt lgkmcnt(5)
  ds_read_b64_tr_b16 a[222:223], v22 offset:14336
  v_add_f32 v85, v85, v31
  v_mfma_f32_16x16x32_bf16 v[96:99], v[64:67], a[160:163], v[96:99]
  ds_read_b64_tr_b16 a[220:221], v22 offset:12288
  v_add_f32 v86, v86, v33
  v_mfma_f32_16x16x32_bf16 v[116:119], v[64:67], a[164:167], v[116:119]
  ds_read_b64_tr_b16 a[198:199], v21 offset:6144
  v_add_f32 v86, v86, v34
  v_mfma_f32_16x16x32_bf16 v[136:139], v[64:67], a[168:171], v[136:139]
  ds_read_b64_tr_b16 a[200:201], v21 offset:8192
  v_add_f32 v86, v86, v35
  v_mfma_f32_16x16x32_bf16 v[156:159], v[64:67], a[172:175], v[156:159]
  ds_read_b64_tr_b16 a[218:219], v22 offset:10240
  v_cvt_pk_bf16_f32 v96, v96, v97
  v_mfma_f32_16x16x32_bf16 v[176:179], v[64:67], a[176:179], v[176:179]
  ds_read_b64 v[74:75], v8 offset:1024
  v_cvt_pk_bf16_f32 v116, v116, v117
  v_mfma_f32_16x16x32_bf16 v[196:199], v[64:67], a[180:183], v[196:199]
  ds_read_b64_tr_b16 a[194:195], v21 offset:2048
  v_cvt_pk_bf16_f32 v136, v136, v137
  v_mfma_f32_16x16x32_bf16 v[216:219], v[64:67], a[184:187], v[216:219]
  ds_read_b64 v[78:79], v8 offset:1536
  v_cvt_pk_bf16_f32 v117, v118, v119
  v_mfma_f32_16x16x32_bf16 v[236:239], v[64:67], a[188:191], v[236:239]
  s_waitcnt lgkmcnt(7)
  ds_read_b64 v[82:83], v8 offset:2048
  v_cvt_pk_bf16_f32 v97, v98, v99
  v_mfma_f32_16x16x32_bf16 v[100:103], v[68:71], a[160:163], v[100:103]
  ds_write_b64 v10, v[96:97] offset:0
  v_mfma_f32_16x16x32_bf16 v[120:123], v[68:71], a[164:167], v[120:123]
  ds_write_b64 v10, v[116:117] offset:512
  v_mfma_f32_16x16x32_bf16 v[140:143], v[68:71], a[168:171], v[140:143]
  ds_read_b64_tr_b16 v[98:99], v17 offset:512
  v_cvt_pk_bf16_f32 v137, v138, v139
  v_mfma_f32_16x16x32_bf16 v[160:163], v[68:71], a[172:175], v[160:163]
  ds_write_b64 v10, v[136:137] offset:1024
  v_mfma_f32_16x16x32_bf16 v[180:183], v[68:71], a[176:179], v[180:183]
  ds_read_b64_tr_b16 v[136:137], v17 offset:1024
  v_cvt_pk_bf16_f32 v156, v156, v157
  v_mfma_f32_16x16x32_bf16 v[200:203], v[68:71], a[180:183], v[200:203]
  ds_read_b64_tr_b16 v[96:97], v17 offset:0
  v_cvt_pk_bf16_f32 v157, v158, v159
  v_mfma_f32_16x16x32_bf16 v[220:223], v[68:71], a[184:187], v[220:223]
  ds_write_b64 v10, v[156:157] offset:1536
  v_mfma_f32_16x16x32_bf16 v[240:243], v[68:71], a[188:191], v[240:243]
  s_waitcnt lgkmcnt(7)
  ds_read_b64_tr_b16 v[138:139], v17 offset:1536
  v_cvt_pk_bf16_f32 v196, v196, v197
  v_mfma_f32_16x16x32_bf16 v[104:107], v[72:75], a[160:163], v[104:107]
  v_cvt_pk_bf16_f32 v197, v198, v199
  v_cvt_pk_bf16_f32 v176, v176, v177
  v_mfma_f32_16x16x32_bf16 v[124:127], v[72:75], a[164:167], v[124:127]
  ds_write_b64 v10, v[196:197] offset:2560
  v_mfma_f32_16x16x32_bf16 v[144:147], v[72:75], a[168:171], v[144:147]
  v_cvt_pk_bf16_f32 v177, v178, v179
  v_cvt_pk_bf16_f32 v216, v216, v217
  v_mfma_f32_16x16x32_bf16 v[164:167], v[72:75], a[172:175], v[164:167]
  ds_read_b64_tr_b16 v[178:179], v17 offset:2560
  v_cvt_pk_bf16_f32 v217, v218, v219
  v_mfma_f32_16x16x32_bf16 v[184:187], v[72:75], a[176:179], v[184:187]
  ds_write_b64 v10, v[176:177] offset:2048
  v_mfma_f32_16x16x32_bf16 v[204:207], v[72:75], a[180:183], v[204:207]
  ds_write_b64 v10, v[216:217] offset:3072
  v_mfma_f32_16x16x32_bf16 v[224:227], v[72:75], a[184:187], v[224:227]
  ds_read_b64_tr_b16 v[216:217], v17 offset:3072
  v_cvt_pk_bf16_f32 v236, v236, v237
  v_mfma_f32_16x16x32_bf16 v[244:247], v[72:75], a[188:191], v[244:247]
  s_waitcnt lgkmcnt(5)
  ds_read_b64_tr_b16 v[176:177], v17 offset:2048
  v_cvt_pk_bf16_f32 v237, v238, v239
  v_mfma_f32_16x16x32_bf16 v[24:27], a[224:227], v[96:99], 0
  ds_write_b64 v10, v[236:237] offset:3584
  v_mfma_f32_16x16x32_bf16 v[24:27], a[228:231], v[136:139], v[24:27]
  s_waitcnt lgkmcnt(1)
  ds_read_b64_tr_b16 v[218:219], v17 offset:3584
  v_cvt_pk_bf16_f32 v200, v200, v201
  v_cvt_pk_bf16_f32 v120, v120, v121
  v_cvt_pk_bf16_f32 v180, v180, v181
  v_cvt_pk_bf16_f32 v160, v160, v161
  v_cvt_pk_bf16_f32 v161, v162, v163
  v_cvt_pk_bf16_f32 v100, v100, v101
  ds_write_b64 v10, v[160:161] offset:17920
  v_cvt_pk_bf16_f32 v101, v102, v103
  v_cvt_pk_bf16_f32 v201, v202, v203
  v_mfma_f32_16x16x32_bf16 v[24:27], a[232:235], v[176:179], v[24:27]
  s_waitcnt lgkmcnt(1)
  v_cvt_pk_bf16_f32 v220, v220, v221
  v_cvt_pk_bf16_f32 v140, v140, v141
  v_cvt_pk_bf16_f32 v141, v142, v143
  ds_read_b64_tr_b16 v[142:143], v17 offset:17920
  ds_write_b64 v10, v[100:101] offset:16384
  v_mfma_f32_16x16x32_bf16 v[24:27], a[236:239], v[216:219], v[24:27]
  ds_write_b64 v10, v[140:141] offset:17408
  v_mfma_f32_16x16x32_bf16 v[44:47], a[192:195], v[96:99], 0
  ds_read_b64_tr_b16 v[140:141], v17 offset:17408
  v_cvt_pk_bf16_f32 v181, v182, v183
  v_mfma_f32_16x16x32_bf16 v[44:47], a[196:199], v[136:139], v[44:47]
  ds_write_b64 v10, v[180:181] offset:18432
  v_mfma_f32_16x16x32_bf16 v[44:47], a[200:203], v[176:179], v[44:47]
  ds_read_b64_tr_b16 v[180:181], v17 offset:18432
  v_cvt_pk_bf16_f32 v121, v122, v123
  v_mfma_f32_16x16x32_bf16 v[44:47], a[204:207], v[216:219], v[44:47]
  ds_write_b64 v10, v[120:121] offset:16896
  v_mfma_f32_16x16x32_bf16 v[108:111], v[76:79], a[160:163], v[108:111]
  ds_read_b64_tr_b16 v[102:103], v17 offset:16896
  v_cvt_pk_bf16_f32 v221, v222, v223
  v_mfma_f32_16x16x32_bf16 v[128:131], v[76:79], a[164:167], v[128:131]
  ds_write_b64 v10, v[220:221] offset:19456
  v_mfma_f32_16x16x32_bf16 v[148:151], v[76:79], a[168:171], v[148:151]
  ds_read_b64_tr_b16 v[220:221], v17 offset:19456
  v_cvt_pk_bf16_f32 v240, v240, v241
  v_mfma_f32_16x16x32_bf16 v[168:171], v[76:79], a[172:175], v[168:171]
  ds_write_b64 v10, v[200:201] offset:18944
  v_mfma_f32_16x16x32_bf16 v[188:191], v[76:79], a[176:179], v[188:191]
  ds_read_b64_tr_b16 v[182:183], v17 offset:18944
  v_cvt_pk_bf16_f32 v241, v242, v243
  v_mfma_f32_16x16x32_bf16 v[208:211], v[76:79], a[180:183], v[208:211]
  ds_write_b64 v10, v[240:241] offset:19968
  v_mfma_f32_16x16x32_bf16 v[228:231], v[76:79], a[184:187], v[228:231]
  ds_read_b64_tr_b16 v[222:223], v17 offset:19968
  v_cvt_pk_bf16_f32 v164, v164, v165
  v_mfma_f32_16x16x32_bf16 v[248:251], v[76:79], a[188:191], v[248:251]
  v_permlane32_swap_b32 v85, v87
  ds_read_b64_tr_b16 v[100:101], v17 offset:16384
  v_permlane32_swap_b32 v84, v86
  v_add_f32 v85, v85, v87
  v_mov_b32 v87, v88
  v_add_f32 v84, v84, v86
  v_cvt_pk_bf16_f32 v165, v166, v167
  v_permlane32_swap_b32 v88, v87
  v_add_f32 v88, v88, v87
  v_mov_b32 v87, v88
  v_permlane16_swap_b32 v84, v85
  v_add_f32 v84, v84, v85
  v_permlane16_swap_b32 v88, v87
  v_add_f32 v88, v88, v87
  ds_write_b32 v16, v84 offset:0
  ds_write_b32 v16, v88 offset:256
  s_waitcnt lgkmcnt(2)
  v_mfma_f32_16x16x32_bf16 v[28:31], a[224:227], v[100:103], 0
  ds_write_b64 v10, v[164:165] offset:34304
  v_mfma_f32_16x16x32_bf16 v[28:31], a[228:231], v[140:143], v[28:31]
  v_cvt_pk_bf16_f32 v144, v144, v145
  v_cvt_pk_bf16_f32 v145, v146, v147
  v_mfma_f32_16x16x32_bf16 v[28:31], a[232:235], v[180:183], v[28:31]
  ds_write_b64 v10, v[144:145] offset:33792
  v_mfma_f32_16x16x32_bf16 v[28:31], a[236:239], v[220:223], v[28:31]
  ds_read_b64_tr_b16 v[146:147], v17 offset:34304
  v_cvt_pk_bf16_f32 v104, v104, v105
  v_mfma_f32_16x16x32_bf16 v[48:51], a[192:195], v[100:103], 0
  ds_read_b64_tr_b16 v[144:145], v17 offset:33792
  v_cvt_pk_bf16_f32 v184, v184, v185
  v_mfma_f32_16x16x32_bf16 v[48:51], a[196:199], v[140:143], v[48:51]
  s_waitcnt vmcnt(0) lgkmcnt(4)
  v_cvt_pk_bf16_f32 v185, v186, v187
  v_cvt_pk_bf16_f32 v204, v204, v205
  v_mfma_f32_16x16x32_bf16 v[48:51], a[200:203], v[180:183], v[48:51]
  s_barrier
  ds_read_b64_tr_b16 v[116:117], v18 offset:0
  v_cvt_pk_bf16_f32 v205, v206, v207
  v_mfma_f32_16x16x32_bf16 v[48:51], a[204:207], v[220:223], v[48:51]
  ds_write_b64 v10, v[204:205] offset:35328
  v_mfma_f32_16x16x32_bf16 v[112:115], v[80:83], a[160:163], v[112:115]
  ds_read_b64_tr_b16 v[186:187], v17 offset:35328
  v_cvt_pk_bf16_f32 v124, v124, v125
  v_mfma_f32_16x16x32_bf16 v[132:135], v[80:83], a[164:167], v[132:135]
  ds_read_b64_tr_b16 v[118:119], v18 offset:512
  v_cvt_pk_bf16_f32 v125, v126, v127
  v_mfma_f32_16x16x32_bf16 v[152:155], v[80:83], a[168:171], v[152:155]
  ds_write_b64 v10, v[184:185] offset:34816
  v_mfma_f32_16x16x32_bf16 v[172:175], v[80:83], a[172:175], v[172:175]
  ds_read_b64_tr_b16 v[184:185], v17 offset:34816
  v_cvt_pk_bf16_f32 v224, v224, v225
  v_mfma_f32_16x16x32_bf16 v[192:195], v[80:83], a[176:179], v[192:195]
  ds_read_b64_tr_b16 v[156:157], v18 offset:1024
  v_cvt_pk_bf16_f32 v225, v226, v227
  v_mfma_f32_16x16x32_bf16 v[212:215], v[80:83], a[180:183], v[212:215]
  ds_write_b64 v10, v[124:125] offset:33280
  v_mfma_f32_16x16x32_bf16 v[232:235], v[80:83], a[184:187], v[232:235]
  ds_write_b64 v10, v[224:225] offset:35840
  v_mfma_f32_16x16x32_bf16 v[252:255], v[80:83], a[188:191], v[252:255]
  ds_read_b64_tr_b16 v[224:225], v17 offset:35840
  v_cvt_pk_bf16_f32 v105, v106, v107
  ds_read_b64_tr_b16 v[106:107], v17 offset:33280
  ds_write_b64 v10, v[104:105] offset:32768
  ds_read_b64_tr_b16 v[104:105], v17 offset:32768
  v_cvt_pk_bf16_f32 v244, v244, v245
  v_cvt_pk_bf16_f32 v245, v246, v247
  v_cvt_pk_bf16_f32 v148, v148, v149
  ds_write_b64 v10, v[244:245] offset:36352
  ds_read_b64_tr_b16 v[226:227], v17 offset:36352
  v_cvt_pk_bf16_f32 v228, v228, v229
  v_cvt_pk_bf16_f32 v149, v150, v151
  v_cvt_pk_bf16_f32 v248, v248, v249
  ds_write_b64 v10, v[148:149] offset:50176
  ds_read_b64_tr_b16 v[148:149], v17 offset:50176
  v_cvt_pk_bf16_f32 v249, v250, v251
  v_cvt_pk_bf16_f32 v229, v230, v231
  ds_write_b64 v10, v[248:249] offset:52736
  ds_read_b64_tr_b16 v[230:231], v17 offset:52736
  ds_write_b64 v10, v[228:229] offset:52224
  ds_read_b64_tr_b16 v[228:229], v17 offset:52224
  s_waitcnt lgkmcnt(8)
  v_mfma_f32_16x16x32_bf16 v[32:35], a[224:227], v[104:107], 0
  buffer_load_dwordx4 v23, s[20:23], s35 offen lds
  v_cvt_pk_bf16_f32 v128, v128, v129
  v_mfma_f32_16x16x32_bf16 v[32:35], a[228:231], v[144:147], v[32:35]
  s_add_u32 m0, s31, 1024
  ds_read_b64_tr_b16 v[158:159], v18 offset:1536
  v_cvt_pk_bf16_f32 v129, v130, v131
  v_mfma_f32_16x16x32_bf16 v[32:35], a[232:235], v[184:187], v[32:35]
  s_waitcnt lgkmcnt(7)
  s_mov_b32 s35, 7424
  ds_write_b64 v10, v[128:129] offset:49664
  v_mfma_f32_16x16x32_bf16 v[32:35], a[236:239], v[224:227], v[32:35]
  ds_read_b64_tr_b16 v[198:199], v18 offset:2560
  v_cvt_pk_bf16_f32 v108, v108, v109
  v_mfma_f32_16x16x32_bf16 v[52:55], a[192:195], v[104:107], 0
  ds_read_b64_tr_b16 v[196:197], v18 offset:2048
  v_cvt_pk_bf16_f32 v109, v110, v111
  v_mfma_f32_16x16x32_bf16 v[52:55], a[196:199], v[144:147], v[52:55]
  ds_read_b64_tr_b16 v[110:111], v17 offset:49664
  v_cvt_pk_bf16_f32 v208, v208, v209
  v_mfma_f32_16x16x32_bf16 v[52:55], a[200:203], v[184:187], v[52:55]
  ds_read_b64_tr_b16 v[238:239], v18 offset:3584
  v_cvt_pk_bf16_f32 v209, v210, v211
  v_mfma_f32_16x16x32_bf16 v[52:55], a[204:207], v[224:227], v[52:55]
  ds_write_b64 v10, v[208:209] offset:51712
  ds_write_b64 v10, v[108:109] offset:49152
  ds_read_b64_tr_b16 v[108:109], v17 offset:49152
  v_cvt_pk_bf16_f32 v188, v188, v189
  v_cvt_pk_bf16_f32 v189, v190, v191
  ds_read_b64_tr_b16 v[190:191], v17 offset:51712
  ds_write_b64 v10, v[188:189] offset:51200
  ds_read_b64_tr_b16 v[188:189], v17 offset:51200
  v_cvt_pk_bf16_f32 v168, v168, v169
  v_cvt_pk_bf16_f32 v169, v170, v171
  v_cvt_pk_bf16_f32 v172, v172, v173
  ds_write_b64 v10, v[168:169] offset:50688
  ds_read_b64_tr_b16 v[150:151], v17 offset:50688
  v_cvt_pk_bf16_f32 v173, v174, v175
  v_add_u32 v17, 65536, v17
  v_cvt_pk_bf16_f32 v252, v252, v253
  v_cvt_pk_bf16_f32 v232, v232, v233
  v_cvt_pk_bf16_f32 v233, v234, v235
  v_cvt_pk_bf16_f32 v253, v254, v255
  v_cvt_pk_bf16_f32 v112, v112, v113
  v_cvt_pk_bf16_f32 v132, v132, v133
  v_cvt_pk_bf16_f32 v133, v134, v135
  v_cvt_pk_bf16_f32 v113, v114, v115
  v_add_u32 v10, 65536, v10
  s_waitcnt lgkmcnt(5)
  v_mfma_f32_16x16x32_bf16 v[36:39], a[224:227], v[108:111], 0
  s_waitcnt lgkmcnt(0)
  ds_write_b64 v10, v[132:133] offset:512
  ds_read_b64_tr_b16 v[114:115], v17 offset:512
  ds_write_b64 v10, v[232:233] offset:3072
  ds_read_b64_tr_b16 v[232:233], v17 offset:3072
  ds_write_b64 v10, v[112:113] offset:0
  ds_read_b64_tr_b16 v[112:113], v17 offset:0
  ds_write_b64 v10, v[172:173] offset:1536
  v_cvt_pk_bf16_f32 v212, v212, v213
  v_mfma_f32_16x16x32_bf16 v[36:39], a[228:231], v[148:151], v[36:39]
  ds_write_b64 v10, v[252:253] offset:3584
  v_mfma_f32_16x16x32_bf16 v[36:39], a[232:235], v[188:191], v[36:39]
  s_barrier
  buffer_load_dwordx4 v23, s[20:23], s35 offen lds
  v_cvt_pk_bf16_f32 v213, v214, v215
  v_mfma_f32_16x16x32_bf16 v[36:39], a[236:239], v[228:231], v[36:39]
  s_add_u32 m0, s31, 2048
  ds_read_b64_tr_b16 v[234:235], v17 offset:3584
  v_cvt_pk_bf16_f32 v152, v152, v153
  v_mfma_f32_16x16x32_bf16 v[56:59], a[192:195], v[108:111], 0
  s_mov_b32 s35, 14592
  ds_write_b64 v10, v[212:213] offset:2560
  v_mfma_f32_16x16x32_bf16 v[56:59], a[196:199], v[148:151], v[56:59]
  ds_read_b64_tr_b16 v[236:237], v18 offset:3072
  v_cvt_pk_bf16_f32 v153, v154, v155
  v_mfma_f32_16x16x32_bf16 v[56:59], a[200:203], v[188:191], v[56:59]
  ds_read_b64_tr_b16 v[154:155], v17 offset:1536
  v_cvt_pk_bf16_f32 v192, v192, v193
  v_mfma_f32_16x16x32_bf16 v[56:59], a[204:207], v[228:231], v[56:59]
  s_waitcnt lgkmcnt(6)
  ds_write_b64 v10, v[152:153] offset:1024
  v_mfma_f32_16x16x32_bf16 v[40:43], a[224:227], v[112:115], 0
  ds_read_b64_tr_b16 v[152:153], v17 offset:1024
  v_cvt_pk_bf16_f32 v193, v194, v195
  ds_read_b64_tr_b16 v[194:195], v17 offset:2560
  ds_write_b64 v10, v[192:193] offset:2048
  ds_read_b64_tr_b16 v[192:193], v17 offset:2048
  buffer_load_dwordx4 v23, s[20:23], s35 offen lds
  s_mov_b32 s35, 21760
  s_add_u32 m0, s31, 3072
  ds_read_b64_tr_b16 v[120:121], v18 offset:16384
  ds_read_b64_tr_b16 v[122:123], v18 offset:16896
  ds_read_b64_tr_b16 v[160:161], v18 offset:17408
  ds_read_b64_tr_b16 v[162:163], v18 offset:17920
  v_add_u32 v12, 159744, v3
  ds_read_b64_tr_b16 v[202:203], v18 offset:18944
  ds_read_b64_tr_b16 v[240:241], v18 offset:19456
  ds_read_b64_tr_b16 v[200:201], v18 offset:18432
  buffer_load_dwordx4 v23, s[20:23], s35 offen lds
  ds_read_b128 v[64:67], v12 offset:1024
  ds_read_b128 v[12:15], v12 offset:0
  s_add_u32 m0, s31, 16896
  s_waitcnt lgkmcnt(12)
  v_mfma_f32_16x16x32_bf16 v[40:43], a[228:231], v[152:155], v[40:43]
  s_waitcnt lgkmcnt(9)
  s_mov_b32 s35, 114944
  ds_read_b64_tr_b16 v[242:243], v18 offset:19968
  v_add_u32 v21, s54, v19
  ds_read_b64_tr_b16 v[124:125], v18 offset:32768
  ds_read_b64_tr_b16 v[126:127], v18 offset:33280
  ds_read_b64_tr_b16 v[164:165], v18 offset:33792
  s_sub_u32 s54, 84480, s54
  ds_read_b64_tr_b16 v[166:167], v18 offset:34304
  v_add_u32 v22, s54, v19
  v_mfma_f32_16x16x32_bf16 v[40:43], a[232:235], v[192:195], v[40:43]
  s_mul_i32 s54, s49, 16896
  ds_read_b64_tr_b16 v[204:205], v18 offset:34816
  v_mov_b32 v10, 1
  v_mfma_f32_16x16x32_bf16 v[40:43], a[236:239], v[232:235], v[40:43]
  s_add_u32 s54, s54, 33792
  ds_read_b64_tr_b16 v[206:207], v18 offset:35328
  v_mfma_f32_16x16x32_bf16 v[60:63], a[192:195], v[112:115], 0
  ds_read_b64_tr_b16 v[246:247], v18 offset:36352
  v_mfma_f32_16x16x32_bf16 v[60:63], a[196:199], v[152:155], v[60:63]
  ds_read_b64_tr_b16 v[244:245], v18 offset:35840
  v_mfma_f32_16x16x32_bf16 v[60:63], a[200:203], v[192:195], v[60:63]
  ds_read_b64_tr_b16 v[130:131], v18 offset:49664
  v_mfma_f32_16x16x32_bf16 v[60:63], a[204:207], v[232:235], v[60:63]
  s_waitcnt lgkmcnt(10)
  ds_read_b64_tr_b16 v[128:129], v18 offset:49152
  v_add_f32 v15, v15, v67
  v_mfma_f32_16x16x32_bf16 v[24:27], a[240:243], v[116:119], v[24:27]
  s_waitcnt lgkmcnt(10)
  ds_read_b64_tr_b16 v[170:171], v18 offset:50688
  v_add_f32 v14, v14, v66
  v_mfma_f32_16x16x32_bf16 v[24:27], a[244:247], v[156:159], v[24:27]
  s_barrier
  ds_read2_b32 v[66:67], v11 offset0:0 offset1:128
  v_add_f32 v14, v14, v15
  v_mfma_f32_16x16x32_bf16 v[24:27], a[248:251], v[196:199], v[24:27]
  ds_read_b64_tr_b16 v[168:169], v18 offset:50176
  v_add_f32 v12, v12, v64
  v_mfma_f32_16x16x32_bf16 v[24:27], a[252:255], v[236:239], v[24:27]
  ds_read_b64_tr_b16 v[210:211], v18 offset:51712
  v_add_f32 v13, v13, v65
  v_mfma_f32_16x16x32_bf16 v[44:47], a[208:211], v[116:119], v[44:47]
  buffer_load_dwordx4 v23, s[20:23], s35 offen lds
  v_add_f32 v12, v12, v13
  v_mfma_f32_16x16x32_bf16 v[44:47], a[212:215], v[156:159], v[44:47]
  s_mov_b32 s35, 122112
  ds_read_b64_tr_b16 v[208:209], v18 offset:51200
  v_add_f32 v12, v12, v14
  v_mfma_f32_16x16x32_bf16 v[44:47], a[216:219], v[196:199], v[44:47]
  s_waitcnt lgkmcnt(3)
  s_add_u32 m0, s31, 17920
  ds_read_b64_tr_b16 v[250:251], v18 offset:52736
  v_add_f32 v89, v66, v67
  v_mfma_f32_16x16x32_bf16 v[44:47], a[220:223], v[236:239], v[44:47]
  ds_read_b64_tr_b16 v[248:249], v18 offset:52224
  v_add_u32 v18, 65536, v18
  v_mfma_f32_16x16x32_bf16 v[28:31], a[240:243], v[120:123], v[28:31]
  ds_read_b64_tr_b16 v[132:133], v18 offset:0
  v_cmp_ngt_f32 vcc, s38, v12
  v_mfma_f32_16x16x32_bf16 v[28:31], a[244:247], v[160:163], v[28:31]
  v_rcp_f32 v84, v89
  v_mfma_f32_16x16x32_bf16 v[28:31], a[248:251], v[200:203], v[28:31]
  s_cbranch_vccnz L_check
L_checked:
  ds_read_b64_tr_b16 v[134:135], v18 offset:512
  v_mul_f32 v26, v26, v84
  v_mfma_f32_16x16x32_bf16 v[28:31], a[252:255], v[240:243], v[28:31]
  s_mov_b32 s55, 0x40000000
  buffer_load_dwordx4 v23, s[20:23], s35 offen lds
  v_mul_f32 v47, v47, v84
  v_mfma_f32_16x16x32_bf16 v[48:51], a[208:211], v[120:123], v[48:51]
  s_mov_b32 s35, 129280
  ds_read2_b32 v[70:71], v11 offset0:16 offset1:144
  v_mul_f32 v25, v25, v84
  v_mfma_f32_16x16x32_bf16 v[48:51], a[212:215], v[160:163], v[48:51]
  s_add_u32 m0, s31, 18944
  ds_read_b64_tr_b16 v[212:213], v18 offset:2048
  v_mul_f32 v45, v45, v84
  v_mfma_f32_16x16x32_bf16 v[48:51], a[216:219], v[200:203], v[48:51]
  ds_read_b64_tr_b16 v[172:173], v18 offset:1024
  v_mul_f32 v44, v44, v84
  v_mfma_f32_16x16x32_bf16 v[48:51], a[220:223], v[240:243], v[48:51]
  ds_read_b64_tr_b16 v[174:175], v18 offset:1536
  v_cvt_pk_bf16_f32 v66, v44, v45
  v_mfma_f32_16x16x32_bf16 v[32:35], a[240:243], v[124:127], v[32:35]
  ds_read_b64_tr_b16 v[214:215], v18 offset:2560
  v_mul_f32 v46, v46, v84
  v_mfma_f32_16x16x32_bf16 v[32:35], a[244:247], v[164:167], v[32:35]
  ds_read_b64_tr_b16 v[254:255], v18 offset:3584
  v_cvt_pk_bf16_f32 v67, v46, v47
  v_mfma_f32_16x16x32_bf16 v[32:35], a[248:251], v[204:207], v[32:35]
  buffer_load_dwordx4 v23, s[20:23], s35 offen lds
  v_mul_f32 v24, v24, v84
  v_mfma_f32_16x16x32_bf16 v[32:35], a[252:255], v[244:247], v[32:35]
  s_mov_b32 s35, 136448
  ds_read_b64_tr_b16 v[252:253], v18 offset:3072
  v_cvt_pk_bf16_f32 v64, v24, v25
  v_mfma_f32_16x16x32_bf16 v[52:55], a[208:211], v[124:127], v[52:55]
  s_add_u32 m0, s31, 19968
  ds_read_b64_tr_b16 a[170:171], v21 offset:10240
  v_mul_f32 v27, v27, v84
  v_mfma_f32_16x16x32_bf16 v[52:55], a[212:215], v[164:167], v[52:55]
  ds_read2_b32 v[74:75], v11 offset0:32 offset1:160
  v_cvt_pk_bf16_f32 v65, v26, v27
  v_mfma_f32_16x16x32_bf16 v[52:55], a[216:219], v[204:207], v[52:55]
  s_cmp_eq_u32 s60, 0
  s_cbranch_scc1 L_own0
  buffer_store_dwordx4 v[64:67], v3, s[24:27], s42 offen sc1
L_ownb0:
  v_mfma_f32_16x16x32_bf16 v[52:55], a[220:223], v[244:247], v[52:55]
  s_waitcnt lgkmcnt(5)
  ds_read_b64_tr_b16 a[162:163], v21 offset:2048
  v_add_f32 v90, v70, v71
  v_mfma_f32_16x16x32_bf16 v[36:39], a[240:243], v[128:131], v[36:39]
  v_rcp_f32 v85, v90
  v_mfma_f32_16x16x32_bf16 v[36:39], a[244:247], v[168:171], v[36:39]
  ds_read_b64_tr_b16 a[164:165], v21 offset:4096
  v_mul_f32 v29, v29, v85
  v_mfma_f32_16x16x32_bf16 v[36:39], a[248:251], v[208:211], v[36:39]
  ds_read_b64_tr_b16 a[168:169], v21 offset:8192
  v_mul_f32 v31, v31, v85
  v_mfma_f32_16x16x32_bf16 v[36:39], a[252:255], v[248:251], v[36:39]
  buffer_load_dwordx4 v23, s[20:23], s35 offen lds
  v_mul_f32 v51, v51, v85
  v_mfma_f32_16x16x32_bf16 v[56:59], a[208:211], v[128:131], v[56:59]
  s_add_u32 m0, s31, 67584
  ds_read_b64_tr_b16 a[160:161], v21 offset:0
  v_mul_f32 v49, v49, v85
  v_mfma_f32_16x16x32_bf16 v[56:59], a[212:215], v[168:171], v[56:59]
  s_mov_b32 s35, 384
  ds_read_b64_tr_b16 a[182:183], v22 offset:6144
  v_mul_f32 v30, v30, v85
  v_mfma_f32_16x16x32_bf16 v[56:59], a[216:219], v[208:211], v[56:59]
  ds_read_b64_tr_b16 a[174:175], v21 offset:14336
  v_cvt_pk_bf16_f32 v69, v30, v31
  v_mfma_f32_16x16x32_bf16 v[56:59], a[220:223], v[248:251], v[56:59]
  ds_read_b64_tr_b16 a[172:173], v21 offset:12288
  v_mul_f32 v48, v48, v85
  v_mfma_f32_16x16x32_bf16 v[40:43], a[240:243], v[132:135], v[40:43]
  ds_read_b64_tr_b16 a[186:187], v22 offset:10240
  v_cvt_pk_bf16_f32 v70, v48, v49
  v_mfma_f32_16x16x32_bf16 v[40:43], a[244:247], v[172:175], v[40:43]
  s_waitcnt lgkmcnt(6)
  ds_read_b64_tr_b16 a[178:179], v22 offset:2048
  v_mul_f32 v28, v28, v85
  v_mfma_f32_16x16x32_bf16 v[40:43], a[248:251], v[212:215], v[40:43]
  ds_read_b64_tr_b16 a[180:181], v22 offset:4096
  v_cvt_pk_bf16_f32 v68, v28, v29
  v_mfma_f32_16x16x32_bf16 v[40:43], a[252:255], v[252:255], v[40:43]
  ds_read_b64_tr_b16 a[190:191], v22 offset:14336
  v_mul_f32 v50, v50, v85
  v_mfma_f32_16x16x32_bf16 v[60:63], a[208:211], v[132:135], v[60:63]
  ds_read_b64_tr_b16 a[166:167], v21 offset:6144
  v_cvt_pk_bf16_f32 v71, v50, v51
  v_mfma_f32_16x16x32_bf16 v[60:63], a[212:215], v[172:175], v[60:63]
  s_cmp_eq_u32 s60, 1
  s_cbranch_scc1 L_own1
  buffer_store_dwordx4 v[68:71], v3, s[24:27], s42 offen offset:1024 sc1
L_ownb1:
  v_mfma_f32_16x16x32_bf16 v[60:63], a[216:219], v[212:215], v[60:63]
  ds_read_b64_tr_b16 a[176:177], v22 offset:0
  v_add_f32 v91, v74, v75
  v_mfma_f32_16x16x32_bf16 v[60:63], a[220:223], v[252:255], v[60:63]
  s_waitcnt lgkmcnt(6)
  ds_read_b64_tr_b16 a[184:185], v22 offset:8192
  v_add_u32 v21, s54, v20
  v_mfma_f32_16x16x32_bf16 v[24:27], a[160:163], v[96:99], 0
  s_waitcnt lgkmcnt(2)
  s_sub_u32 s54, 84480, s54
  ds_read_b64_tr_b16 a[188:189], v22 offset:12288
  v_add_u32 v22, s54, v20
  v_rcp_f32 v86, v91
  v_mfma_f32_16x16x32_bf16 v[24:27], a[164:167], v[136:139], v[24:27]
  s_mul_i32 s54, s49, 16896
  ds_read2_b32 v[78:79], v11 offset0:48 offset1:176
  v_mul_f32 v54, v54, v86
  v_mfma_f32_16x16x32_bf16 v[24:27], a[168:171], v[176:179], v[24:27]
  s_add_u32 s54, s54, 0
  buffer_load_dwordx4 v23, s[20:23], s35 offen lds
  v_mul_f32 v34, v34, v86
  v_mfma_f32_16x16x32_bf16 v[24:27], a[172:175], v[216:219], v[24:27]
  s_waitcnt lgkmcnt(3)
  s_add_u32 m0, s31, 68608
  ds_read2_b32 v[82:83], v11 offset0:64 offset1:192
  v_mul_f32 v52, v52, v86
  v_mfma_f32_16x16x32_bf16 v[24:27], a[176:179], v[116:119], v[24:27]
  s_mov_b32 s35, 7552
  ds_read_b64_tr_b16 a[242:243], v22 offset:2048
  v_mul_f32 v53, v53, v86
  v_mfma_f32_16x16x32_bf16 v[24:27], a[180:183], v[156:159], v[24:27]
  s_waitcnt lgkmcnt(4)
  buffer_load_dwordx4 v23, s[20:23], s35 offen lds
  v_cvt_pk_bf16_f32 v74, v52, v53
  v_mfma_f32_16x16x32_bf16 v[24:27], a[184:187], v[196:199], v[24:27]
  s_waitcnt lgkmcnt(3)
  s_add_u32 m0, s31, 69632
  ds_read_b64_tr_b16 a[226:227], v21 offset:2048
  v_mul_f32 v35, v35, v86
  v_mfma_f32_16x16x32_bf16 v[24:27], a[188:191], v[236:239], v[24:27]
  s_mov_b32 s35, 14720
  ds_read_b64_tr_b16 a[224:225], v21 offset:0
  v_mul_f32 v33, v33, v86
  v_mfma_f32_16x16x32_bf16 v[28:31], a[188:191], v[240:243], 0
  ds_read_b64_tr_b16 a[248:249], v22 offset:8192
  v_mul_f32 v32, v32, v86
  v_mfma_f32_16x16x32_bf16 v[28:31], a[184:187], v[200:203], v[28:31]
  ds_read_b64_tr_b16 a[230:231], v21 offset:6144
  v_cvt_pk_bf16_f32 v72, v32, v33
  v_mfma_f32_16x16x32_bf16 v[28:31], a[180:183], v[160:163], v[28:31]
  buffer_load_dwordx4 v23, s[20:23], s35 offen lds
  v_mul_f32 v55, v55, v86
  v_mfma_f32_16x16x32_bf16 v[28:31], a[176:179], v[120:123], v[28:31]
  s_add_u32 m0, s31, 70656
  ds_read_b64_tr_b16 a[228:229], v21 offset:4096
  v_cvt_pk_bf16_f32 v75, v54, v55
  v_mfma_f32_16x16x32_bf16 v[28:31], a[172:175], v[220:223], v[28:31]
  s_mov_b32 s35, 21888
  ds_read_b64_tr_b16 a[246:247], v22 offset:6144
  v_cvt_pk_bf16_f32 v73, v34, v35
  v_mfma_f32_16x16x32_bf16 v[28:31], a[168:171], v[180:183], v[28:31]
  s_cmp_eq_u32 s60, 2
  s_cbranch_scc1 L_own2
  buffer_store_dwordx4 v[72:75], v3, s[24:27], s42 offen offset:2048 sc1
L_ownb2:
  v_mfma_f32_16x16x32_bf16 v[28:31], a[164:167], v[140:143], v[28:31]
  s_waitcnt lgkmcnt(5)
  ds_read_b64_tr_b16 a[240:241], v22 offset:0
  v_add_f32 v92, v78, v79
  v_mfma_f32_16x16x32_bf16 v[28:31], a[160:163], v[100:103], v[28:31]
  v_rcp_f32 v87, v92
  v_mfma_f32_16x16x32_bf16 v[32:35], a[160:163], v[104:107], 0
  ds_read_b64_tr_b16 a[234:235], v21 offset:10240
  v_mul_f32 v39, v39, v87
  v_mfma_f32_16x16x32_bf16 v[32:35], a[164:167], v[144:147], v[32:35]
  ds_read_b64_tr_b16 a[244:245], v22 offset:4096
  v_mul_f32 v36, v36, v87
  v_mfma_f32_16x16x32_bf16 v[32:35], a[168:171], v[184:187], v[32:35]
  buffer_load_dwordx4 v23, s[20:23], s35 offen lds
  v_mul_f32 v38, v38, v87
  v_mfma_f32_16x16x32_bf16 v[32:35], a[172:175], v[224:227], v[32:35]
  s_mov_b32 s35, 115072
  ds_read_b64_tr_b16 a[232:233], v21 offset:8192
  v_mul_f32 v58, v58, v87
  v_mfma_f32_16x16x32_bf16 v[32:35], a[176:179], v[124:127], v[32:35]
  s_add_u32 m0, s31, 84480
  ds_read_b64_tr_b16 a[250:251], v22 offset:10240
  v_mul_f32 v37, v37, v87
  v_mfma_f32_16x16x32_bf16 v[32:35], a[180:183], v[164:167], v[32:35]
  ds_read_b64_tr_b16 a[236:237], v21 offset:12288
  v_cvt_pk_bf16_f32 v76, v36, v37
  v_mfma_f32_16x16x32_bf16 v[32:35], a[184:187], v[204:207], v[32:35]
  ds_read_b64_tr_b16 a[252:253], v22 offset:12288
  v_mul_f32 v56, v56, v87
  v_mfma_f32_16x16x32_bf16 v[32:35], a[188:191], v[244:247], v[32:35]
  ds_read_b64_tr_b16 a[238:239], v21 offset:14336
  v_mul_f32 v59, v59, v87
  v_cvt_pk_bf16_f32 v77, v38, v39
  v_mfma_f32_16x16x32_bf16 v[36:39], a[188:191], v[248:251], 0
  buffer_load_dwordx4 v23, s[20:23], s35 offen lds
  v_add_f32 v93, v82, v83
  v_mfma_f32_16x16x32_bf16 v[36:39], a[184:187], v[208:211], v[36:39]
  s_mov_b32 s35, 122240
  ds_read_b64_tr_b16 a[254:255], v22 offset:14336
  v_mul_f32 v57, v57, v87
  v_mfma_f32_16x16x32_bf16 v[36:39], a[180:183], v[168:171], v[36:39]
  s_add_u32 m0, s31, 85504
  v_cvt_pk_bf16_f32 v79, v58, v59
  v_cvt_pk_bf16_f32 v78, v56, v57
  v_mfma_f32_16x16x32_bf16 v[36:39], a[176:179], v[128:131], v[36:39]
  s_cmp_eq_u32 s60, 3
  s_cbranch_scc1 L_own3
  buffer_store_dwordx4 v[76:79], v3, s[24:27], s42 offen offset:3072 sc1
L_ownb3:
  v_mfma_f32_16x16x32_bf16 v[36:39], a[172:175], v[228:231], v[36:39]
  s_add_u32 s42, s42, 4096
  v_rcp_f32 v88, v93
  v_mfma_f32_16x16x32_bf16 v[36:39], a[168:171], v[188:191], v[36:39]
  v_mul_f32 v42, v42, v88
  v_mul_f32 v43, v43, v88
  v_mfma_f32_16x16x32_bf16 v[36:39], a[164:167], v[148:151], v[36:39]
  v_mul_f32 v41, v41, v88
  v_mul_f32 v40, v40, v88
  v_mfma_f32_16x16x32_bf16 v[36:39], a[160:163], v[108:111], v[36:39]
  v_cvt_pk_bf16_f32 v80, v40, v41
  v_cvt_pk_bf16_f32 v81, v42, v43
  v_mfma_f32_16x16x32_bf16 v[40:43], a[160:163], v[112:115], 0
  buffer_load_dwordx4 v23, s[20:23], s35 offen lds
  v_mul_f32 v63, v63, v88
  v_mfma_f32_16x16x32_bf16 v[40:43], a[164:167], v[152:155], v[40:43]
  s_mov_b32 s35, 129408
  v_mul_f32 v60, v60, v88
  v_mul_f32 v61, v61, v88
  v_mfma_f32_16x16x32_bf16 v[40:43], a[168:171], v[192:195], v[40:43]
  s_add_u32 m0, s31, 86528
  v_cvt_pk_bf16_f32 v82, v60, v61
  v_mul_f32 v62, v62, v88
  v_mfma_f32_16x16x32_bf16 v[40:43], a[172:175], v[232:235], v[40:43]
  s_waitcnt vmcnt(9) lgkmcnt(0)
  v_cvt_pk_bf16_f32 v83, v62, v63
  v_mul_f32 v25, v25, v84
  v_mfma_f32_16x16x32_bf16 v[40:43], a[176:179], v[132:135], v[40:43]
  s_barrier
  s_cmp_eq_u32 s60, 4
  s_cbranch_scc1 L_own4
  buffer_store_dwordx4 v[80:83], v3, s[24:27], s42 offen sc1
L_ownb4:
  v_mfma_f32_16x16x32_bf16 v[40:43], a[180:183], v[172:175], v[40:43]
  v_mul_f32 v27, v27, v84
  v_mul_f32 v26, v26, v84
  v_mfma_f32_16x16x32_bf16 v[40:43], a[184:187], v[212:215], v[40:43]
  v_mul_f32 v24, v24, v84
  v_cvt_pk_bf16_f32 v44, v24, v25
  v_mfma_f32_16x16x32_bf16 v[40:43], a[188:191], v[252:255], v[40:43]
  v_cvt_pk_bf16_f32 v45, v26, v27
  v_mul_f32 v29, v29, v85
  v_mfma_f32_16x16x32_bf16 v[24:27], a[224:227], v[96:99], 0
  s_lshr_b32 s43, s60, 3
  buffer_load_dwordx4 v23, s[20:23], s35 offen lds
  v_mul_f32 v31, v31, v85
  v_mfma_f32_16x16x32_bf16 v[24:27], a[228:231], v[136:139], v[24:27]
  s_add_u32 m0, s31, 87552
  v_mul_f32 v30, v30, v85
  v_mul_f32 v28, v28, v85
  v_mfma_f32_16x16x32_bf16 v[24:27], a[232:235], v[176:179], v[24:27]
  s_mov_b32 s35, 136576
  v_cvt_pk_bf16_f32 v49, v30, v31
  v_cvt_pk_bf16_f32 v48, v28, v29
  v_mfma_f32_16x16x32_bf16 v[24:27], a[236:239], v[216:219], v[24:27]
  s_lshl_b32 s43, s43, 1
  v_mul_f32 v34, v34, v86
  v_mul_f32 v32, v32, v86
  v_mfma_f32_16x16x32_bf16 v[24:27], a[240:243], v[116:119], v[24:27]
  s_sub_u32 s43, 6, s43
  v_mul_f32 v33, v33, v86
  v_mul_f32 v35, v35, v86
  v_mfma_f32_16x16x32_bf16 v[24:27], a[244:247], v[156:159], v[24:27]
  buffer_load_dwordx4 v23, s[20:23], s35 offen lds
  v_cvt_pk_bf16_f32 v53, v34, v35
  v_mfma_f32_16x16x32_bf16 v[24:27], a[248:251], v[196:199], v[24:27]
  s_add_u32 m0, s31, 101376
  v_cvt_pk_bf16_f32 v52, v32, v33
  v_mul_f32 v36, v36, v87
  v_mfma_f32_16x16x32_bf16 v[24:27], a[252:255], v[236:239], v[24:27]
  s_mov_b32 s35, 512
  v_mul_f32 v37, v37, v87
  v_mul_f32 v38, v38, v87
  v_mfma_f32_16x16x32_bf16 v[28:31], a[252:255], v[240:243], 0
  v_cvt_pk_bf16_f32 v56, v36, v37
  v_mul_f32 v39, v39, v87
  v_mfma_f32_16x16x32_bf16 v[28:31], a[248:251], v[200:203], v[28:31]
  v_cvt_pk_bf16_f32 v57, v38, v39
  v_mul_f32 v26, v26, v84
  v_mfma_f32_16x16x32_bf16 v[28:31], a[244:247], v[160:163], v[28:31]
  v_mul_f32 v25, v25, v84
  v_mul_f32 v24, v24, v84
  v_mfma_f32_16x16x32_bf16 v[28:31], a[240:243], v[120:123], v[28:31]
  v_mul_f32 v27, v27, v84
  v_cvt_pk_bf16_f32 v47, v26, v27
  v_mfma_f32_16x16x32_bf16 v[28:31], a[236:239], v[220:223], v[28:31]
  buffer_load_dwordx4 v23, s[20:23], s35 offen lds
  v_cvt_pk_bf16_f32 v46, v24, v25
  v_mfma_f32_16x16x32_bf16 v[28:31], a[232:235], v[180:183], v[28:31]
  s_add_u32 m0, s31, 102400
  v_mul_f32 v40, v40, v88
  v_mul_f32 v43, v43, v88
  v_mfma_f32_16x16x32_bf16 v[28:31], a[228:231], v[140:143], v[28:31]
  s_mov_b32 s35, 7680
  v_add_u32 v21, s54, v19
  v_mul_f32 v41, v41, v88
  v_mfma_f32_16x16x32_bf16 v[28:31], a[224:227], v[100:103], v[28:31]
  s_sub_u32 s54, 16896, s54
  s_cmp_eq_u32 s60, 5
  s_cbranch_scc1 L_own5
  buffer_store_dwordx4 v[44:47], v3, s[24:27], s42 offen offset:1024 sc1
L_ownb5:
  v_mfma_f32_16x16x32_bf16 v[32:35], a[224:227], v[104:107], 0
  ds_read_b64_tr_b16 a[192:193], v21 offset:0
  v_mul_f32 v42, v42, v88
  v_mfma_f32_16x16x32_bf16 v[32:35], a[228:231], v[144:147], v[32:35]
  ds_read_b64_tr_b16 a[194:195], v21 offset:2048
  v_cvt_pk_bf16_f32 v61, v42, v43
  v_mfma_f32_16x16x32_bf16 v[32:35], a[232:235], v[184:187], v[32:35]
  ds_read_b64_tr_b16 a[198:199], v21 offset:6144
  v_mul_f32 v31, v31, v85
  v_mfma_f32_16x16x32_bf16 v[32:35], a[236:239], v[224:227], v[32:35]
  ds_read_b64_tr_b16 a[196:197], v21 offset:4096
  v_mul_f32 v30, v30, v85
  v_mfma_f32_16x16x32_bf16 v[32:35], a[240:243], v[124:127], v[32:35]
  buffer_load_dwordx4 v23, s[20:23], s35 offen lds
  v_cvt_pk_bf16_f32 v51, v30, v31
  v_mfma_f32_16x16x32_bf16 v[32:35], a[244:247], v[164:167], v[32:35]
  s_mov_b32 s35, 14848
  ds_read_b64_tr_b16 a[200:201], v21 offset:8192
  v_mul_f32 v28, v28, v85
  v_mfma_f32_16x16x32_bf16 v[32:35], a[248:251], v[204:207], v[32:35]
  s_add_u32 m0, s31, 103424
  ds_read_b64_tr_b16 a[202:203], v21 offset:10240
  v_mul_f32 v29, v29, v85
  v_mfma_f32_16x16x32_bf16 v[32:35], a[252:255], v[244:247], v[32:35]
  ds_read_b64_tr_b16 a[206:207], v21 offset:14336
  v_cvt_pk_bf16_f32 v50, v28, v29
  v_mfma_f32_16x16x32_bf16 v[36:39], a[252:255], v[248:251], 0
  s_cmp_eq_u32 s60, 6
  s_cbranch_scc1 L_own6
  buffer_store_dwordx4 v[48:51], v3, s[24:27], s42 offen offset:2048 sc1
L_ownb6:
  v_mfma_f32_16x16x32_bf16 v[36:39], a[248:251], v[208:211], v[36:39]
  ds_read_b64_tr_b16 a[204:205], v21 offset:12288
  v_cvt_pk_bf16_f32 v60, v40, v41
  v_mfma_f32_16x16x32_bf16 v[36:39], a[244:247], v[168:171], v[36:39]
  v_mul_f32 v35, v35, v86
  v_mul_f32 v32, v32, v86
  v_mfma_f32_16x16x32_bf16 v[36:39], a[240:243], v[128:131], v[36:39]
  v_mul_f32 v33, v33, v86
  v_mul_f32 v34, v34, v86
  v_mfma_f32_16x16x32_bf16 v[36:39], a[236:239], v[228:231], v[36:39]
  v_cvt_pk_bf16_f32 v54, v32, v33
  v_cvt_pk_bf16_f32 v55, v34, v35
  v_mfma_f32_16x16x32_bf16 v[36:39], a[232:235], v[188:191], v[36:39]
  buffer_load_dwordx4 v23, s[20:23], s35 offen lds
  v_add_u32 v22, s54, v19
  v_mfma_f32_16x16x32_bf16 v[36:39], a[228:231], v[148:151], v[36:39]
  s_add_u32 m0, s31, 104448
  ds_read_b64_tr_b16 a[208:209], v22 offset:0
  v_and_b32 v16, 32, v0
  v_mfma_f32_16x16x32_bf16 v[36:39], a[224:227], v[108:111], v[36:39]
  s_mov_b32 s35, 22016
  ds_read_b64_tr_b16 a[210:211], v22 offset:2048
  v_lshlrev_b32 v16, 8, v16
  v_mfma_f32_16x16x32_bf16 v[40:43], a[224:227], v[112:115], 0
  s_mul_i32 s54, s49, 16896
  s_cmp_eq_u32 s60, 7
  s_cbranch_scc1 L_own7
  buffer_store_dwordx4 v[52:55], v3, s[24:27], s42 offen offset:3072 sc1
L_ownb7:
  v_mfma_f32_16x16x32_bf16 v[40:43], a[228:231], v[152:155], v[40:43]
  s_add_u32 s42, s42, 4096
  ds_read_b64_tr_b16 a[214:215], v22 offset:6144
  v_mul_f32 v39, v39, v87
  v_mfma_f32_16x16x32_bf16 v[40:43], a[232:235], v[192:195], v[40:43]
  s_add_u32 s54, s54, 0
  ds_read_b64_tr_b16 a[212:213], v22 offset:4096
  v_mul_f32 v38, v38, v87
  v_mfma_f32_16x16x32_bf16 v[40:43], a[236:239], v[232:235], v[40:43]
  ds_read_b64_tr_b16 a[218:219], v22 offset:10240
  v_cvt_pk_bf16_f32 v59, v38, v39
  v_mfma_f32_16x16x32_bf16 v[40:43], a[240:243], v[132:135], v[40:43]
  ds_read_b64_tr_b16 a[216:217], v22 offset:8192
  v_mul_f32 v37, v37, v87
  v_mfma_f32_16x16x32_bf16 v[40:43], a[244:247], v[172:175], v[40:43]
  buffer_load_dwordx4 v23, s[20:23], s35 offen lds
  s_add_u32 m0, s31, 118272
  v_mfma_f32_16x16x32_bf16 v[40:43], a[248:251], v[212:215], v[40:43]
  s_mov_b32 s35, 115200
  ds_read_b64_tr_b16 a[220:221], v22 offset:12288
  v_mul_f32 v36, v36, v87
  v_mfma_f32_16x16x32_bf16 v[40:43], a[252:255], v[252:255], v[40:43]
  s_waitcnt lgkmcnt(5)
  ds_read_b64_tr_b16 a[222:223], v22 offset:14336
  v_cvt_pk_bf16_f32 v58, v36, v37
  v_mfma_f32_16x16x32_bf16 v[24:27], a[192:195], v[96:99], 0
  buffer_load_dwordx4 v23, s[20:23], s35 offen lds
  v_add_u32 v21, s54, v20
  v_mfma_f32_16x16x32_bf16 v[24:27], a[196:199], v[136:139], v[24:27]
  s_mov_b32 s35, 122368
  ds_read_b64_tr_b16 a[160:161], v21 offset:0
  v_mul_f32 v43, v43, v88
  v_mfma_f32_16x16x32_bf16 v[24:27], a[200:203], v[176:179], v[24:27]
  s_add_u32 m0, s31, 119296
  ds_read_b64_tr_b16 a[162:163], v21 offset:2048
  v_mul_f32 v40, v40, v88
  v_mfma_f32_16x16x32_bf16 v[24:27], a[204:207], v[216:219], v[24:27]
  s_sub_u32 s54, 16896, s54
  s_cmp_eq_u32 s60, 8
  s_cbranch_scc1 L_own8
  buffer_store_dwordx4 v[56:59], v3, s[24:27], s42 offen sc1
L_ownb8:
  v_mfma_f32_16x16x32_bf16 v[24:27], a[208:211], v[116:119], v[24:27]
  s_waitcnt lgkmcnt(4)
  ds_read_b64_tr_b16 a[166:167], v21 offset:6144
  v_mul_f32 v42, v42, v88
  v_mfma_f32_16x16x32_bf16 v[24:27], a[212:215], v[156:159], v[24:27]
  ds_read_b64_tr_b16 a[164:165], v21 offset:4096
  v_mul_f32 v41, v41, v88
  v_mfma_f32_16x16x32_bf16 v[24:27], a[216:219], v[196:199], v[24:27]
  s_waitcnt lgkmcnt(4)
  ds_read_b64_tr_b16 a[170:171], v21 offset:10240
  v_cvt_pk_bf16_f32 v62, v40, v41
  v_mfma_f32_16x16x32_bf16 v[24:27], a[220:223], v[236:239], v[24:27]
  ds_read_b64_tr_b16 a[172:173], v21 offset:12288
  v_cvt_pk_bf16_f32 v63, v42, v43
  v_mfma_f32_16x16x32_bf16 v[28:31], a[220:223], v[240:243], 0
  buffer_load_dwordx4 v23, s[20:23], s35 offen lds
  v_add_u32 v22, s54, v20
  v_mfma_f32_16x16x32_bf16 v[28:31], a[216:219], v[200:203], v[28:31]
  s_add_u32 m0, s31, 120320
  ds_read_b64_tr_b16 a[168:169], v21 offset:8192
  v_mul_f32 v24, v24, v84
  v_mfma_f32_16x16x32_bf16 v[28:31], a[212:215], v[160:163], v[28:31]
  s_mov_b32 s35, 129536
  ds_read_b64_tr_b16 a[174:175], v21 offset:14336
  v_mul_f32 v26, v26, v84
  v_mfma_f32_16x16x32_bf16 v[28:31], a[208:211], v[120:123], v[28:31]
  s_mul_i32 s54, s49, 16896
  s_cmp_eq_u32 s60, 9
  s_cbranch_scc1 L_own9
  buffer_store_dwordx4 v[60:63], v3, s[24:27], s42 offen offset:1024 sc1
L_ownb9:
  v_mfma_f32_16x16x32_bf16 v[28:31], a[204:207], v[220:223], v[28:31]
  s_add_u32 s54, s54, 67584
  ds_read_b64_tr_b16 a[178:179], v22 offset:2048
  v_mul_f32 v27, v27, v84
  v_mfma_f32_16x16x32_bf16 v[28:31], a[200:203], v[180:183], v[28:31]
  ds_read_b64_tr_b16 a[176:177], v22 offset:0
  v_cvt_pk_bf16_f32 v65, v26, v27
  v_mfma_f32_16x16x32_bf16 v[28:31], a[196:199], v[140:143], v[28:31]
  ds_read_b64_tr_b16 a[182:183], v22 offset:6144
  v_mul_f32 v25, v25, v84
  v_mfma_f32_16x16x32_bf16 v[28:31], a[192:195], v[100:103], v[28:31]
  ds_read_b64_tr_b16 a[180:181], v22 offset:4096
  v_cvt_pk_bf16_f32 v64, v24, v25
  v_mfma_f32_16x16x32_bf16 v[32:35], a[192:195], v[104:107], 0
  buffer_load_dwordx4 v23, s[20:23], s35 offen lds
  v_add_u32 v21, s54, v19
  v_mfma_f32_16x16x32_bf16 v[32:35], a[196:199], v[144:147], v[32:35]
  s_mov_b32 s35, 136704
  ds_read_b64_tr_b16 a[188:189], v22 offset:12288
  v_mul_f32 v30, v30, v85
  v_mfma_f32_16x16x32_bf16 v[32:35], a[200:203], v[184:187], v[32:35]
  s_add_u32 m0, s31, 121344
  ds_read_b64_tr_b16 a[184:185], v22 offset:8192
  v_mul_f32 v31, v31, v85
  v_mfma_f32_16x16x32_bf16 v[32:35], a[204:207], v[224:227], v[32:35]
  s_sub_u32 s54, 152064, s54
  ds_read_b64_tr_b16 a[186:187], v22 offset:10240
  v_mul_f32 v28, v28, v85
  v_mfma_f32_16x16x32_bf16 v[32:35], a[208:211], v[124:127], v[32:35]
  ds_read_b64_tr_b16 a[190:191], v22 offset:14336
  v_mul_f32 v29, v29, v85
  v_mfma_f32_16x16x32_bf16 v[32:35], a[212:215], v[164:167], v[32:35]
  buffer_load_dwordx4 v23, s[20:23], s35 offen lds
  v_cvt_pk_bf16_f32 v68, v28, v29
  v_mfma_f32_16x16x32_bf16 v[32:35], a[216:219], v[204:207], v[32:35]
  s_mov_b32 s35, 640
  v_cvt_pk_bf16_f32 v69, v30, v31
  v_add_u32 v22, s54, v19
  v_mfma_f32_16x16x32_bf16 v[32:35], a[220:223], v[244:247], v[32:35]
  s_add_u32 m0, s31, 135168
  v_and_b32 v8, 31, v0
  v_lshl_add_u32 v16, v8, 2, v16
  v_mfma_f32_16x16x32_bf16 v[36:39], a[220:223], v[248:251], 0
  s_mul_i32 s54, s49, 16896
  v_and_b32 v1, 15, v0
  v_mov_b32 v8, 4
  v_mfma_f32_16x16x32_bf16 v[36:39], a[216:219], v[208:211], v[36:39]
  s_add_u32 s54, s54, 67584
  v_mul_f32 v34, v34, v86
  v_mul_f32 v32, v32, v86
  v_mfma_f32_16x16x32_bf16 v[36:39], a[212:215], v[168:171], v[36:39]
  v_mul_f32 v33, v33, v86
  v_cvt_pk_bf16_f32 v72, v32, v33
  v_mfma_f32_16x16x32_bf16 v[36:39], a[208:211], v[128:131], v[36:39]
  v_mul_f32 v35, v35, v86
  v_cvt_pk_bf16_f32 v73, v34, v35
  v_mfma_f32_16x16x32_bf16 v[36:39], a[204:207], v[228:231], v[36:39]
  buffer_load_dwordx4 v23, s[20:23], s35 offen lds
  v_cmp_eq_u32 vcc, s60, v1
  v_mfma_f32_16x16x32_bf16 v[36:39], a[200:203], v[188:191], v[36:39]
  s_mov_b32 s35, 7808
  v_cndmask_b32 v11, 0, v8, vcc
  v_lshrrev_b32 v8, 1, v1
  v_mfma_f32_16x16x32_bf16 v[36:39], a[196:199], v[148:151], v[36:39]
  s_add_u32 m0, s31, 136192
  v_bfe_u32 v2, v0, 4, 2
  v_and_b32 v8, 2, v8
  v_mfma_f32_16x16x32_bf16 v[36:39], a[192:195], v[108:111], v[36:39]
  v_xor_b32 v17, v2, v8
  v_cmp_eq_u32 vcc, 0, v17
  v_mfma_f32_16x16x32_bf16 v[40:43], a[192:195], v[112:115], 0
  v_mov_b32 v9, 0x3f80
  v_bfe_u32 v4, v1, 1, 1
  v_mfma_f32_16x16x32_bf16 v[40:43], a[196:199], v[152:155], v[40:43]
  v_and_b32 v17, 1, v1
  v_lshlrev_b32 v17, 4, v17
  v_mfma_f32_16x16x32_bf16 v[40:43], a[200:203], v[192:195], v[40:43]
  s_waitcnt vmcnt(14) lgkmcnt(0)
  v_mul_f32 v39, v39, v87
  v_mul_f32 v38, v38, v87
  v_mfma_f32_16x16x32_bf16 v[40:43], a[204:207], v[232:235], v[40:43]
  s_barrier
  buffer_load_dwordx4 v23, s[20:23], s35 offen lds
  v_cvt_pk_bf16_f32 v77, v38, v39
  v_mfma_f32_16x16x32_bf16 v[40:43], a[208:211], v[132:135], v[40:43]
  s_mov_b32 s35, 14976
  ds_read_b64_tr_b16 a[224:225], v21 offset:0
  v_mul_f32 v37, v37, v87
  v_mfma_f32_16x16x32_bf16 v[40:43], a[212:215], v[172:175], v[40:43]
  s_add_u32 m0, s31, 137216
  ds_read_b64_tr_b16 a[226:227], v21 offset:2048
  v_mul_f32 v36, v36, v87
  v_mfma_f32_16x16x32_bf16 v[40:43], a[216:219], v[212:215], v[40:43]
  ds_read_b64_tr_b16 a[228:229], v21 offset:4096
  v_cvt_pk_bf16_f32 v76, v36, v37
  v_mfma_f32_16x16x32_bf16 v[40:43], a[220:223], v[252:255], v[40:43]
  ds_read_b64_tr_b16 a[230:231], v21 offset:6144
  v_lshlrev_b32 v17, v17, v9
  v_mfma_f32_16x16x32_bf16 v[24:27], a[160:163], v[96:99], 0
  ds_read_b64_tr_b16 a[234:235], v21 offset:10240
  v_cndmask_b32 v9, 0, v17, vcc
  v_mfma_f32_16x16x32_bf16 v[24:27], a[164:167], v[136:139], v[24:27]
  ds_read_b64_tr_b16 a[238:239], v21 offset:14336
  v_lshrrev_b32 v17, 3, v1
  v_mfma_f32_16x16x32_bf16 v[24:27], a[168:171], v[176:179], v[24:27]
  buffer_load_dwordx4 v23, s[20:23], s35 offen lds
  v_mul_f32 v43, v43, v88
  v_mfma_f32_16x16x32_bf16 v[24:27], a[172:175], v[216:219], v[24:27]
  s_mov_b32 s35, 22144
  ds_read_b64_tr_b16 a[236:237], v21 offset:12288
  v_mul_f32 v41, v41, v88
  v_mfma_f32_16x16x32_bf16 v[24:27], a[176:179], v[116:119], v[24:27]
  s_add_u32 m0, s31, 138240
  ds_read_b64_tr_b16 a[232:233], v21 offset:8192
  v_mul_f32 v42, v42, v88
  v_mfma_f32_16x16x32_bf16 v[24:27], a[180:183], v[156:159], v[24:27]
  ds_read_b64_tr_b16 a[242:243], v22 offset:2048
  v_mul_f32 v40, v40, v88
  v_mfma_f32_16x16x32_bf16 v[24:27], a[184:187], v[196:199], v[24:27]
  ds_read_b64_tr_b16 a[246:247], v22 offset:6144
  v_cvt_pk_bf16_f32 v80, v40, v41
  v_mfma_f32_16x16x32_bf16 v[24:27], a[188:191], v[236:239], v[24:27]
  ds_read_b64_tr_b16 a[240:241], v22 offset:0
  v_cvt_pk_bf16_f32 v81, v42, v43
  v_mfma_f32_16x16x32_bf16 v[28:31], a[188:191], v[240:243], 0
  ds_read_b64_tr_b16 a[244:245], v22 offset:4096
  v_add_u32 v21, s54, v20
  v_mfma_f32_16x16x32_bf16 v[28:31], a[184:187], v[200:203], v[28:31]
  s_sub_u32 s54, 152064, s54
  buffer_load_dwordx4 v23, s[20:23], s35 offen lds
  v_mul_f32 v24, v24, v84
  v_mfma_f32_16x16x32_bf16 v[28:31], a[180:183], v[160:163], v[28:31]
  s_add_u32 m0, s31, 33792
  ds_read_b64_tr_b16 a[248:249], v22 offset:8192
  v_mul_f32 v26, v26, v84
  v_mfma_f32_16x16x32_bf16 v[28:31], a[176:179], v[120:123], v[28:31]
  s_mov_b32 s35, 115328
  ds_read_b64_tr_b16 a[254:255], v22 offset:14336
  v_mul_f32 v27, v27, v84
  v_mfma_f32_16x16x32_bf16 v[28:31], a[172:175], v[220:223], v[28:31]
  ds_read_b64_tr_b16 a[250:251], v22 offset:10240
  v_cvt_pk_bf16_f32 v67, v26, v27
  v_mfma_f32_16x16x32_bf16 v[28:31], a[168:171], v[180:183], v[28:31]
  ds_read_b64_tr_b16 a[252:253], v22 offset:12288
  v_mul_f32 v25, v25, v84
  v_mfma_f32_16x16x32_bf16 v[28:31], a[164:167], v[140:143], v[28:31]
  ds_read_b64_tr_b16 a[194:195], v21 offset:2048
  v_cvt_pk_bf16_f32 v66, v24, v25
  v_mfma_f32_16x16x32_bf16 v[28:31], a[160:163], v[100:103], v[28:31]
  s_cmp_eq_u32 s60, 10
  s_cbranch_scc1 L_own10
  buffer_store_dwordx4 v[64:67], v3, s[24:27], s42 offen offset:2048 sc1
L_ownb10:
  v_mfma_f32_16x16x32_bf16 v[32:35], a[160:163], v[104:107], 0
  ds_read_b64_tr_b16 a[192:193], v21 offset:0
  v_add_u32 v22, s54, v20
  v_mfma_f32_16x16x32_bf16 v[32:35], a[164:167], v[144:147], v[32:35]
  s_mul_i32 s54, s49, 16896
  ds_read_b64_tr_b16 a[202:203], v21 offset:10240
  v_lshlrev_b32 v17, 1, v17
  v_mfma_f32_16x16x32_bf16 v[32:35], a[168:171], v[184:187], v[32:35]
  s_add_u32 s54, s54, 101376
  ds_read_b64_tr_b16 a[196:197], v21 offset:4096
  v_mul_f32 v30, v30, v85
  v_mfma_f32_16x16x32_bf16 v[32:35], a[172:175], v[224:227], v[32:35]
  ds_read_b64_tr_b16 a[198:199], v21 offset:6144
  v_mul_f32 v29, v29, v85
  v_mfma_f32_16x16x32_bf16 v[32:35], a[176:179], v[124:127], v[32:35]
  buffer_load_dwordx4 v23, s[20:23], s35 offen lds
  v_mul_f32 v28, v28, v85
  v_mfma_f32_16x16x32_bf16 v[32:35], a[180:183], v[164:167], v[32:35]
  s_add_u32 m0, s31, 34816
  ds_read_b64_tr_b16 a[206:207], v21 offset:14336
  v_cvt_pk_bf16_f32 v70, v28, v29
  v_mfma_f32_16x16x32_bf16 v[32:35], a[184:187], v[204:207], v[32:35]
  s_mov_b32 s35, 122496
  ds_read_b64_tr_b16 a[200:201], v21 offset:8192
  v_mul_f32 v31, v31, v85
  v_mfma_f32_16x16x32_bf16 v[32:35], a[188:191], v[244:247], v[32:35]
  buffer_load_dwordx4 v23, s[20:23], s35 offen lds
  v_cvt_pk_bf16_f32 v71, v30, v31
  v_mfma_f32_16x16x32_bf16 v[36:39], a[188:191], v[248:251], 0
  s_add_u32 m0, s31, 35840
  ds_read_b64_tr_b16 a[208:209], v22 offset:0
  v_add_u32 v17, v17, v4
  v_mfma_f32_16x16x32_bf16 v[36:39], a[184:187], v[208:211], v[36:39]
  s_mov_b32 s35, 129664
  ds_read_b64_tr_b16 a[204:205], v21 offset:12288
  v_mul_f32 v32, v32, v86
  v_mfma_f32_16x16x32_bf16 v[36:39], a[180:183], v[168:171], v[36:39]
  s_cmp_eq_u32 s60, 11
  s_cbranch_scc1 L_own11
  buffer_store_dwordx4 v[68:71], v3, s[24:27], s42 offen offset:3072 sc1
L_ownb11:
  v_mfma_f32_16x16x32_bf16 v[36:39], a[176:179], v[128:131], v[36:39]
  s_add_u32 s42, s42, 4096
  ds_read_b64_tr_b16 a[210:211], v22 offset:2048
  v_mul_f32 v35, v35, v86
  v_mfma_f32_16x16x32_bf16 v[36:39], a[172:175], v[228:231], v[36:39]
  ds_read_b64_tr_b16 a[212:213], v22 offset:4096
  v_mul_f32 v34, v34, v86
  v_mfma_f32_16x16x32_bf16 v[36:39], a[168:171], v[188:191], v[36:39]
  ds_read_b64_tr_b16 a[218:219], v22 offset:10240
  v_cvt_pk_bf16_f32 v75, v34, v35
  v_mfma_f32_16x16x32_bf16 v[36:39], a[164:167], v[148:151], v[36:39]
  ds_read_b64_tr_b16 a[216:217], v22 offset:8192
  v_mul_f32 v33, v33, v86
  v_mfma_f32_16x16x32_bf16 v[36:39], a[160:163], v[108:111], v[36:39]
  buffer_load_dwordx4 v23, s[20:23], s35 offen lds
  v_cvt_pk_bf16_f32 v74, v32, v33
  v_mfma_f32_16x16x32_bf16 v[40:43], a[160:163], v[112:115], 0
  s_mov_b32 s35, 136832
  ds_read_b64_tr_b16 a[214:215], v22 offset:6144
  v_add_u32 v21, s54, v19
  v_mfma_f32_16x16x32_bf16 v[40:43], a[164:167], v[152:155], v[40:43]
  s_add_u32 m0, s31, 36864
  ds_read_b64_tr_b16 a[222:223], v22 offset:14336
  v_mul_f32 v37, v37, v87
  v_mfma_f32_16x16x32_bf16 v[40:43], a[168:171], v[192:195], v[40:43]
  s_sub_u32 s54, 219648, s54
  s_cmp_eq_u32 s60, 12
  s_cbranch_scc1 L_own12
  buffer_store_dwordx4 v[72:75], v3, s[24:27], s42 offen sc1
L_ownb12:
  v_mfma_f32_16x16x32_bf16 v[40:43], a[172:175], v[232:235], v[40:43]
  ds_read_b64_tr_b16 a[220:221], v22 offset:12288
  v_mul_f32 v36, v36, v87
  v_mfma_f32_16x16x32_bf16 v[40:43], a[176:179], v[132:135], v[40:43]
  v_mul_f32 v38, v38, v87
  v_mul_f32 v39, v39, v87
  v_mfma_f32_16x16x32_bf16 v[40:43], a[180:183], v[172:175], v[40:43]
  v_cvt_pk_bf16_f32 v78, v36, v37
  v_cvt_pk_bf16_f32 v79, v38, v39
  v_mfma_f32_16x16x32_bf16 v[40:43], a[184:187], v[212:215], v[40:43]
  v_add_u32 v22, s54, v19
  v_cmp_eq_u32 vcc, 0, v17
  v_mfma_f32_16x16x32_bf16 v[40:43], a[188:191], v[252:255], v[40:43]
  s_waitcnt lgkmcnt(3)
  s_mul_i32 s54, s49, 16896
  buffer_load_dwordx4 v23, s[20:23], s35 offen lds
  v_cndmask_b32 v4, 0, v9, vcc
  v_mfma_f32_16x16x32_bf16 v[24:27], a[224:227], v[96:99], 0
  s_mov_b32 s35, 768
  v_cmp_eq_u32 vcc, 1, v17
  v_bfe_u32 v12, v1, 1, 1
  v_mfma_f32_16x16x32_bf16 v[24:27], a[228:231], v[136:139], v[24:27]
  s_add_u32 m0, s31, 50688
  v_mul_f32 v42, v42, v88
  v_mul_f32 v40, v40, v88
  v_mfma_f32_16x16x32_bf16 v[24:27], a[232:235], v[176:179], v[24:27]
  s_add_u32 s54, s54, 101376
  s_cmp_eq_u32 s60, 13
  s_cbranch_scc1 L_own13
  buffer_store_dwordx4 v[76:79], v3, s[24:27], s42 offen offset:1024 sc1
L_ownb13:
  v_mfma_f32_16x16x32_bf16 v[24:27], a[236:239], v[216:219], v[24:27]
  v_mul_f32 v41, v41, v88
  v_mul_f32 v43, v43, v88
  v_mfma_f32_16x16x32_bf16 v[24:27], a[240:243], v[116:119], v[24:27]
  v_cvt_pk_bf16_f32 v83, v42, v43
  v_cvt_pk_bf16_f32 v82, v40, v41
  v_mfma_f32_16x16x32_bf16 v[24:27], a[244:247], v[156:159], v[24:27]
  v_cndmask_b32 v5, 0, v9, vcc
  v_cmp_eq_u32 vcc, 2, v17
  v_mfma_f32_16x16x32_bf16 v[24:27], a[248:251], v[196:199], v[24:27]
  v_lshlrev_b32 v18, 7, v1
  v_cndmask_b32 v6, 0, v9, vcc
  v_mfma_f32_16x16x32_bf16 v[24:27], a[252:255], v[236:239], v[24:27]
  buffer_load_dwordx4 v23, s[20:23], s35 offen lds
  v_cmp_eq_u32 vcc, 3, v17
  v_mfma_f32_16x16x32_bf16 v[28:31], a[252:255], v[240:243], 0
  s_add_u32 m0, s31, 51712
  v_cndmask_b32 v7, 0, v9, vcc
  v_mov_b32 v9, 0x3f80
  v_mfma_f32_16x16x32_bf16 v[28:31], a[248:251], v[200:203], v[28:31]
  s_mov_b32 s35, 7936
  v_mul_f32 v25, v25, v84
  v_mul_f32 v26, v26, v84
  v_mfma_f32_16x16x32_bf16 v[28:31], a[244:247], v[160:163], v[28:31]
  s_cmp_eq_u32 s60, 14
  s_cbranch_scc1 L_own14
  buffer_store_dwordx4 v[80:83], v3, s[24:27], s42 offen offset:2048 sc1
L_ownb14:
  v_mfma_f32_16x16x32_bf16 v[28:31], a[240:243], v[120:123], v[28:31]
  v_mul_f32 v27, v27, v84
  v_cvt_pk_bf16_f32 v45, v26, v27
  v_mfma_f32_16x16x32_bf16 v[28:31], a[236:239], v[220:223], v[28:31]
  v_mul_f32 v24, v24, v84
  v_cvt_pk_bf16_f32 v44, v24, v25
  v_mfma_f32_16x16x32_bf16 v[28:31], a[232:235], v[180:183], v[28:31]
  v_xor_b32 v17, v2, v8
  v_cmp_eq_u32 vcc, 1, v17
  v_mfma_f32_16x16x32_bf16 v[28:31], a[228:231], v[140:143], v[28:31]
  v_and_b32 v17, 1, v1
  v_lshlrev_b32 v17, 4, v17
  v_mfma_f32_16x16x32_bf16 v[28:31], a[224:227], v[100:103], v[28:31]
  buffer_load_dwordx4 v23, s[20:23], s35 offen lds
  v_lshlrev_b32 v17, v17, v9
  v_mfma_f32_16x16x32_bf16 v[32:35], a[224:227], v[104:107], 0
  s_mov_b32 s35, 15104
  v_cndmask_b32 v9, 0, v17, vcc
  v_lshrrev_b32 v17, 3, v1
  v_mfma_f32_16x16x32_bf16 v[32:35], a[228:231], v[144:147], v[32:35]
  s_add_u32 m0, s31, 52736
  v_mul_f32 v30, v30, v85
  v_mul_f32 v28, v28, v85
  v_mfma_f32_16x16x32_bf16 v[32:35], a[232:235], v[184:187], v[32:35]
  buffer_load_dwordx4 v23, s[20:23], s35 offen lds
  v_mul_f32 v29, v29, v85
  v_mfma_f32_16x16x32_bf16 v[32:35], a[236:239], v[224:227], v[32:35]
  s_add_u32 m0, s31, 53760
  v_mul_f32 v31, v31, v85
  v_cvt_pk_bf16_f32 v49, v30, v31
  v_mfma_f32_16x16x32_bf16 v[32:35], a[240:243], v[124:127], v[32:35]
  s_mov_b32 s35, 22272
  v_cvt_pk_bf16_f32 v48, v28, v29
  v_lshlrev_b32 v17, 1, v17
  v_mfma_f32_16x16x32_bf16 v[32:35], a[244:247], v[164:167], v[32:35]
  v_add_u32 v17, v17, v12
  v_cmp_eq_u32 vcc, 0, v17
  v_mfma_f32_16x16x32_bf16 v[32:35], a[248:251], v[204:207], v[32:35]
  v_mul_u32_u24 v8, 1792, v1
  v_cndmask_b32 v12, 0, v9, vcc
  v_mfma_f32_16x16x32_bf16 v[32:35], a[252:255], v[244:247], v[32:35]
  v_cmp_eq_u32 vcc, 1, v17
  v_lshl_add_u32 v8, v2, 4, v8
  v_mfma_f32_16x16x32_bf16 v[36:39], a[252:255], v[248:251], 0
  v_cndmask_b32 v13, 0, v9, vcc
  v_cmp_eq_u32 vcc, 2, v17
  v_mfma_f32_16x16x32_bf16 v[36:39], a[248:251], v[208:211], v[36:39]
  buffer_load_dwordx4 v23, s[20:23], s35 offen lds
  v_cndmask_b32 v14, 0, v9, vcc
  v_mfma_f32_16x16x32_bf16 v[36:39], a[244:247], v[168:171], v[36:39]
  s_add_u32 m0, s31, 0
  v_mul_f32 v34, v34, v86
  v_mul_f32 v32, v32, v86
  v_mfma_f32_16x16x32_bf16 v[36:39], a[240:243], v[128:131], v[36:39]
  s_mov_b32 s35, 115456
  v_mul_f32 v33, v33, v86
  v_cvt_pk_bf16_f32 v52, v32, v33
  v_mfma_f32_16x16x32_bf16 v[36:39], a[236:239], v[228:231], v[36:39]
  v_mul_f32 v35, v35, v86
  v_cvt_pk_bf16_f32 v53, v34, v35
  v_mfma_f32_16x16x32_bf16 v[36:39], a[232:235], v[188:191], v[36:39]
  v_cmp_eq_u32 vcc, 3, v17
  v_mov_b32 v17, 0x7f000000
  v_mfma_f32_16x16x32_bf16 v[36:39], a[228:231], v[148:151], v[36:39]
  v_cndmask_b32 v15, 0, v9, vcc
  v_cmp_gt_u32 vcc, s43, v1
  v_mfma_f32_16x16x32_bf16 v[36:39], a[224:227], v[108:111], v[36:39]
  s_min_u32 s43, s60, 8
  v_cndmask_b32 v2, v17, v95, vcc
  v_cndmask_b32 v1, v17, v8, vcc
  v_mfma_f32_16x16x32_bf16 v[40:43], a[224:227], v[112:115], 0
  s_lshl1_add_u32 s43, s60, s43
  buffer_load_dwordx4 v23, s[20:23], s35 offen lds
  s_add_u32 m0, s31, 1024
  v_mfma_f32_16x16x32_bf16 v[40:43], a[228:231], v[152:155], v[40:43]
  s_mov_b32 s35, 122624
  v_mul_f32 v36, v36, v87
  v_mul_f32 v39, v39, v87
  v_mfma_f32_16x16x32_bf16 v[40:43], a[232:235], v[192:195], v[40:43]
  s_waitcnt vmcnt(18) lgkmcnt(0)
  v_mul_f32 v38, v38, v87
  v_cvt_pk_bf16_f32 v57, v38, v39
  v_mfma_f32_16x16x32_bf16 v[40:43], a[236:239], v[232:235], v[40:43]
  s_barrier
  ds_read_b64_tr_b16 a[162:163], v21 offset:2048
  v_mul_f32 v37, v37, v87
  v_mfma_f32_16x16x32_bf16 v[40:43], a[240:243], v[132:135], v[40:43]
  s_lshl_b32 s43, s43, 1
  ds_read_b64_tr_b16 a[160:161], v21 offset:0
  v_cvt_pk_bf16_f32 v56, v36, v37
  v_mfma_f32_16x16x32_bf16 v[40:43], a[244:247], v[172:175], v[40:43]
  ds_read_b64_tr_b16 a[166:167], v21 offset:6144
  v_mfma_f32_16x16x32_bf16 v[40:43], a[248:251], v[212:215], v[40:43]
  ds_read_b64_tr_b16 a[168:169], v21 offset:8192
  v_mfma_f32_16x16x32_bf16 v[40:43], a[252:255], v[252:255], v[40:43]
  buffer_load_dwordx4 v23, s[20:23], s35 offen lds
  s_mov_b32 s35, 129792
  v_mfma_f32_16x16x32_bf16 v[24:27], a[192:195], v[96:99], 0
  s_add_u32 m0, s31, 2048
  ds_read_b64_tr_b16 a[164:165], v21 offset:4096
  v_mfma_f32_16x16x32_bf16 v[24:27], a[196:199], v[136:139], v[24:27]
  ds_read_b64_tr_b16 a[170:171], v21 offset:10240
  v_mfma_f32_16x16x32_bf16 v[24:27], a[200:203], v[176:179], v[24:27]
  ds_read_b64_tr_b16 a[174:175], v21 offset:14336
  v_mul_f32 v43, v43, v88
  v_mfma_f32_16x16x32_bf16 v[24:27], a[204:207], v[216:219], v[24:27]
  ds_read_b64_tr_b16 a[176:177], v22 offset:0
  v_mul_f32 v41, v41, v88
  v_mfma_f32_16x16x32_bf16 v[24:27], a[208:211], v[116:119], v[24:27]
  ds_read_b64_tr_b16 a[172:173], v21 offset:12288
  v_mul_f32 v40, v40, v88
  v_mfma_f32_16x16x32_bf16 v[24:27], a[212:215], v[156:159], v[24:27]
  ds_read_b64_tr_b16 a[178:179], v22 offset:2048
  v_mul_f32 v42, v42, v88
  v_mfma_f32_16x16x32_bf16 v[24:27], a[216:219], v[196:199], v[24:27]
  buffer_load_dwordx4 v23, s[20:23], s35 offen lds
  v_cvt_pk_bf16_f32 v61, v42, v43
  v_mfma_f32_16x16x32_bf16 v[24:27], a[220:223], v[236:239], v[24:27]
  s_mov_b32 s35, 136960
  ds_read_b64_tr_b16 a[182:183], v22 offset:6144
  v_cvt_pk_bf16_f32 v60, v40, v41
  v_mfma_f32_16x16x32_bf16 v[28:31], a[220:223], v[240:243], 0
  s_add_u32 m0, s31, 3072
  ds_read_b64_tr_b16 a[186:187], v22 offset:10240
  v_add_u32 v21, s54, v20
  v_mfma_f32_16x16x32_bf16 v[28:31], a[216:219], v[200:203], v[28:31]
  s_waitcnt vmcnt(6)
  buffer_store_dword v10, v16, s[24:27], s51 offen sc1
  v_mfma_f32_16x16x32_bf16 v[28:31], a[212:215], v[160:163], v[28:31]
  s_sub_u32 s54, 219648, s54
  ds_read_b64_tr_b16 a[180:181], v22 offset:4096
  v_mul_f32 v27, v27, v84
  v_mfma_f32_16x16x32_bf16 v[28:31], a[208:211], v[120:123], v[28:31]
  ds_read_b64_tr_b16 a[184:185], v22 offset:8192
  v_mul_f32 v26, v26, v84
  v_mfma_f32_16x16x32_bf16 v[28:31], a[204:207], v[220:223], v[28:31]
  ds_read_b64_tr_b16 a[190:191], v22 offset:14336
  v_cvt_pk_bf16_f32 v47, v26, v27
  v_mfma_f32_16x16x32_bf16 v[28:31], a[200:203], v[180:183], v[28:31]
  buffer_load_dwordx4 v23, s[20:23], s35 offen lds
  v_mul_f32 v24, v24, v84
  v_mfma_f32_16x16x32_bf16 v[28:31], a[196:199], v[140:143], v[28:31]
  ds_read_b64_tr_b16 a[188:189], v22 offset:12288
  v_mul_f32 v25, v25, v84
  v_mfma_f32_16x16x32_bf16 v[28:31], a[192:195], v[100:103], v[28:31]
  ds_read_b64_tr_b16 a[226:227], v21 offset:2048
  v_cvt_pk_bf16_f32 v46, v24, v25
  v_mfma_f32_16x16x32_bf16 v[32:35], a[192:195], v[104:107], 0
  s_cmp_eq_u32 s60, 0
  s_cbranch_scc1 L_own15
  buffer_store_dwordx4 v[44:47], v3, s[24:27], s42 offen offset:3072 sc1
L_ownb15:
  v_mfma_f32_16x16x32_bf16 v[32:35], a[196:199], v[144:147], v[32:35]
  s_add_u32 s42, s42, 4096
  ds_read_b64_tr_b16 a[224:225], v21 offset:0
  v_add_u32 v22, s54, v20
  v_mfma_f32_16x16x32_bf16 v[32:35], a[200:203], v[184:187], v[32:35]
  s_mul_i32 s54, s49, -101376
  ds_read_b64_tr_b16 a[230:231], v21 offset:6144
  v_mul_f32 v31, v31, v85
  v_mfma_f32_16x16x32_bf16 v[32:35], a[204:207], v[224:227], v[32:35]
  s_add_u32 s54, s54, 135168
  ds_read_b64_tr_b16 a[228:229], v21 offset:4096
  v_mul_f32 v28, v28, v85
  v_mfma_f32_16x16x32_bf16 v[32:35], a[208:211], v[124:127], v[32:35]
  ds_read_b64_tr_b16 a[232:233], v21 offset:8192
  v_mul_f32 v30, v30, v85
  v_mfma_f32_16x16x32_bf16 v[32:35], a[212:215], v[164:167], v[32:35]
  ds_read_b64_tr_b16 a[236:237], v21 offset:12288
  v_mul_f32 v29, v29, v85
  v_mfma_f32_16x16x32_bf16 v[32:35], a[216:219], v[204:207], v[32:35]
  ds_read_b64_tr_b16 a[234:235], v21 offset:10240
  v_cvt_pk_bf16_f32 v50, v28, v29
  v_mfma_f32_16x16x32_bf16 v[32:35], a[220:223], v[244:247], v[32:35]
  ds_read_b64_tr_b16 a[242:243], v22 offset:2048
  v_cvt_pk_bf16_f32 v51, v30, v31
  v_mfma_f32_16x16x32_bf16 v[36:39], a[220:223], v[248:251], 0
  s_cmp_eq_u32 s60, 1
  s_cbranch_scc1 L_own16
  buffer_store_dwordx4 v[48:51], v3, s[24:27], s42 offen sc1
L_ownb16:
  v_mfma_f32_16x16x32_bf16 v[36:39], a[216:219], v[208:211], v[36:39]
  ds_read_b64_tr_b16 a[238:239], v21 offset:14336
  v_add_u32 v21, s54, v19
  v_mfma_f32_16x16x32_bf16 v[36:39], a[212:215], v[168:171], v[36:39]
  s_sub_u32 s54, 168960, s54
  ds_read_b64_tr_b16 a[240:241], v22 offset:0
  v_mul_f32 v35, v35, v86
  v_mfma_f32_16x16x32_bf16 v[36:39], a[208:211], v[128:131], v[36:39]
  ds_read_b64_tr_b16 a[246:247], v22 offset:6144
  v_mul_f32 v34, v34, v86
  v_mfma_f32_16x16x32_bf16 v[36:39], a[204:207], v[228:231], v[36:39]
  ds_read_b64_tr_b16 a[250:251], v22 offset:10240
  v_mul_f32 v32, v32, v86
  v_mfma_f32_16x16x32_bf16 v[36:39], a[200:203], v[188:191], v[36:39]
  ds_read_b64_tr_b16 a[244:245], v22 offset:4096
  v_cvt_pk_bf16_f32 v55, v34, v35
  v_mfma_f32_16x16x32_bf16 v[36:39], a[196:199], v[148:151], v[36:39]
  ds_read_b64_tr_b16 a[248:249], v22 offset:8192
  v_mul_f32 v33, v33, v86
  v_mfma_f32_16x16x32_bf16 v[36:39], a[192:195], v[108:111], v[36:39]
  ds_read_b64_tr_b16 a[254:255], v22 offset:14336
  v_cvt_pk_bf16_f32 v54, v32, v33
  v_mfma_f32_16x16x32_bf16 v[40:43], a[192:195], v[112:115], 0
  s_cmp_eq_u32 s60, 2
  s_cbranch_scc1 L_own17
  buffer_store_dwordx4 v[52:55], v3, s[24:27], s42 offen offset:1024 sc1
L_ownb17:
  v_mfma_f32_16x16x32_bf16 v[40:43], a[196:199], v[152:155], v[40:43]
  ds_read_b64_tr_b16 a[252:253], v22 offset:12288
  v_add_u32 v22, s54, v19
  v_mfma_f32_16x16x32_bf16 v[40:43], a[200:203], v[192:195], v[40:43]
  s_mul_i32 s54, s49, -101376
  v_mul_f32 v39, v39, v87
  v_mul_f32 v36, v36, v87
  v_mfma_f32_16x16x32_bf16 v[40:43], a[204:207], v[232:235], v[40:43]
  s_add_u32 s54, s54, 135168
  v_mul_f32 v37, v37, v87
  v_mul_f32 v38, v38, v87
  v_mfma_f32_16x16x32_bf16 v[40:43], a[208:211], v[132:135], v[40:43]
  v_cvt_pk_bf16_f32 v59, v38, v39
  v_cvt_pk_bf16_f32 v58, v36, v37
  v_mfma_f32_16x16x32_bf16 v[40:43], a[212:215], v[172:175], v[40:43]
  s_cmp_eq_u32 s60, 3
  s_cbranch_scc1 L_own18
  buffer_store_dwordx4 v[56:59], v3, s[24:27], s42 offen offset:2048 sc1
L_ownb18:
  v_mfma_f32_16x16x32_bf16 v[40:43], a[216:219], v[212:215], v[40:43]
  v_mov_b32 v10, 2
  v_mfma_f32_16x16x32_bf16 v[40:43], a[220:223], v[252:255], v[40:43]
  s_waitcnt lgkmcnt(1)
  v_mfma_f32_16x16x32_bf16 v[24:27], a[160:163], v[96:99], 0
  v_mfma_f32_16x16x32_bf16 v[24:27], a[164:167], v[136:139], v[24:27]
  v_mfma_f32_16x16x32_bf16 v[24:27], a[168:171], v[176:179], v[24:27]
  v_mfma_f32_16x16x32_bf16 v[24:27], a[172:175], v[216:219], v[24:27]
  v_mfma_f32_16x16x32_bf16 v[24:27], a[176:179], v[116:119], v[24:27]
  v_mfma_f32_16x16x32_bf16 v[24:27], a[180:183], v[156:159], v[24:27]
  v_mfma_f32_16x16x32_bf16 v[24:27], a[184:187], v[196:199], v[24:27]
  v_mfma_f32_16x16x32_bf16 v[24:27], a[188:191], v[236:239], v[24:27]
  v_mul_f32 v41, v41, v88
  v_mul_f32 v42, v42, v88
  v_mfma_f32_16x16x32_bf16 v[28:31], a[188:191], v[240:243], 0
  v_mul_f32 v43, v43, v88
  v_cvt_pk_bf16_f32 v63, v42, v43
  v_mfma_f32_16x16x32_bf16 v[28:31], a[184:187], v[200:203], v[28:31]
  v_mul_f32 v40, v40, v88
  v_cvt_pk_bf16_f32 v62, v40, v41
  v_mfma_f32_16x16x32_bf16 v[28:31], a[180:183], v[160:163], v[28:31]
  s_cmp_eq_u32 s60, 4
  s_cbranch_scc1 L_own19
  buffer_store_dwordx4 v[60:63], v3, s[24:27], s42 offen offset:3072 sc1
L_ownb19:
  v_mfma_f32_16x16x32_bf16 v[28:31], a[176:179], v[120:123], v[28:31]
  s_add_u32 s42, s42, 4096
  v_mul_f32 v25, v25, v84
  v_mul_f32 v24, v24, v84
  v_mfma_f32_16x16x32_bf16 v[28:31], a[172:175], v[220:223], v[28:31]
  v_mul_f32 v27, v27, v84
  v_cvt_pk_bf16_f32 v64, v24, v25
  v_mfma_f32_16x16x32_bf16 v[28:31], a[168:171], v[180:183], v[28:31]
  v_mul_f32 v26, v26, v84
  v_cvt_pk_bf16_f32 v65, v26, v27
  v_mfma_f32_16x16x32_bf16 v[28:31], a[164:167], v[140:143], v[28:31]
  v_mfma_f32_16x16x32_bf16 v[28:31], a[160:163], v[100:103], v[28:31]
  v_mfma_f32_16x16x32_bf16 v[32:35], a[160:163], v[104:107], 0
  v_mfma_f32_16x16x32_bf16 v[32:35], a[164:167], v[144:147], v[32:35]
  v_mfma_f32_16x16x32_bf16 v[32:35], a[168:171], v[184:187], v[32:35]
  v_mfma_f32_16x16x32_bf16 v[32:35], a[172:175], v[224:227], v[32:35]
  v_mfma_f32_16x16x32_bf16 v[32:35], a[176:179], v[124:127], v[32:35]
  v_mfma_f32_16x16x32_bf16 v[32:35], a[180:183], v[164:167], v[32:35]
  v_mfma_f32_16x16x32_bf16 v[32:35], a[184:187], v[204:207], v[32:35]
  v_mfma_f32_16x16x32_bf16 v[32:35], a[188:191], v[244:247], v[32:35]
  v_mul_f32 v30, v30, v85
  v_mul_f32 v29, v29, v85
  v_mfma_f32_16x16x32_bf16 v[36:39], a[188:191], v[248:251], 0
  v_mul_f32 v28, v28, v85
  v_cvt_pk_bf16_f32 v68, v28, v29
  v_mfma_f32_16x16x32_bf16 v[36:39], a[184:187], v[208:211], v[36:39]
  v_mul_f32 v31, v31, v85
  v_cvt_pk_bf16_f32 v69, v30, v31
  v_mfma_f32_16x16x32_bf16 v[36:39], a[180:183], v[168:171], v[36:39]
  v_mul_f32 v32, v32, v86
  v_mul_f32 v35, v35, v86
  v_mfma_f32_16x16x32_bf16 v[36:39], a[176:179], v[128:131], v[36:39]
  v_mul_f32 v33, v33, v86
  v_cvt_pk_bf16_f32 v72, v32, v33
  v_mfma_f32_16x16x32_bf16 v[36:39], a[172:175], v[228:231], v[36:39]
  v_mul_f32 v34, v34, v86
  v_cvt_pk_bf16_f32 v73, v34, v35
  v_mfma_f32_16x16x32_bf16 v[36:39], a[168:171], v[188:191], v[36:39]
  v_mfma_f32_16x16x32_bf16 v[36:39], a[164:167], v[148:151], v[36:39]
  v_mfma_f32_16x16x32_bf16 v[36:39], a[160:163], v[108:111], v[36:39]
  v_mfma_f32_16x16x32_bf16 v[40:43], a[160:163], v[112:115], 0
  v_mfma_f32_16x16x32_bf16 v[40:43], a[164:167], v[152:155], v[40:43]
  v_mfma_f32_16x16x32_bf16 v[40:43], a[168:171], v[192:195], v[40:43]
  s_waitcnt vmcnt(5) lgkmcnt(0)
  s_barrier
  v_mfma_f32_16x16x32_bf16 v[40:43], a[172:175], v[232:235], v[40:43]
  ds_read_b64_tr_b16 a[192:193], v21 offset:0
  v_mfma_f32_16x16x32_bf16 v[40:43], a[176:179], v[132:135], v[40:43]
  ds_read_b64_tr_b16 a[194:195], v21 offset:2048
  v_mul_f32 v36, v36, v87
  v_mfma_f32_16x16x32_bf16 v[40:43], a[180:183], v[172:175], v[40:43]
  ds_read_b64_tr_b16 a[196:197], v21 offset:4096
  v_mul_f32 v37, v37, v87
  v_mfma_f32_16x16x32_bf16 v[40:43], a[184:187], v[212:215], v[40:43]
  ds_read_b64_tr_b16 a[198:199], v21 offset:6144
  v_cvt_pk_bf16_f32 v76, v36, v37
  v_mfma_f32_16x16x32_bf16 v[40:43], a[188:191], v[252:255], v[40:43]
  ds_read_b64_tr_b16 a[200:201], v21 offset:8192
  v_mul_f32 v39, v39, v87
  v_mfma_f32_16x16x32_bf16 v[24:27], a[224:227], v[96:99], 0
  ds_read_b64_tr_b16 a[202:203], v21 offset:10240
  v_mul_f32 v38, v38, v87
  v_mfma_f32_16x16x32_bf16 v[24:27], a[228:231], v[136:139], v[24:27]
  ds_read_b64_tr_b16 a[204:205], v21 offset:12288
  v_cvt_pk_bf16_f32 v77, v38, v39
  v_mfma_f32_16x16x32_bf16 v[24:27], a[232:235], v[176:179], v[24:27]
  ds_read_b64_tr_b16 a[210:211], v22 offset:2048
  v_mul_f32 v41, v41, v88
  v_mfma_f32_16x16x32_bf16 v[24:27], a[236:239], v[216:219], v[24:27]
  ds_read_b64_tr_b16 a[214:215], v22 offset:6144
  v_mul_f32 v43, v43, v88
  v_mfma_f32_16x16x32_bf16 v[24:27], a[240:243], v[116:119], v[24:27]
  ds_read_b64_tr_b16 a[206:207], v21 offset:14336
  v_mul_f32 v42, v42, v88
  v_mfma_f32_16x16x32_bf16 v[24:27], a[244:247], v[156:159], v[24:27]
  ds_read_b64_tr_b16 a[208:209], v22 offset:0
  v_cvt_pk_bf16_f32 v81, v42, v43
  v_mfma_f32_16x16x32_bf16 v[24:27], a[248:251], v[196:199], v[24:27]
  ds_read_b64_tr_b16 a[212:213], v22 offset:4096
  v_mul_f32 v40, v40, v88
  v_mfma_f32_16x16x32_bf16 v[24:27], a[252:255], v[236:239], v[24:27]
  ds_read_b64_tr_b16 a[216:217], v22 offset:8192
  v_cvt_pk_bf16_f32 v80, v40, v41
  v_mfma_f32_16x16x32_bf16 v[28:31], a[252:255], v[240:243], 0
  ds_read_b64_tr_b16 a[218:219], v22 offset:10240
  v_add_u32 v21, s54, v20
  v_mfma_f32_16x16x32_bf16 v[28:31], a[248:251], v[200:203], v[28:31]
  s_sub_u32 s54, 168960, s54
  ds_read_b64_tr_b16 a[222:223], v22 offset:14336
  v_mul_f32 v26, v26, v84
  v_mfma_f32_16x16x32_bf16 v[28:31], a[244:247], v[160:163], v[28:31]
  ds_read_b64_tr_b16 a[220:221], v22 offset:12288
  v_mul_f32 v25, v25, v84
  v_mfma_f32_16x16x32_bf16 v[28:31], a[240:243], v[120:123], v[28:31]
  ds_read_b64_tr_b16 a[160:161], v21 offset:0
  v_mul_f32 v27, v27, v84
  v_mfma_f32_16x16x32_bf16 v[28:31], a[236:239], v[220:223], v[28:31]
  ds_read_b64_tr_b16 a[162:163], v21 offset:2048
  v_mul_f32 v24, v24, v84
  v_mfma_f32_16x16x32_bf16 v[28:31], a[232:235], v[180:183], v[28:31]
  ds_read_b64_tr_b16 a[166:167], v21 offset:6144
  v_cvt_pk_bf16_f32 v67, v26, v27
  v_mfma_f32_16x16x32_bf16 v[28:31], a[228:231], v[140:143], v[28:31]
  ds_read_b64_tr_b16 a[170:171], v21 offset:10240
  v_cvt_pk_bf16_f32 v66, v24, v25
  v_mfma_f32_16x16x32_bf16 v[28:31], a[224:227], v[100:103], v[28:31]
  s_cmp_eq_u32 s60, 5
  s_cbranch_scc1 L_own20
  buffer_store_dwordx4 v[64:67], v3, s[24:27], s42 offen sc1
L_ownb20:
  v_mfma_f32_16x16x32_bf16 v[32:35], a[224:227], v[104:107], 0
  ds_read_b64_tr_b16 a[168:169], v21 offset:8192
  v_add_u32 v22, s54, v20
  v_mfma_f32_16x16x32_bf16 v[32:35], a[228:231], v[144:147], v[32:35]
  s_mul_i32 s54, s49, -50688
  ds_read_b64_tr_b16 a[164:165], v21 offset:4096
  s_add_u32 s54, s54, 50688
  v_mfma_f32_16x16x32_bf16 v[32:35], a[232:235], v[184:187], v[32:35]
  ds_read_b64_tr_b16 a[172:173], v21 offset:12288
  v_mul_f32 v28, v28, v85
  v_mfma_f32_16x16x32_bf16 v[32:35], a[236:239], v[224:227], v[32:35]
  ds_read_b64_tr_b16 a[174:175], v21 offset:14336
  v_mul_f32 v30, v30, v85
  v_mfma_f32_16x16x32_bf16 v[32:35], a[240:243], v[124:127], v[32:35]
  ds_read_b64_tr_b16 a[176:177], v22 offset:0
  v_mul_f32 v31, v31, v85
  v_mfma_f32_16x16x32_bf16 v[32:35], a[244:247], v[164:167], v[32:35]
  ds_read_b64_tr_b16 a[182:183], v22 offset:6144
  v_cvt_pk_bf16_f32 v71, v30, v31
  v_mfma_f32_16x16x32_bf16 v[32:35], a[248:251], v[204:207], v[32:35]
  ds_read_b64_tr_b16 a[178:179], v22 offset:2048
  v_mul_f32 v29, v29, v85
  v_mfma_f32_16x16x32_bf16 v[32:35], a[252:255], v[244:247], v[32:35]
  ds_read_b64_tr_b16 a[180:181], v22 offset:4096
  v_cvt_pk_bf16_f32 v70, v28, v29
  v_mfma_f32_16x16x32_bf16 v[36:39], a[252:255], v[248:251], 0
  s_cmp_eq_u32 s60, 6
  s_cbranch_scc1 L_own21
  buffer_store_dwordx4 v[68:71], v3, s[24:27], s42 offen offset:1024 sc1
L_ownb21:
  v_mfma_f32_16x16x32_bf16 v[36:39], a[248:251], v[208:211], v[36:39]
  ds_read_b64_tr_b16 a[184:185], v22 offset:8192
  v_add_u32 v21, s54, v19
  v_mfma_f32_16x16x32_bf16 v[36:39], a[244:247], v[168:171], v[36:39]
  s_sub_u32 s54, 50688, s54
  ds_read_b64_tr_b16 a[190:191], v22 offset:14336
  v_mul_f32 v32, v32, v86
  v_mfma_f32_16x16x32_bf16 v[36:39], a[240:243], v[128:131], v[36:39]
  ds_read_b64_tr_b16 a[186:187], v22 offset:10240
  v_mul_f32 v35, v35, v86
  v_mfma_f32_16x16x32_bf16 v[36:39], a[236:239], v[228:231], v[36:39]
  ds_read_b64_tr_b16 a[188:189], v22 offset:12288
  v_mul_f32 v33, v33, v86
  v_mfma_f32_16x16x32_bf16 v[36:39], a[232:235], v[188:191], v[36:39]
  v_cvt_pk_bf16_f32 v74, v32, v33
  v_mul_f32 v34, v34, v86
  v_mfma_f32_16x16x32_bf16 v[36:39], a[228:231], v[148:151], v[36:39]
  v_cvt_pk_bf16_f32 v75, v34, v35
  v_add_u32 v22, s54, v19
  v_mfma_f32_16x16x32_bf16 v[36:39], a[224:227], v[108:111], v[36:39]
  s_mul_i32 s54, s49, -50688
  s_cmp_eq_u32 s60, 7
  s_cbranch_scc1 L_own22
  buffer_store_dwordx4 v[72:75], v3, s[24:27], s42 offen offset:2048 sc1
L_ownb22:
  v_mfma_f32_16x16x32_bf16 v[40:43], a[224:227], v[112:115], 0
  s_add_u32 s54, s54, 50688
  ds_read_b64_tr_b16 a[226:227], v21 offset:2048
  v_mfma_f32_16x16x32_bf16 v[40:43], a[228:231], v[152:155], v[40:43]
  ds_read_b64_tr_b16 a[224:225], v21 offset:0
  v_mfma_f32_16x16x32_bf16 v[40:43], a[232:235], v[192:195], v[40:43]
  ds_read_b64_tr_b16 a[228:229], v21 offset:4096
  v_mul_f32 v37, v37, v87
  v_mfma_f32_16x16x32_bf16 v[40:43], a[236:239], v[232:235], v[40:43]
  ds_read_b64_tr_b16 a[232:233], v21 offset:8192
  v_mul_f32 v38, v38, v87
  v_mfma_f32_16x16x32_bf16 v[40:43], a[240:243], v[132:135], v[40:43]
  ds_read_b64_tr_b16 a[230:231], v21 offset:6144
  v_mul_f32 v36, v36, v87
  v_mfma_f32_16x16x32_bf16 v[40:43], a[244:247], v[172:175], v[40:43]
  ds_read_b64_tr_b16 a[236:237], v21 offset:12288
  v_cvt_pk_bf16_f32 v78, v36, v37
  v_mfma_f32_16x16x32_bf16 v[40:43], a[248:251], v[212:215], v[40:43]
  ds_read_b64_tr_b16 a[238:239], v21 offset:14336
  v_mul_f32 v39, v39, v87
  v_mfma_f32_16x16x32_bf16 v[40:43], a[252:255], v[252:255], v[40:43]
  s_waitcnt lgkmcnt(7)
  ds_read_b64_tr_b16 a[234:235], v21 offset:10240
  v_cvt_pk_bf16_f32 v79, v38, v39
  v_mfma_f32_16x16x32_bf16 v[24:27], a[192:195], v[96:99], 0
  s_cmp_eq_u32 s60, 8
  s_cbranch_scc1 L_own23
  buffer_store_dwordx4 v[76:79], v3, s[24:27], s42 offen offset:3072 sc1
L_ownb23:
  v_mfma_f32_16x16x32_bf16 v[24:27], a[196:199], v[136:139], v[24:27]
  s_add_u32 s42, s42, 4096
  ds_read_b64_tr_b16 a[240:241], v22 offset:0
  v_add_u32 v21, s54, v20
  v_mfma_f32_16x16x32_bf16 v[24:27], a[200:203], v[176:179], v[24:27]
  s_sub_u32 s54, 50688, s54
  ds_read_b64_tr_b16 a[242:243], v22 offset:2048
  v_mul_f32 v43, v43, v88
  v_mfma_f32_16x16x32_bf16 v[24:27], a[204:207], v[216:219], v[24:27]
  ds_read_b64_tr_b16 a[244:245], v22 offset:4096
  v_mul_f32 v40, v40, v88
  v_mfma_f32_16x16x32_bf16 v[24:27], a[208:211], v[116:119], v[24:27]
  ds_read_b64_tr_b16 a[250:251], v22 offset:10240
  v_mul_f32 v41, v41, v88
  v_mfma_f32_16x16x32_bf16 v[24:27], a[212:215], v[156:159], v[24:27]
  ds_read_b64_tr_b16 a[246:247], v22 offset:6144
  v_mul_f32 v42, v42, v88
  v_mfma_f32_16x16x32_bf16 v[24:27], a[216:219], v[196:199], v[24:27]
  ds_read_b64_tr_b16 a[252:253], v22 offset:12288
  v_cvt_pk_bf16_f32 v83, v42, v43
  v_mfma_f32_16x16x32_bf16 v[24:27], a[220:223], v[236:239], v[24:27]
  ds_read_b64_tr_b16 a[248:249], v22 offset:8192
  v_cvt_pk_bf16_f32 v82, v40, v41
  v_mfma_f32_16x16x32_bf16 v[28:31], a[220:223], v[240:243], 0
  s_cmp_eq_u32 s60, 9
  s_cbranch_scc1 L_own24
  buffer_store_dwordx4 v[80:83], v3, s[24:27], s42 offen sc1
L_ownb24:
  v_mfma_f32_16x16x32_bf16 v[28:31], a[216:219], v[200:203], v[28:31]
  ds_read_b64_tr_b16 a[254:255], v22 offset:14336
  v_add_u32 v22, s54, v20
  v_mfma_f32_16x16x32_bf16 v[28:31], a[212:215], v[160:163], v[28:31]
  v_mul_f32 v27, v27, v84
  v_mul_f32 v25, v25, v84
  v_mfma_f32_16x16x32_bf16 v[28:31], a[208:211], v[120:123], v[28:31]
  v_mul_f32 v24, v24, v84
  v_mul_f32 v26, v26, v84
  v_mfma_f32_16x16x32_bf16 v[28:31], a[204:207], v[220:223], v[28:31]
  v_cvt_pk_bf16_f32 v45, v26, v27
  v_cvt_pk_bf16_f32 v44, v24, v25
  v_mfma_f32_16x16x32_bf16 v[28:31], a[200:203], v[180:183], v[28:31]
  v_mfma_f32_16x16x32_bf16 v[28:31], a[196:199], v[140:143], v[28:31]
  v_mfma_f32_16x16x32_bf16 v[28:31], a[192:195], v[100:103], v[28:31]
  v_mfma_f32_16x16x32_bf16 v[32:35], a[192:195], v[104:107], 0
  v_mfma_f32_16x16x32_bf16 v[32:35], a[196:199], v[144:147], v[32:35]
  v_mfma_f32_16x16x32_bf16 v[32:35], a[200:203], v[184:187], v[32:35]
  v_mfma_f32_16x16x32_bf16 v[32:35], a[204:207], v[224:227], v[32:35]
  v_mfma_f32_16x16x32_bf16 v[32:35], a[208:211], v[124:127], v[32:35]
  v_mfma_f32_16x16x32_bf16 v[32:35], a[212:215], v[164:167], v[32:35]
  v_mfma_f32_16x16x32_bf16 v[32:35], a[216:219], v[204:207], v[32:35]
  v_mfma_f32_16x16x32_bf16 v[32:35], a[220:223], v[244:247], v[32:35]
  v_mul_f32 v30, v30, v85
  v_mul_f32 v29, v29, v85
  v_mfma_f32_16x16x32_bf16 v[36:39], a[220:223], v[248:251], 0
  v_mul_f32 v31, v31, v85
  v_cvt_pk_bf16_f32 v49, v30, v31
  v_mfma_f32_16x16x32_bf16 v[36:39], a[216:219], v[208:211], v[36:39]
  v_mul_f32 v28, v28, v85
  v_cvt_pk_bf16_f32 v48, v28, v29
  v_mfma_f32_16x16x32_bf16 v[36:39], a[212:215], v[168:171], v[36:39]
  v_mul_f32 v35, v35, v86
  v_mul_f32 v32, v32, v86
  v_mfma_f32_16x16x32_bf16 v[36:39], a[208:211], v[128:131], v[36:39]
  v_mul_f32 v34, v34, v86
  v_cvt_pk_bf16_f32 v53, v34, v35
  v_mfma_f32_16x16x32_bf16 v[36:39], a[204:207], v[228:231], v[36:39]
  v_mul_f32 v33, v33, v86
  v_cvt_pk_bf16_f32 v52, v32, v33
  v_mfma_f32_16x16x32_bf16 v[36:39], a[200:203], v[188:191], v[36:39]
  v_mfma_f32_16x16x32_bf16 v[36:39], a[196:199], v[148:151], v[36:39]
  v_mfma_f32_16x16x32_bf16 v[36:39], a[192:195], v[108:111], v[36:39]
  v_mfma_f32_16x16x32_bf16 v[40:43], a[192:195], v[112:115], 0
  ds_read_b64_tr_b16 a[192:193], v21 offset:0
  v_mfma_f32_16x16x32_bf16 v[40:43], a[196:199], v[152:155], v[40:43]
  ds_read_b64_tr_b16 a[194:195], v21 offset:2048
  v_mfma_f32_16x16x32_bf16 v[40:43], a[200:203], v[192:195], v[40:43]
  ds_read_b64_tr_b16 a[198:199], v21 offset:6144
  v_mfma_f32_16x16x32_bf16 v[40:43], a[204:207], v[232:235], v[40:43]
  ds_read_b64_tr_b16 a[200:201], v21 offset:8192
  v_mul_f32 v37, v37, v87
  v_mfma_f32_16x16x32_bf16 v[40:43], a[208:211], v[132:135], v[40:43]
  ds_read_b64_tr_b16 a[196:197], v21 offset:4096
  v_mul_f32 v38, v38, v87
  v_mfma_f32_16x16x32_bf16 v[40:43], a[212:215], v[172:175], v[40:43]
  ds_read_b64_tr_b16 a[202:203], v21 offset:10240
  v_mul_f32 v39, v39, v87
  v_mfma_f32_16x16x32_bf16 v[40:43], a[216:219], v[212:215], v[40:43]
  ds_read_b64_tr_b16 a[206:207], v21 offset:14336
  v_mul_f32 v36, v36, v87
  v_mfma_f32_16x16x32_bf16 v[40:43], a[220:223], v[252:255], v[40:43]
  ds_read_b64_tr_b16 a[204:205], v21 offset:12288
  v_cvt_pk_bf16_f32 v56, v36, v37
  v_mfma_f32_16x16x32_bf16 v[24:27], a[160:163], v[96:99], 0
  ds_read_b64_tr_b16 a[214:215], v22 offset:6144
  v_cvt_pk_bf16_f32 v57, v38, v39
  v_mfma_f32_16x16x32_bf16 v[24:27], a[164:167], v[136:139], v[24:27]
  ds_read_b64_tr_b16 a[208:209], v22 offset:0
  v_mfma_f32_16x16x32_bf16 v[24:27], a[168:171], v[176:179], v[24:27]
  ds_read_b64_tr_b16 a[210:211], v22 offset:2048
  v_mul_f32 v41, v41, v88
  v_mfma_f32_16x16x32_bf16 v[24:27], a[172:175], v[216:219], v[24:27]
  ds_read_b64_tr_b16 a[212:213], v22 offset:4096
  v_mul_f32 v42, v42, v88
  v_mfma_f32_16x16x32_bf16 v[24:27], a[176:179], v[116:119], v[24:27]
  ds_read_b64_tr_b16 a[216:217], v22 offset:8192
  v_mul_f32 v40, v40, v88
  v_mfma_f32_16x16x32_bf16 v[24:27], a[180:183], v[156:159], v[24:27]
  ds_read_b64_tr_b16 a[218:219], v22 offset:10240
  v_cvt_pk_bf16_f32 v60, v40, v41
  v_mfma_f32_16x16x32_bf16 v[24:27], a[184:187], v[196:199], v[24:27]
  ds_read_b64_tr_b16 a[220:221], v22 offset:12288
  v_mul_f32 v43, v43, v88
  v_mfma_f32_16x16x32_bf16 v[24:27], a[188:191], v[236:239], v[24:27]
  ds_read_b64_tr_b16 a[222:223], v22 offset:14336
  v_cvt_pk_bf16_f32 v61, v42, v43
  v_mfma_f32_16x16x32_bf16 v[28:31], a[188:191], v[240:243], 0
  v_mfma_f32_16x16x32_bf16 v[28:31], a[184:187], v[200:203], v[28:31]
  v_mfma_f32_16x16x32_bf16 v[28:31], a[180:183], v[160:163], v[28:31]
  v_mfma_f32_16x16x32_bf16 v[28:31], a[176:179], v[120:123], v[28:31]
  v_mfma_f32_16x16x32_bf16 v[28:31], a[172:175], v[220:223], v[28:31]
  v_mfma_f32_16x16x32_bf16 v[28:31], a[168:171], v[180:183], v[28:31]
  v_mul_f32 v25, v25, v84
  v_mul_f32 v24, v24, v84
  v_mfma_f32_16x16x32_bf16 v[28:31], a[164:167], v[140:143], v[28:31]
  v_mul_f32 v26, v26, v84
  v_mul_f32 v27, v27, v84
  v_mfma_f32_16x16x32_bf16 v[28:31], a[160:163], v[100:103], v[28:31]
  v_cvt_pk_bf16_f32 v47, v26, v27
  v_cvt_pk_bf16_f32 v46, v24, v25
  v_mfma_f32_16x16x32_bf16 v[32:35], a[160:163], v[104:107], 0
  s_cmp_eq_u32 s60, 10
  s_cbranch_scc1 L_own25
  buffer_store_dwordx4 v[44:47], v3, s[24:27], s42 offen offset:1024 sc1
L_ownb25:
  v_mfma_f32_16x16x32_bf16 v[32:35], a[164:167], v[144:147], v[32:35]
  v_mfma_f32_16x16x32_bf16 v[32:35], a[168:171], v[184:187], v[32:35]
  v_mfma_f32_16x16x32_bf16 v[32:35], a[172:175], v[224:227], v[32:35]
  v_mfma_f32_16x16x32_bf16 v[32:35], a[176:179], v[124:127], v[32:35]
  v_mul_f32 v28, v28, v85
  v_mul_f32 v29, v29, v85
  v_mfma_f32_16x16x32_bf16 v[32:35], a[180:183], v[164:167], v[32:35]
  v_cvt_pk_bf16_f32 v50, v28, v29
  v_mul_f32 v31, v31, v85
  v_mfma_f32_16x16x32_bf16 v[32:35], a[184:187], v[204:207], v[32:35]
  v_mul_f32 v30, v30, v85
  v_cvt_pk_bf16_f32 v51, v30, v31
  v_mfma_f32_16x16x32_bf16 v[32:35], a[188:191], v[244:247], v[32:35]
  s_cmp_eq_u32 s60, 11
  s_cbranch_scc1 L_own26
  buffer_store_dwordx4 v[48:51], v3, s[24:27], s42 offen offset:2048 sc1
L_ownb26:
  v_mfma_f32_16x16x32_bf16 v[36:39], a[188:191], v[248:251], 0
  v_mfma_f32_16x16x32_bf16 v[36:39], a[184:187], v[208:211], v[36:39]
  v_mfma_f32_16x16x32_bf16 v[36:39], a[180:183], v[168:171], v[36:39]
  v_mfma_f32_16x16x32_bf16 v[36:39], a[176:179], v[128:131], v[36:39]
  v_mfma_f32_16x16x32_bf16 v[36:39], a[172:175], v[228:231], v[36:39]
  v_mfma_f32_16x16x32_bf16 v[36:39], a[168:171], v[188:191], v[36:39]
  v_mfma_f32_16x16x32_bf16 v[36:39], a[164:167], v[148:151], v[36:39]
  v_mul_f32 v34, v34, v86
  v_mul_f32 v33, v33, v86
  v_mfma_f32_16x16x32_bf16 v[36:39], a[160:163], v[108:111], v[36:39]
  v_mul_f32 v32, v32, v86
  v_cvt_pk_bf16_f32 v54, v32, v33
  v_mfma_f32_16x16x32_bf16 v[40:43], a[160:163], v[112:115], 0
  v_mul_f32 v35, v35, v86
  v_cvt_pk_bf16_f32 v55, v34, v35
  v_mfma_f32_16x16x32_bf16 v[40:43], a[164:167], v[152:155], v[40:43]
  s_cmp_eq_u32 s60, 12
  s_cbranch_scc1 L_own27
  buffer_store_dwordx4 v[52:55], v3, s[24:27], s42 offen offset:3072 sc1
L_ownb27:
  v_mfma_f32_16x16x32_bf16 v[40:43], a[168:171], v[192:195], v[40:43]
  s_add_u32 s42, s42, 4096
  v_mul_f32 v37, v37, v87
  v_mul_f32 v38, v38, v87
  v_mfma_f32_16x16x32_bf16 v[40:43], a[172:175], v[232:235], v[40:43]
  v_mul_f32 v36, v36, v87
  v_cvt_pk_bf16_f32 v58, v36, v37
  v_mfma_f32_16x16x32_bf16 v[40:43], a[176:179], v[132:135], v[40:43]
  v_mul_f32 v39, v39, v87
  v_cvt_pk_bf16_f32 v59, v38, v39
  v_mfma_f32_16x16x32_bf16 v[40:43], a[180:183], v[172:175], v[40:43]
  v_mfma_f32_16x16x32_bf16 v[40:43], a[184:187], v[212:215], v[40:43]
  s_cmp_eq_u32 s60, 13
  s_cbranch_scc1 L_own28
  buffer_store_dwordx4 v[56:59], v3, s[24:27], s42 offen sc1
L_ownb28:
  v_mfma_f32_16x16x32_bf16 v[40:43], a[188:191], v[252:255], v[40:43]
  s_waitcnt lgkmcnt(0)
  v_mfma_f32_16x16x32_bf16 v[24:27], a[224:227], v[96:99], 0
  v_mfma_f32_16x16x32_bf16 v[24:27], a[228:231], v[136:139], v[24:27]
  v_mfma_f32_16x16x32_bf16 v[24:27], a[232:235], v[176:179], v[24:27]
  v_mfma_f32_16x16x32_bf16 v[24:27], a[236:239], v[216:219], v[24:27]
  v_mfma_f32_16x16x32_bf16 v[24:27], a[240:243], v[116:119], v[24:27]
  v_mfma_f32_16x16x32_bf16 v[24:27], a[244:247], v[156:159], v[24:27]
  v_mfma_f32_16x16x32_bf16 v[24:27], a[248:251], v[196:199], v[24:27]
  v_mfma_f32_16x16x32_bf16 v[24:27], a[252:255], v[236:239], v[24:27]
  v_mul_f32 v40, v40, v88
  v_mul_f32 v42, v42, v88
  v_mfma_f32_16x16x32_bf16 v[28:31], a[252:255], v[240:243], 0
  v_mul_f32 v41, v41, v88
  v_cvt_pk_bf16_f32 v62, v40, v41
  v_mfma_f32_16x16x32_bf16 v[28:31], a[248:251], v[200:203], v[28:31]
  v_mul_f32 v43, v43, v88
  v_cvt_pk_bf16_f32 v63, v42, v43
  v_mfma_f32_16x16x32_bf16 v[28:31], a[244:247], v[160:163], v[28:31]
  s_cmp_eq_u32 s60, 14
  s_cbranch_scc1 L_own29
  buffer_store_dwordx4 v[60:63], v3, s[24:27], s42 offen offset:1024 sc1
L_ownb29:
  v_mfma_f32_16x16x32_bf16 v[28:31], a[240:243], v[120:123], v[28:31]
  v_mul_f32 v25, v25, v84
  v_mul_f32 v27, v27, v84
  v_mfma_f32_16x16x32_bf16 v[28:31], a[236:239], v[220:223], v[28:31]
  v_mul_f32 v24, v24, v84
  v_cvt_pk_bf16_f32 v64, v24, v25
  v_mfma_f32_16x16x32_bf16 v[28:31], a[232:235], v[180:183], v[28:31]
  v_mul_f32 v26, v26, v84
  v_cvt_pk_bf16_f32 v65, v26, v27
  v_mfma_f32_16x16x32_bf16 v[28:31], a[228:231], v[140:143], v[28:31]
  v_mfma_f32_16x16x32_bf16 v[28:31], a[224:227], v[100:103], v[28:31]
  v_mfma_f32_16x16x32_bf16 v[32:35], a[224:227], v[104:107], 0
  v_mfma_f32_16x16x32_bf16 v[32:35], a[228:231], v[144:147], v[32:35]
  v_mfma_f32_16x16x32_bf16 v[32:35], a[232:235], v[184:187], v[32:35]
  v_mfma_f32_16x16x32_bf16 v[32:35], a[236:239], v[224:227], v[32:35]
  v_mfma_f32_16x16x32_bf16 v[32:35], a[240:243], v[124:127], v[32:35]
  v_mfma_f32_16x16x32_bf16 v[32:35], a[244:247], v[164:167], v[32:35]
  v_mfma_f32_16x16x32_bf16 v[32:35], a[248:251], v[204:207], v[32:35]
  v_mfma_f32_16x16x32_bf16 v[32:35], a[252:255], v[244:247], v[32:35]
  v_mul_f32 v30, v30, v85
  v_mul_f32 v31, v31, v85
  v_mfma_f32_16x16x32_bf16 v[36:39], a[252:255], v[248:251], 0
  v_mul_f32 v28, v28, v85
  v_cvt_pk_bf16_f32 v69, v30, v31
  v_mfma_f32_16x16x32_bf16 v[36:39], a[248:251], v[208:211], v[36:39]
  v_mul_f32 v29, v29, v85
  v_cvt_pk_bf16_f32 v68, v28, v29
  v_mfma_f32_16x16x32_bf16 v[36:39], a[244:247], v[168:171], v[36:39]
  v_mul_f32 v33, v33, v86
  v_mul_f32 v32, v32, v86
  v_mfma_f32_16x16x32_bf16 v[36:39], a[240:243], v[128:131], v[36:39]
  v_mul_f32 v35, v35, v86
  v_mul_f32 v34, v34, v86
  v_mfma_f32_16x16x32_bf16 v[36:39], a[236:239], v[228:231], v[36:39]
  v_cvt_pk_bf16_f32 v73, v34, v35
  v_cvt_pk_bf16_f32 v72, v32, v33
  v_mfma_f32_16x16x32_bf16 v[36:39], a[232:235], v[188:191], v[36:39]
  v_mfma_f32_16x16x32_bf16 v[36:39], a[228:231], v[148:151], v[36:39]
  buffer_load_dword v17, v18, s[24:27], s50 offen sc1
  v_mfma_f32_16x16x32_bf16 v[36:39], a[224:227], v[108:111], v[36:39]
  v_mfma_f32_16x16x32_bf16 v[40:43], a[224:227], v[112:115], 0
  v_mfma_f32_16x16x32_bf16 v[40:43], a[228:231], v[152:155], v[40:43]
  v_mfma_f32_16x16x32_bf16 v[40:43], a[232:235], v[192:195], v[40:43]
  v_mfma_f32_16x16x32_bf16 v[40:43], a[236:239], v[232:235], v[40:43]
  v_mfma_f32_16x16x32_bf16 v[40:43], a[240:243], v[132:135], v[40:43]
  v_mfma_f32_16x16x32_bf16 v[40:43], a[244:247], v[172:175], v[40:43]
  v_mfma_f32_16x16x32_bf16 v[40:43], a[248:251], v[212:215], v[40:43]
  v_mfma_f32_16x16x32_bf16 v[40:43], a[252:255], v[252:255], v[40:43]
  v_mul_f32 v36, v36, v87
  v_mul_f32 v39, v39, v87
  v_mfma_f32_16x16x32_bf16 v[24:27], a[192:195], v[96:99], 0
  v_mul_f32 v37, v37, v87
  v_cvt_pk_bf16_f32 v76, v36, v37
  v_mfma_f32_16x16x32_bf16 v[24:27], a[196:199], v[136:139], v[24:27]
  v_mul_f32 v38, v38, v87
  v_cvt_pk_bf16_f32 v77, v38, v39
  v_mfma_f32_16x16x32_bf16 v[24:27], a[200:203], v[176:179], v[24:27]
  v_mul_f32 v40, v40, v88
  v_mul_f32 v43, v43, v88
  v_mfma_f32_16x16x32_bf16 v[24:27], a[204:207], v[216:219], v[24:27]
  v_mul_f32 v41, v41, v88
  v_mul_f32 v42, v42, v88
  v_mfma_f32_16x16x32_bf16 v[24:27], a[208:211], v[116:119], v[24:27]
  v_cvt_pk_bf16_f32 v81, v42, v43
  v_cvt_pk_bf16_f32 v80, v40, v41
  v_mfma_f32_16x16x32_bf16 v[24:27], a[212:215], v[156:159], v[24:27]
  v_mfma_f32_16x16x32_bf16 v[24:27], a[216:219], v[196:199], v[24:27]
  v_mfma_f32_16x16x32_bf16 v[24:27], a[220:223], v[236:239], v[24:27]
  v_mfma_f32_16x16x32_bf16 v[28:31], a[220:223], v[240:243], 0
  v_mfma_f32_16x16x32_bf16 v[28:31], a[216:219], v[200:203], v[28:31]
  v_mfma_f32_16x16x32_bf16 v[28:31], a[212:215], v[160:163], v[28:31]
  v_mfma_f32_16x16x32_bf16 v[28:31], a[208:211], v[120:123], v[28:31]
  v_mfma_f32_16x16x32_bf16 v[28:31], a[204:207], v[220:223], v[28:31]
  v_mfma_f32_16x16x32_bf16 v[28:31], a[200:203], v[180:183], v[28:31]
  v_mfma_f32_16x16x32_bf16 v[28:31], a[196:199], v[140:143], v[28:31]
  v_mfma_f32_16x16x32_bf16 v[28:31], a[192:195], v[100:103], v[28:31]
  v_mul_f32 v25, v25, v84
  v_mul_f32 v26, v26, v84
  v_mfma_f32_16x16x32_bf16 v[32:35], a[192:195], v[104:107], 0
  v_mul_f32 v24, v24, v84
  v_cvt_pk_bf16_f32 v66, v24, v25
  v_mfma_f32_16x16x32_bf16 v[32:35], a[196:199], v[144:147], v[32:35]
  v_mul_f32 v27, v27, v84
  v_cvt_pk_bf16_f32 v67, v26, v27
  v_mfma_f32_16x16x32_bf16 v[32:35], a[200:203], v[184:187], v[32:35]
  buffer_store_dwordx4 v[64:67], v95, s[24:27], s42 offen offset:2048 sc1
  v_mfma_f32_16x16x32_bf16 v[32:35], a[204:207], v[224:227], v[32:35]
  v_mul_f32 v29, v29, v85
  v_mul_f32 v31, v31, v85
  v_mfma_f32_16x16x32_bf16 v[32:35], a[208:211], v[124:127], v[32:35]
  v_mul_f32 v30, v30, v85
  v_mul_f32 v28, v28, v85
  v_mfma_f32_16x16x32_bf16 v[32:35], a[212:215], v[164:167], v[32:35]
  v_cvt_pk_bf16_f32 v71, v30, v31
  v_cvt_pk_bf16_f32 v70, v28, v29
  v_mfma_f32_16x16x32_bf16 v[32:35], a[216:219], v[204:207], v[32:35]
  v_mfma_f32_16x16x32_bf16 v[32:35], a[220:223], v[244:247], v[32:35]
  v_mfma_f32_16x16x32_bf16 v[36:39], a[220:223], v[248:251], 0
  buffer_store_dwordx4 v[68:71], v95, s[24:27], s42 offen offset:3072 sc1
  v_mfma_f32_16x16x32_bf16 v[36:39], a[216:219], v[208:211], v[36:39]
  s_add_u32 s42, s42, 4096
  v_mfma_f32_16x16x32_bf16 v[36:39], a[212:215], v[168:171], v[36:39]
  v_mfma_f32_16x16x32_bf16 v[36:39], a[208:211], v[128:131], v[36:39]
  v_mfma_f32_16x16x32_bf16 v[36:39], a[204:207], v[228:231], v[36:39]
  v_mfma_f32_16x16x32_bf16 v[36:39], a[200:203], v[188:191], v[36:39]
  v_mul_f32 v35, v35, v86
  v_mul_f32 v34, v34, v86
  v_mfma_f32_16x16x32_bf16 v[36:39], a[196:199], v[148:151], v[36:39]
  v_mul_f32 v32, v32, v86
  v_mul_f32 v33, v33, v86
  v_mfma_f32_16x16x32_bf16 v[36:39], a[192:195], v[108:111], v[36:39]
  v_cvt_pk_bf16_f32 v74, v32, v33
  v_cvt_pk_bf16_f32 v75, v34, v35
  v_mfma_f32_16x16x32_bf16 v[40:43], a[192:195], v[112:115], 0
  buffer_store_dwordx4 v[72:75], v95, s[24:27], s42 offen sc1
  v_mfma_f32_16x16x32_bf16 v[40:43], a[196:199], v[152:155], v[40:43]
  v_mfma_f32_16x16x32_bf16 v[40:43], a[200:203], v[192:195], v[40:43]
  v_mfma_f32_16x16x32_bf16 v[40:43], a[204:207], v[232:235], v[40:43]
  v_mfma_f32_16x16x32_bf16 v[40:43], a[208:211], v[132:135], v[40:43]
  v_mul_f32 v37, v37, v87
  v_mul_f32 v36, v36, v87
  v_mfma_f32_16x16x32_bf16 v[40:43], a[212:215], v[172:175], v[40:43]
  v_mul_f32 v39, v39, v87
  v_mul_f32 v38, v38, v87
  v_mfma_f32_16x16x32_bf16 v[40:43], a[216:219], v[212:215], v[40:43]
  v_cvt_pk_bf16_f32 v78, v36, v37
  v_cvt_pk_bf16_f32 v79, v38, v39
  v_mfma_f32_16x16x32_bf16 v[40:43], a[220:223], v[252:255], v[40:43]
  buffer_store_dwordx4 v[76:79], v95, s[24:27], s42 offen offset:1024 sc1
  s_nop 6
  v_mul_f32 v42, v42, v88
  v_mul_f32 v43, v43, v88
  v_cvt_pk_bf16_f32 v83, v42, v43
  v_mul_f32 v40, v40, v88
  v_mul_f32 v41, v41, v88
  v_cvt_pk_bf16_f32 v82, v40, v41
  buffer_store_dwordx4 v[80:83], v95, s[24:27], s42 offen offset:2048 sc1
  s_waitcnt vmcnt(6)
  buffer_store_dword v10, v16, s[24:27], s51 offen sc1
  s_waitcnt vmcnt(6)
  v_or_b32 v17, v17, v11
  v_cmp_gt_u32 vcc, 1, v17
  s_nop 1
  s_cbranch_vccnz L_pre_a
L_back_a:
  s_cmp_eq_u32 s60, 0
  s_cselect_b32 s35, 143360, 0
  s_add_u32 s52, s52, s35
  buffer_load_dwordx4 a[4:7], v3, s[24:27], s52 offen sc1
  s_cmp_eq_u32 s60, 1
  s_cselect_b32 s35, 143360, 0
  s_add_u32 s52, s52, s35
  s_add_u32 s52, s52, 143360
  buffer_load_dwordx4 a[8:11], v3, s[24:27], s52 offen sc1
  s_cmp_eq_u32 s60, 2
  s_cselect_b32 s35, 143360, 0
  s_add_u32 s52, s52, s35
  s_add_u32 s52, s52, 143360
  buffer_load_dwordx4 a[12:15], v3, s[24:27], s52 offen sc1
  s_cmp_eq_u32 s60, 3
  s_cselect_b32 s35, 143360, 0
  s_add_u32 s52, s52, s35
  s_add_u32 s52, s52, 143360
  buffer_load_dwordx4 a[16:19], v3, s[24:27], s52 offen sc1
  s_cmp_eq_u32 s60, 4
  s_cselect_b32 s35, 143360, 0
  s_add_u32 s52, s52, s35
  s_add_u32 s52, s52, 143360
  buffer_load_dwordx4 a[20:23], v3, s[24:27], s52 offen sc1
  s_cmp_eq_u32 s60, 5
  s_cselect_b32 s35, 143360, 0
  s_add_u32 s52, s52, s35
  s_add_u32 s52, s52, 143360
  buffer_load_dwordx4 a[24:27], v3, s[24:27], s52 offen sc1
  s_cmp_eq_u32 s60, 6
  s_cselect_b32 s35, 143360, 0
  s_add_u32 s52, s52, s35
  s_add_u32 s52, s52, 143360
  buffer_load_dwordx4 a[28:31], v3, s[24:27], s52 offen sc1
  s_cmp_eq_u32 s60, 7
  s_cselect_b32 s35, 143360, 0
  s_add_u32 s52, s52, s35
  s_add_u32 s52, s52, 143360
  buffer_load_dwordx4 a[32:35], v3, s[24:27], s52 offen sc1
  v_mov_b32 v10, 3
  s_waitcnt vmcnt(8)
  buffer_store_dword v10, v16, s[24:27], s51 offen sc1
  buffer_load_dword v17, v18, s[24:27], s50 offen sc1
  s_cmp_eq_u32 s60, 8
  s_cselect_b32 s35, 143360, 0
  s_add_u32 s52, s52, s35
  s_add_u32 s52, s52, 143360
  buffer_load_dwordx4 a[36:39], v3, s[24:27], s52 offen sc1
  s_cmp_eq_u32 s60, 9
  s_cselect_b32 s35, 143360, 0
  s_add_u32 s52, s52, s35
  s_add_u32 s52, s52, 143360
  buffer_load_dwordx4 a[40:43], v3, s[24:27], s52 offen sc1
  s_cmp_eq_u32 s60, 10
  s_cselect_b32 s35, 143360, 0
  s_add_u32 s52, s52, s35
  s_add_u32 s52, s52, 143360
  buffer_load_dwordx4 a[44:47], v3, s[24:27], s52 offen sc1
  s_cmp_eq_u32 s60, 11
  s_cselect_b32 s35, 143360, 0
  s_add_u32 s52, s52, s35
  s_add_u32 s52, s52, 143360
  buffer_load_dwordx4 a[48:51], v3, s[24:27], s52 offen sc1
  s_cmp_eq_u32 s60, 12
  s_cselect_b32 s35, 143360, 0
  s_add_u32 s52, s52, s35
  s_add_u32 s52, s52, 143360
  buffer_load_dwordx4 a[52:55], v3, s[24:27], s52 offen sc1
  s_cmp_eq_u32 s60, 13
  s_cselect_b32 s35, 143360, 0
  s_add_u32 s52, s52, s35
  s_add_u32 s52, s52, 143360
  buffer_load_dwordx4 a[56:59], v3, s[24:27], s52 offen sc1
  s_cmp_eq_u32 s60, 14
  s_cselect_b32 s35, 143360, 0
  s_add_u32 s52, s52, s35
  s_add_u32 s52, s52, 143360
  buffer_load_dwordx4 a[60:63], v3, s[24:27], s52 offen sc1
  s_add_u32 s52, s48, 15360
  s_waitcnt vmcnt(7)
  v_or_b32 v17, v17, v11
  v_cmp_gt_u32 vcc, 2, v17
  s_nop 1
  s_cbranch_vccnz L_spin_b
L_back_b:
  s_cmp_eq_u32 s60, 0
  s_cselect_b32 s35, 143360, 0
  s_add_u32 s52, s52, s35
  buffer_load_dwordx4 a[68:71], v3, s[24:27], s52 offen sc1
  s_cmp_eq_u32 s60, 1
  s_cselect_b32 s35, 143360, 0
  s_add_u32 s52, s52, s35
  s_add_u32 s52, s52, 143360
  buffer_load_dwordx4 a[72:75], v3, s[24:27], s52 offen sc1
  s_cmp_eq_u32 s60, 2
  s_cselect_b32 s35, 143360, 0
  s_add_u32 s52, s52, s35
  s_add_u32 s52, s52, 143360
  buffer_load_dwordx4 a[76:79], v3, s[24:27], s52 offen sc1
  s_cmp_eq_u32 s60, 3
  s_cselect_b32 s35, 143360, 0
  s_add_u32 s52, s52, s35
  s_add_u32 s52, s52, 143360
  buffer_load_dwordx4 a[80:83], v3, s[24:27], s52 offen sc1
  s_cmp_eq_u32 s60, 4
  s_cselect_b32 s35, 143360, 0
  s_add_u32 s52, s52, s35
  s_add_u32 s52, s52, 143360
  buffer_load_dwordx4 a[84:87], v3, s[24:27], s52 offen sc1
  s_cmp_eq_u32 s60, 5
  s_cselect_b32 s35, 143360, 0
  s_add_u32 s52, s52, s35
  s_add_u32 s52, s52, 143360
  buffer_load_dwordx4 a[88:91], v3, s[24:27], s52 offen sc1
  s_cmp_eq_u32 s60, 6
  s_cselect_b32 s35, 143360, 0
  s_add_u32 s52, s52, s35
  s_add_u32 s52, s52, 143360
  buffer_load_dwordx4 a[92:95], v3, s[24:27], s52 offen sc1
  s_cmp_eq_u32 s60, 7
  s_cselect_b32 s35, 143360, 0
  s_add_u32 s52, s52, s35
  s_add_u32 s52, s52, 143360
  buffer_load_dwordx4 a[96:99], v3, s[24:27], s52 offen sc1
  buffer_load_dword v17, v18, s[24:27], s50 offen sc1
  s_cmp_eq_u32 s60, 8
  s_cselect_b32 s35, 143360, 0
  s_add_u32 s52, s52, s35
  s_add_u32 s52, s52, 143360
  buffer_load_dwordx4 a[100:103], v3, s[24:27], s52 offen sc1
  s_cmp_eq_u32 s60, 9
  s_cselect_b32 s35, 143360, 0
  s_add_u32 s52, s52, s35
  s_add_u32 s52, s52, 143360
  buffer_load_dwordx4 a[104:107], v3, s[24:27], s52 offen sc1
  s_cmp_eq_u32 s60, 10
  s_cselect_b32 s35, 143360, 0
  s_add_u32 s52, s52, s35
  s_add_u32 s52, s52, 143360
  buffer_load_dwordx4 a[108:111], v3, s[24:27], s52 offen sc1
  s_cmp_eq_u32 s60, 11
  s_cselect_b32 s35, 143360, 0
  s_add_u32 s52, s52, s35
  s_add_u32 s52, s52, 143360
  buffer_load_dwordx4 a[112:115], v3, s[24:27], s52 offen sc1
  s_cmp_eq_u32 s60, 12
  s_cselect_b32 s35, 143360, 0
  s_add_u32 s52, s52, s35
  s_add_u32 s52, s52, 143360
  buffer_load_dwordx4 a[116:119], v3, s[24:27], s52 offen sc1
  s_cmp_eq_u32 s60, 13
  s_cselect_b32 s35, 143360, 0
  s_add_u32 s52, s52, s35
  s_add_u32 s52, s52, 143360
  buffer_load_dwordx4 a[120:123], v3, s[24:27], s52 offen sc1
  s_cmp_eq_u32 s60, 14
  s_cselect_b32 s35, 143360, 0
  s_add_u32 s52, s52, s35
  s_add_u32 s52, s52, 143360
  buffer_load_dwordx4 a[124:127], v3, s[24:27], s52 offen sc1
  s_lshl_b32 s52, s43, 6
  s_add_u32 s52, s52, s44
  s_add_u32 s52, s52, 30720
  v_mfma_f32_16x16x32_bf16 v[96:99], v[4:7], a[0:3], 0
  v_mfma_f32_16x16x32_bf16 v[100:103], v[12:15], a[0:3], 0
  v_mfma_f32_16x16x32_bf16 v[96:99], v[4:7], a[4:7], v[96:99]
  v_mfma_f32_16x16x32_bf16 v[100:103], v[12:15], a[4:7], v[100:103]
  v_mfma_f32_16x16x32_bf16 v[96:99], v[4:7], a[8:11], v[96:99]
  v_mfma_f32_16x16x32_bf16 v[100:103], v[12:15], a[8:11], v[100:103]
  v_mfma_f32_16x16x32_bf16 v[96:99], v[4:7], a[12:15], v[96:99]
  v_mfma_f32_16x16x32_bf16 v[100:103], v[12:15], a[12:15], v[100:103]
  v_mfma_f32_16x16x32_bf16 v[96:99], v[4:7], a[16:19], v[96:99]
  v_mfma_f32_16x16x32_bf16 v[100:103], v[12:15], a[16:19], v[100:103]
  v_mfma_f32_16x16x32_bf16 v[96:99], v[4:7], a[20:23], v[96:99]
  v_mfma_f32_16x16x32_bf16 v[100:103], v[12:15], a[20:23], v[100:103]
  v_mfma_f32_16x16x32_bf16 v[96:99], v[4:7], a[24:27], v[96:99]
  v_mfma_f32_16x16x32_bf16 v[100:103], v[12:15], a[24:27], v[100:103]
  v_mfma_f32_16x16x32_bf16 v[96:99], v[4:7], a[28:31], v[96:99]
  v_mfma_f32_16x16x32_bf16 v[100:103], v[12:15], a[28:31], v[100:103]
  s_waitcnt vmcnt(20)
  v_mfma_f32_16x16x32_bf16 v[96:99], v[4:7], a[32:35], v[96:99]
  v_mfma_f32_16x16x32_bf16 v[100:103], v[12:15], a[32:35], v[100:103]
  v_mfma_f32_16x16x32_bf16 v[96:99], v[4:7], a[36:39], v[96:99]
  v_mfma_f32_16x16x32_bf16 v[100:103], v[12:15], a[36:39], v[100:103]
  v_mfma_f32_16x16x32_bf16 v[96:99], v[4:7], a[40:43], v[96:99]
  v_mfma_f32_16x16x32_bf16 v[100:103], v[12:15], a[40:43], v[100:103]
  v_mfma_f32_16x16x32_bf16 v[96:99], v[4:7], a[44:47], v[96:99]
  v_mfma_f32_16x16x32_bf16 v[100:103], v[12:15], a[44:47], v[100:103]
  s_waitcnt vmcnt(16)
  v_mfma_f32_16x16x32_bf16 v[96:99], v[4:7], a[48:51], v[96:99]
  v_mfma_f32_16x16x32_bf16 v[100:103], v[12:15], a[48:51], v[100:103]
  v_mfma_f32_16x16x32_bf16 v[96:99], v[4:7], a[52:55], v[96:99]
  v_mfma_f32_16x16x32_bf16 v[100:103], v[12:15], a[52:55], v[100:103]
  v_mfma_f32_16x16x32_bf16 v[96:99], v[4:7], a[56:59], v[96:99]
  v_mfma_f32_16x16x32_bf16 v[100:103], v[12:15], a[56:59], v[100:103]
  v_mfma_f32_16x16x32_bf16 v[96:99], v[4:7], a[60:63], v[96:99]
  v_mfma_f32_16x16x32_bf16 v[100:103], v[12:15], a[60:63], v[100:103]
  s_nop 6
  v_cvt_pk_bf16_f32 v104, v96, v97
  v_cvt_pk_bf16_f32 v105, v98, v99
  v_cvt_pk_bf16_f32 v106, v100, v101
  v_cvt_pk_bf16_f32 v107, v102, v103
  buffer_store_dwordx4 v[104:107], v8, s[8:11], s53 offen sc1
  s_waitcnt vmcnt(8)
  v_or_b32 v17, v17, v11
  v_cmp_gt_u32 vcc, 3, v17
  s_nop 1
  s_cbranch_vccnz L_spin_c
L_back_c:
  buffer_load_dwordx4 a[128:131], v2, s[24:27], s52 offen sc1
  s_add_u32 s52, s52, 143360
  buffer_load_dwordx4 a[132:135], v2, s[24:27], s52 offen sc1
  s_add_u32 s52, s52, 143360
  buffer_load_dwordx4 a[136:139], v2, s[24:27], s52 offen sc1
  s_add_u32 s52, s52, 143360
  buffer_load_dwordx4 a[140:143], v2, s[24:27], s52 offen sc1
  s_add_u32 s52, s52, 143360
  buffer_load_dwordx4 a[144:147], v2, s[24:27], s52 offen sc1
  s_add_u32 s52, s52, 143360
  buffer_load_dwordx4 a[148:151], v2, s[24:27], s52 offen sc1
  s_add_u32 s52, s52, 143360
  buffer_load_dwordx4 a[152:155], v2, s[24:27], s52 offen sc1
  s_add_u32 s52, s52, 143360
  buffer_load_dwordx4 a[156:159], v2, s[24:27], s52 offen sc1
  s_add_u32 s52, s52, 143360
  buffer_load_dwordx4 a[160:163], v2, s[24:27], s52 offen sc1
  s_add_u32 s52, s52, 143360
  buffer_load_dwordx4 a[164:167], v2, s[24:27], s52 offen sc1
  s_add_u32 s52, s52, 143360
  buffer_load_dwordx4 a[168:171], v2, s[24:27], s52 offen sc1
  s_add_u32 s52, s52, 143360
  buffer_load_dwordx4 a[172:175], v2, s[24:27], s52 offen sc1
  s_add_u32 s52, s52, 143360
  buffer_load_dwordx4 a[176:179], v2, s[24:27], s52 offen sc1
  s_add_u32 s52, s52, 143360
  buffer_load_dwordx4 a[180:183], v2, s[24:27], s52 offen sc1
  s_add_u32 s52, s52, 143360
  buffer_load_dwordx4 a[184:187], v2, s[24:27], s52 offen sc1
  s_add_u32 s52, s52, 143360
  buffer_load_dwordx4 a[188:191], v2, s[24:27], s52 offen sc1
  s_add_u32 s53, s53, 384
  v_mfma_f32_16x16x32_bf16 v[112:115], v[4:7], a[64:67], 0
  v_mfma_f32_16x16x32_bf16 v[116:119], v[12:15], a[64:67], 0
  v_mfma_f32_16x16x32_bf16 v[112:115], v[4:7], a[68:71], v[112:115]
  v_mfma_f32_16x16x32_bf16 v[116:119], v[12:15], a[68:71], v[116:119]
  v_mfma_f32_16x16x32_bf16 v[112:115], v[4:7], a[72:75], v[112:115]
  v_mfma_f32_16x16x32_bf16 v[116:119], v[12:15], a[72:75], v[116:119]
  v_mfma_f32_16x16x32_bf16 v[112:115], v[4:7], a[76:79], v[112:115]
  v_mfma_f32_16x16x32_bf16 v[116:119], v[12:15], a[76:79], v[116:119]
  v_mfma_f32_16x16x32_bf16 v[112:115], v[4:7], a[80:83], v[112:115]
  v_mfma_f32_16x16x32_bf16 v[116:119], v[12:15], a[80:83], v[116:119]
  v_mfma_f32_16x16x32_bf16 v[112:115], v[4:7], a[84:87], v[112:115]
  v_mfma_f32_16x16x32_bf16 v[116:119], v[12:15], a[84:87], v[116:119]
  v_mfma_f32_16x16x32_bf16 v[112:115], v[4:7], a[88:91], v[112:115]
  v_mfma_f32_16x16x32_bf16 v[116:119], v[12:15], a[88:91], v[116:119]
  v_mfma_f32_16x16x32_bf16 v[112:115], v[4:7], a[92:95], v[112:115]
  v_mfma_f32_16x16x32_bf16 v[116:119], v[12:15], a[92:95], v[116:119]
  s_waitcnt vmcnt(21)
  v_mfma_f32_16x16x32_bf16 v[112:115], v[4:7], a[96:99], v[112:115]
  v_mfma_f32_16x16x32_bf16 v[116:119], v[12:15], a[96:99], v[116:119]
  v_mfma_f32_16x16x32_bf16 v[112:115], v[4:7], a[100:103], v[112:115]
  v_mfma_f32_16x16x32_bf16 v[116:119], v[12:15], a[100:103], v[116:119]
  v_mfma_f32_16x16x32_bf16 v[112:115], v[4:7], a[104:107], v[112:115]
  v_mfma_f32_16x16x32_bf16 v[116:119], v[12:15], a[104:107], v[116:119]
  v_mfma_f32_16x16x32_bf16 v[112:115], v[4:7], a[108:111], v[112:115]
  v_mfma_f32_16x16x32_bf16 v[116:119], v[12:15], a[108:111], v[116:119]
  s_waitcnt vmcnt(17)
  v_mfma_f32_16x16x32_bf16 v[112:115], v[4:7], a[112:115], v[112:115]
  v_mfma_f32_16x16x32_bf16 v[116:119], v[12:15], a[112:115], v[116:119]
  v_mfma_f32_16x16x32_bf16 v[112:115], v[4:7], a[116:119], v[112:115]
  v_mfma_f32_16x16x32_bf16 v[116:119], v[12:15], a[116:119], v[116:119]
  v_mfma_f32_16x16x32_bf16 v[112:115], v[4:7], a[120:123], v[112:115]
  v_mfma_f32_16x16x32_bf16 v[116:119], v[12:15], a[120:123], v[116:119]
  v_mfma_f32_16x16x32_bf16 v[112:115], v[4:7], a[124:127], v[112:115]
  v_mfma_f32_16x16x32_bf16 v[116:119], v[12:15], a[124:127], v[116:119]
  s_nop 6
  v_cvt_pk_bf16_f32 v120, v112, v113
  v_cvt_pk_bf16_f32 v121, v114, v115
  v_cvt_pk_bf16_f32 v122, v116, v117
  v_cvt_pk_bf16_f32 v123, v118, v119
  buffer_store_dwordx4 v[120:123], v8, s[8:11], s53 offen sc1
  s_mul_i32 s53, s43, 1792
  s_add_u32 s53, s53, s46
  s_add_u32 s53, s53, 768
  s_waitcnt vmcnt(13)
  v_mfma_f32_16x16x32_bf16 v[128:131], v[4:7], a[128:131], 0
  v_mfma_f32_16x16x32_bf16 v[132:135], v[12:15], a[128:131], 0
  v_mfma_f32_16x16x32_bf16 v[128:131], v[4:7], a[132:135], v[128:131]
  v_mfma_f32_16x16x32_bf16 v[132:135], v[12:15], a[132:135], v[132:135]
  v_mfma_f32_16x16x32_bf16 v[128:131], v[4:7], a[136:139], v[128:131]
  v_mfma_f32_16x16x32_bf16 v[132:135], v[12:15], a[136:139], v[132:135]
  v_mfma_f32_16x16x32_bf16 v[128:131], v[4:7], a[140:143], v[128:131]
  v_mfma_f32_16x16x32_bf16 v[132:135], v[12:15], a[140:143], v[132:135]
  s_waitcnt vmcnt(9)
  v_mfma_f32_16x16x32_bf16 v[128:131], v[4:7], a[144:147], v[128:131]
  v_mfma_f32_16x16x32_bf16 v[132:135], v[12:15], a[144:147], v[132:135]
  v_mfma_f32_16x16x32_bf16 v[128:131], v[4:7], a[148:151], v[128:131]
  v_mfma_f32_16x16x32_bf16 v[132:135], v[12:15], a[148:151], v[132:135]
  v_mfma_f32_16x16x32_bf16 v[128:131], v[4:7], a[152:155], v[128:131]
  v_mfma_f32_16x16x32_bf16 v[132:135], v[12:15], a[152:155], v[132:135]
  v_mfma_f32_16x16x32_bf16 v[128:131], v[4:7], a[156:159], v[128:131]
  v_mfma_f32_16x16x32_bf16 v[132:135], v[12:15], a[156:159], v[132:135]
  s_waitcnt vmcnt(5)
  v_mfma_f32_16x16x32_bf16 v[128:131], v[4:7], a[160:163], v[128:131]
  v_mfma_f32_16x16x32_bf16 v[132:135], v[12:15], a[160:163], v[132:135]
  v_mfma_f32_16x16x32_bf16 v[128:131], v[4:7], a[164:167], v[128:131]
  v_mfma_f32_16x16x32_bf16 v[132:135], v[12:15], a[164:167], v[132:135]
  v_mfma_f32_16x16x32_bf16 v[128:131], v[4:7], a[168:171], v[128:131]
  v_mfma_f32_16x16x32_bf16 v[132:135], v[12:15], a[168:171], v[132:135]
  v_mfma_f32_16x16x32_bf16 v[128:131], v[4:7], a[172:175], v[128:131]
  v_mfma_f32_16x16x32_bf16 v[132:135], v[12:15], a[172:175], v[132:135]
  s_waitcnt vmcnt(1)
  v_mfma_f32_16x16x32_bf16 v[128:131], v[4:7], a[176:179], v[128:131]
  v_mfma_f32_16x16x32_bf16 v[132:135], v[12:15], a[176:179], v[132:135]
  v_mfma_f32_16x16x32_bf16 v[128:131], v[4:7], a[180:183], v[128:131]
  v_mfma_f32_16x16x32_bf16 v[132:135], v[12:15], a[180:183], v[132:135]
  v_mfma_f32_16x16x32_bf16 v[128:131], v[4:7], a[184:187], v[128:131]
  v_mfma_f32_16x16x32_bf16 v[132:135], v[12:15], a[184:187], v[132:135]
  v_mfma_f32_16x16x32_bf16 v[128:131], v[4:7], a[188:191], v[128:131]
  v_mfma_f32_16x16x32_bf16 v[132:135], v[12:15], a[188:191], v[132:135]
  s_nop 6
  v_cvt_pk_bf16_f32 v136, v128, v129
  v_cvt_pk_bf16_f32 v137, v130, v131
  v_cvt_pk_bf16_f32 v138, v132, v133
  v_cvt_pk_bf16_f32 v139, v134, v135
  buffer_store_dwordx4 v[136:139], v1, s[8:11], s53 offen sc1
L_exit:
  s_endpgm
L_spin_arm:
  buffer_load_dword v14, v10, s[4:7], s54 offen sc1
  s_add_u32 s37, s37, 1
  s_cmp_gt_u32 s37, 0x100000
  s_waitcnt vmcnt(0)
  s_cbranch_scc1 L_back_arm
  v_cmp_gt_u32 vcc, 1, v14
  s_nop 3
  s_cbranch_vccnz L_spin_arm
  s_branch L_back_arm
L_pre_a:
  s_waitcnt vmcnt(0)
  v_mov_b32 v10, 3
  buffer_store_dword v10, v16, s[24:27], s51 offen sc1
L_spin_a:
  buffer_load_dword v17, v18, s[24:27], s50 offen sc1
  s_add_u32 s37, s37, 1
  s_cmp_gt_u32 s37, 0x100000
  s_waitcnt vmcnt(0)
  s_cbranch_scc1 L_back_a
  v_or_b32 v17, v17, v11
  v_cmp_gt_u32 vcc, 1, v17
  s_nop 3
  s_cbranch_vccnz L_spin_a
  s_branch L_back_a
L_spin_b:
  buffer_load_dword v17, v18, s[24:27], s50 offen sc1
  s_add_u32 s37, s37, 1
  s_cmp_gt_u32 s37, 0x100000
  s_waitcnt vmcnt(0)
  s_cbranch_scc1 L_back_b
  v_or_b32 v17, v17, v11
  v_cmp_gt_u32 vcc, 2, v17
  s_nop 3
  s_cbranch_vccnz L_spin_b
  s_branch L_back_b
L_spin_c:
  buffer_load_dword v17, v18, s[24:27], s50 offen sc1
  s_add_u32 s37, s37, 1
  s_cmp_gt_u32 s37, 0x100000
  s_waitcnt vmcnt(0)
  s_cbranch_scc1 L_back_c
  v_or_b32 v17, v17, v11
  v_cmp_gt_u32 vcc, 3, v17
  s_nop 3
  s_cbranch_vccnz L_spin_c
  s_branch L_back_c
L_own0:
  v_accvgpr_write_b32 a0, v64
  v_accvgpr_write_b32 a1, v65
  v_accvgpr_write_b32 a2, v66
  v_accvgpr_write_b32 a3, v67
  buffer_store_dwordx4 v[64:67], v3, s[24:27], s55 offen sc1
  s_branch L_ownb0
L_own1:
  v_accvgpr_write_b32 a0, v68
  v_accvgpr_write_b32 a1, v69
  v_accvgpr_write_b32 a2, v70
  v_accvgpr_write_b32 a3, v71
  buffer_store_dwordx4 v[68:71], v3, s[24:27], s55 offen offset:1024 sc1
  s_branch L_ownb1
L_own2:
  v_accvgpr_write_b32 a0, v72
  v_accvgpr_write_b32 a1, v73
  v_accvgpr_write_b32 a2, v74
  v_accvgpr_write_b32 a3, v75
  buffer_store_dwordx4 v[72:75], v3, s[24:27], s55 offen offset:2048 sc1
  s_branch L_ownb2
L_own3:
  v_accvgpr_write_b32 a0, v76
  v_accvgpr_write_b32 a1, v77
  v_accvgpr_write_b32 a2, v78
  v_accvgpr_write_b32 a3, v79
  buffer_store_dwordx4 v[76:79], v3, s[24:27], s55 offen offset:3072 sc1
  s_branch L_ownb3
L_own4:
  v_accvgpr_write_b32 a0, v80
  v_accvgpr_write_b32 a1, v81
  v_accvgpr_write_b32 a2, v82
  v_accvgpr_write_b32 a3, v83
  buffer_store_dwordx4 v[80:83], v3, s[24:27], s55 offen sc1
  s_branch L_ownb4
L_own5:
  v_accvgpr_write_b32 a0, v44
  v_accvgpr_write_b32 a1, v45
  v_accvgpr_write_b32 a2, v46
  v_accvgpr_write_b32 a3, v47
  buffer_store_dwordx4 v[44:47], v3, s[24:27], s55 offen offset:1024 sc1
  s_branch L_ownb5
L_own6:
  v_accvgpr_write_b32 a0, v48
  v_accvgpr_write_b32 a1, v49
  v_accvgpr_write_b32 a2, v50
  v_accvgpr_write_b32 a3, v51
  buffer_store_dwordx4 v[48:51], v3, s[24:27], s55 offen offset:2048 sc1
  s_branch L_ownb6
L_own7:
  v_accvgpr_write_b32 a0, v52
  v_accvgpr_write_b32 a1, v53
  v_accvgpr_write_b32 a2, v54
  v_accvgpr_write_b32 a3, v55
  buffer_store_dwordx4 v[52:55], v3, s[24:27], s55 offen offset:3072 sc1
  s_branch L_ownb7
L_own8:
  v_accvgpr_write_b32 a0, v56
  v_accvgpr_write_b32 a1, v57
  v_accvgpr_write_b32 a2, v58
  v_accvgpr_write_b32 a3, v59
  buffer_store_dwordx4 v[56:59], v3, s[24:27], s55 offen sc1
  s_branch L_ownb8
L_own9:
  v_accvgpr_write_b32 a0, v60
  v_accvgpr_write_b32 a1, v61
  v_accvgpr_write_b32 a2, v62
  v_accvgpr_write_b32 a3, v63
  buffer_store_dwordx4 v[60:63], v3, s[24:27], s55 offen offset:1024 sc1
  s_branch L_ownb9
L_own10:
  v_accvgpr_write_b32 a0, v64
  v_accvgpr_write_b32 a1, v65
  v_accvgpr_write_b32 a2, v66
  v_accvgpr_write_b32 a3, v67
  buffer_store_dwordx4 v[64:67], v3, s[24:27], s55 offen offset:2048 sc1
  s_branch L_ownb10
L_own11:
  v_accvgpr_write_b32 a0, v68
  v_accvgpr_write_b32 a1, v69
  v_accvgpr_write_b32 a2, v70
  v_accvgpr_write_b32 a3, v71
  buffer_store_dwordx4 v[68:71], v3, s[24:27], s55 offen offset:3072 sc1
  s_branch L_ownb11
L_own12:
  v_accvgpr_write_b32 a0, v72
  v_accvgpr_write_b32 a1, v73
  v_accvgpr_write_b32 a2, v74
  v_accvgpr_write_b32 a3, v75
  buffer_store_dwordx4 v[72:75], v3, s[24:27], s55 offen sc1
  s_branch L_ownb12
L_own13:
  v_accvgpr_write_b32 a0, v76
  v_accvgpr_write_b32 a1, v77
  v_accvgpr_write_b32 a2, v78
  v_accvgpr_write_b32 a3, v79
  buffer_store_dwordx4 v[76:79], v3, s[24:27], s55 offen offset:1024 sc1
  s_branch L_ownb13
L_own14:
  v_accvgpr_write_b32 a0, v80
  v_accvgpr_write_b32 a1, v81
  v_accvgpr_write_b32 a2, v82
  v_accvgpr_write_b32 a3, v83
  buffer_store_dwordx4 v[80:83], v3, s[24:27], s55 offen offset:2048 sc1
  s_branch L_ownb14
L_own15:
  v_accvgpr_write_b32 a64, v44
  v_accvgpr_write_b32 a65, v45
  v_accvgpr_write_b32 a66, v46
  v_accvgpr_write_b32 a67, v47
  buffer_store_dwordx4 v[44:47], v3, s[24:27], s55 offen offset:3072 sc1
  s_branch L_ownb15
L_own16:
  v_accvgpr_write_b32 a64, v48
  v_accvgpr_write_b32 a65, v49
  v_accvgpr_write_b32 a66, v50
  v_accvgpr_write_b32 a67, v51
  buffer_store_dwordx4 v[48:51], v3, s[24:27], s55 offen sc1
  s_branch L_ownb16
L_own17:
  v_accvgpr_write_b32 a64, v52
  v_accvgpr_write_b32 a65, v53
  v_accvgpr_write_b32 a66, v54
  v_accvgpr_write_b32 a67, v55
  buffer_store_dwordx4 v[52:55], v3, s[24:27], s55 offen offset:1024 sc1
  s_branch L_ownb17
L_own18:
  v_accvgpr_write_b32 a64, v56
  v_accvgpr_write_b32 a65, v57
  v_accvgpr_write_b32 a66, v58
  v_accvgpr_write_b32 a67, v59
  buffer_store_dwordx4 v[56:59], v3, s[24:27], s55 offen offset:2048 sc1
  s_branch L_ownb18
L_own19:
  v_accvgpr_write_b32 a64, v60
  v_accvgpr_write_b32 a65, v61
  v_accvgpr_write_b32 a66, v62
  v_accvgpr_write_b32 a67, v63
  buffer_store_dwordx4 v[60:63], v3, s[24:27], s55 offen offset:3072 sc1
  s_branch L_ownb19
L_own20:
  v_accvgpr_write_b32 a64, v64
  v_accvgpr_write_b32 a65, v65
  v_accvgpr_write_b32 a66, v66
  v_accvgpr_write_b32 a67, v67
  buffer_store_dwordx4 v[64:67], v3, s[24:27], s55 offen sc1
  s_branch L_ownb20
L_own21:
  v_accvgpr_write_b32 a64, v68
  v_accvgpr_write_b32 a65, v69
  v_accvgpr_write_b32 a66, v70
  v_accvgpr_write_b32 a67, v71
  buffer_store_dwordx4 v[68:71], v3, s[24:27], s55 offen offset:1024 sc1
  s_branch L_ownb21
L_own22:
  v_accvgpr_write_b32 a64, v72
  v_accvgpr_write_b32 a65, v73
  v_accvgpr_write_b32 a66, v74
  v_accvgpr_write_b32 a67, v75
  buffer_store_dwordx4 v[72:75], v3, s[24:27], s55 offen offset:2048 sc1
  s_branch L_ownb22
L_own23:
  v_accvgpr_write_b32 a64, v76
  v_accvgpr_write_b32 a65, v77
  v_accvgpr_write_b32 a66, v78
  v_accvgpr_write_b32 a67, v79
  buffer_store_dwordx4 v[76:79], v3, s[24:27], s55 offen offset:3072 sc1
  s_branch L_ownb23
L_own24:
  v_accvgpr_write_b32 a64, v80
  v_accvgpr_write_b32 a65, v81
  v_accvgpr_write_b32 a66, v82
  v_accvgpr_write_b32 a67, v83
  buffer_store_dwordx4 v[80:83], v3, s[24:27], s55 offen sc1
  s_branch L_ownb24
L_own25:
  v_accvgpr_write_b32 a64, v44
  v_accvgpr_write_b32 a65, v45
  v_accvgpr_write_b32 a66, v46
  v_accvgpr_write_b32 a67, v47
  buffer_store_dwordx4 v[44:47], v3, s[24:27], s55 offen offset:1024 sc1
  s_branch L_ownb25
L_own26:
  v_accvgpr_write_b32 a64, v48
  v_accvgpr_write_b32 a65, v49
  v_accvgpr_write_b32 a66, v50
  v_accvgpr_write_b32 a67, v51
  buffer_store_dwordx4 v[48:51], v3, s[24:27], s55 offen offset:2048 sc1
  s_branch L_ownb26
L_own27:
  v_accvgpr_write_b32 a64, v52
  v_accvgpr_write_b32 a65, v53
  v_accvgpr_write_b32 a66, v54
  v_accvgpr_write_b32 a67, v55
  buffer_store_dwordx4 v[52:55], v3, s[24:27], s55 offen offset:3072 sc1
  s_branch L_ownb27
L_own28:
  v_accvgpr_write_b32 a64, v56
  v_accvgpr_write_b32 a65, v57
  v_accvgpr_write_b32 a66, v58
  v_accvgpr_write_b32 a67, v59
  buffer_store_dwordx4 v[56:59], v3, s[24:27], s55 offen sc1
  s_branch L_ownb28
L_own29:
  v_accvgpr_write_b32 a64, v60
  v_accvgpr_write_b32 a65, v61
  v_accvgpr_write_b32 a66, v62
  v_accvgpr_write_b32 a67, v63
  buffer_store_dwordx4 v[60:63], v3, s[24:27], s55 offen offset:1024 sc1
  s_branch L_ownb29
L_check:
  s_cmp_lg_u32 s36, 0
  s_cbranch_scc1 L_checked
L_fallback:
  s_mov_b32 s36, 1
  s_waitcnt vmcnt(0) lgkmcnt(0)
  s_barrier
  v_lshrrev_b32 v9, 7, v0
  v_mul_u32_u24 v9, 10, v9
  v_bfe_u32 v10, v0, 3, 1
  v_add_u32 v9, v9, v10
  v_mul_u32_u24 v9, 1056, v9
  v_and_b32 v10, 7, v0
  v_lshl_add_u32 v9, v10, 2, v9
  v_add_u32 v15, 1024, v9
  v_mov_b32 v12, 0
  v_mov_b32 v89, 0xff800000
  v_mov_b32 v90, 0xff800000
  v_mov_b32 v91, 0xff800000
  v_mov_b32 v92, 0xff800000
  v_mov_b32 v93, 0xff800000
  ds_write_b32 v15, v89 offset:0
  ds_write_b32 v15, v90 offset:2112
  ds_write_b32 v15, v91 offset:4224
  ds_write_b32 v15, v92 offset:6336
  ds_write_b32 v15, v93 offset:8448
  s_mov_b32 s37, 1
L_fb_loop:
  s_and_b32 s33, s37, 31
  s_lshl_b32 s33, s33, 14
  s_add_u32 m0, s29, 0
  s_nop 0
  buffer_load_dwordx4 v1, s[12:15], s33 offen nt lds
  s_add_u32 m0, s29, 32
  s_nop 0
  buffer_load_dwordx4 v1, s[12:15], s33 offen offset:1024 nt lds
  s_add_u32 m0, s29, 64
  s_nop 0
  buffer_load_dwordx4 v1, s[12:15], s33 offen offset:2048 nt lds
  s_add_u32 m0, s29, 96
  s_nop 0
  buffer_load_dwordx4 v1, s[12:15], s33 offen offset:3072 nt lds
  s_waitcnt vmcnt(0)
  s_barrier
  ds_read_b128 a[160:163], v4 offset:0
  ds_read_b128 a[164:167], v4 offset:64
  ds_read_b128 a[168:171], v4 offset:128
  ds_read_b128 a[172:175], v4 offset:192
  ds_read_b128 a[176:179], v4 offset:256
  ds_read_b128 a[180:183], v4 offset:320
  ds_read_b128 a[184:187], v4 offset:384
  ds_read_b128 a[188:191], v4 offset:448
  s_waitcnt lgkmcnt(0)
  s_barrier
  v_mfma_f32_16x16x32_bf16 v[24:27], a[160:163], a[0:3], 0
  v_mfma_f32_16x16x32_bf16 v[24:27], a[164:167], a[20:23], v[24:27]
  v_mfma_f32_16x16x32_bf16 v[24:27], a[168:171], a[40:43], v[24:27]
  v_mfma_f32_16x16x32_bf16 v[24:27], a[172:175], a[60:63], v[24:27]
  v_mfma_f32_16x16x32_bf16 v[24:27], a[176:179], a[80:83], v[24:27]
  v_mfma_f32_16x16x32_bf16 v[24:27], a[180:183], a[100:103], v[24:27]
  v_mfma_f32_16x16x32_bf16 v[24:27], a[184:187], a[120:123], v[24:27]
  v_mfma_f32_16x16x32_bf16 v[24:27], a[188:191], a[140:143], v[24:27]
  v_mfma_f32_16x16x32_bf16 v[28:31], a[188:191], a[144:147], 0
  v_mfma_f32_16x16x32_bf16 v[28:31], a[184:187], a[124:127], v[28:31]
  v_mfma_f32_16x16x32_bf16 v[28:31], a[180:183], a[104:107], v[28:31]
  v_mfma_f32_16x16x32_bf16 v[28:31], a[176:179], a[84:87], v[28:31]
  v_mfma_f32_16x16x32_bf16 v[28:31], a[172:175], a[64:67], v[28:31]
  v_mfma_f32_16x16x32_bf16 v[28:31], a[168:171], a[44:47], v[28:31]
  v_mfma_f32_16x16x32_bf16 v[28:31], a[164:167], a[24:27], v[28:31]
  v_mfma_f32_16x16x32_bf16 v[28:31], a[160:163], a[4:7], v[28:31]
  v_mfma_f32_16x16x32_bf16 v[32:35], a[160:163], a[8:11], 0
  v_mfma_f32_16x16x32_bf16 v[32:35], a[164:167], a[28:31], v[32:35]
  v_mfma_f32_16x16x32_bf16 v[32:35], a[168:171], a[48:51], v[32:35]
  v_mfma_f32_16x16x32_bf16 v[32:35], a[172:175], a[68:71], v[32:35]
  v_mfma_f32_16x16x32_bf16 v[32:35], a[176:179], a[88:91], v[32:35]
  v_mfma_f32_16x16x32_bf16 v[32:35], a[180:183], a[108:111], v[32:35]
  v_mfma_f32_16x16x32_bf16 v[32:35], a[184:187], a[128:131], v[32:35]
  v_mfma_f32_16x16x32_bf16 v[32:35], a[188:191], a[148:151], v[32:35]
  v_mfma_f32_16x16x32_bf16 v[36:39], a[188:191], a[152:155], 0
  v_mfma_f32_16x16x32_bf16 v[36:39], a[184:187], a[132:135], v[36:39]
  v_mfma_f32_16x16x32_bf16 v[36:39], a[180:183], a[112:115], v[36:39]
  v_mfma_f32_16x16x32_bf16 v[36:39], a[176:179], a[92:95], v[36:39]
  v_mfma_f32_16x16x32_bf16 v[36:39], a[172:175], a[72:75], v[36:39]
  v_mfma_f32_16x16x32_bf16 v[36:39], a[168:171], a[52:55], v[36:39]
  v_mfma_f32_16x16x32_bf16 v[36:39], a[164:167], a[32:35], v[36:39]
  v_mfma_f32_16x16x32_bf16 v[36:39], a[160:163], a[12:15], v[36:39]
  v_mfma_f32_16x16x32_bf16 v[40:43], a[160:163], a[16:19], 0
  v_mfma_f32_16x16x32_bf16 v[40:43], a[164:167], a[36:39], v[40:43]
  v_mfma_f32_16x16x32_bf16 v[40:43], a[168:171], a[56:59], v[40:43]
  v_mfma_f32_16x16x32_bf16 v[40:43], a[172:175], a[76:79], v[40:43]
  v_mfma_f32_16x16x32_bf16 v[40:43], a[176:179], a[96:99], v[40:43]
  v_mfma_f32_16x16x32_bf16 v[40:43], a[180:183], a[116:119], v[40:43]
  v_mfma_f32_16x16x32_bf16 v[40:43], a[184:187], a[136:139], v[40:43]
  v_mfma_f32_16x16x32_bf16 v[40:43], a[188:191], a[156:159], v[40:43]
  v_max3_f32 v89, v24, v25, v89
  v_max3_f32 v89, v26, v27, v89
  v_max3_f32 v90, v28, v29, v90
  v_max3_f32 v90, v30, v31, v90
  v_max3_f32 v91, v32, v33, v91
  v_max3_f32 v91, v34, v35, v91
  v_max3_f32 v92, v36, v37, v92
  v_max3_f32 v92, v38, v39, v92
  v_max3_f32 v93, v40, v41, v93
  v_max3_f32 v93, v42, v43, v93
  s_add_u32 s37, s37, 1
  s_cmp_le_u32 s37, 32
  s_cbranch_scc1 L_fb_loop
  s_mov_b32 s33, 16384
  s_add_u32 m0, s29, 16896
  s_nop 0
  buffer_load_dwordx4 v1, s[12:15], s33 offen nt lds
  s_add_u32 m0, s29, 16928
  s_nop 0
  buffer_load_dwordx4 v1, s[12:15], s33 offen offset:1024 nt lds
  s_add_u32 m0, s29, 16960
  s_nop 0
  buffer_load_dwordx4 v1, s[12:15], s33 offen offset:2048 nt lds
  s_add_u32 m0, s29, 16992
  s_nop 0
  buffer_load_dwordx4 v1, s[12:15], s33 offen offset:3072 nt lds
  s_mov_b32 s33, 32768
  s_add_u32 m0, s29, 33792
  s_nop 0
  buffer_load_dwordx4 v1, s[12:15], s33 offen nt lds
  s_add_u32 m0, s29, 33824
  s_nop 0
  buffer_load_dwordx4 v1, s[12:15], s33 offen offset:1024 nt lds
  s_add_u32 m0, s29, 33856
  s_nop 0
  buffer_load_dwordx4 v1, s[12:15], s33 offen offset:2048 nt lds
  s_add_u32 m0, s29, 33888
  s_nop 0
  buffer_load_dwordx4 v1, s[12:15], s33 offen offset:3072 nt lds
  s_mov_b32 s33, 49152
  s_add_u32 m0, s29, 50688
  s_nop 0
  buffer_load_dwordx4 v1, s[12:15], s33 offen nt lds
  s_add_u32 m0, s29, 50720
  s_nop 0
  buffer_load_dwordx4 v1, s[12:15], s33 offen offset:1024 nt lds
  s_add_u32 m0, s29, 50752
  s_nop 0
  buffer_load_dwordx4 v1, s[12:15], s33 offen offset:2048 nt lds
  s_add_u32 m0, s29, 50784
  s_nop 0
  buffer_load_dwordx4 v1, s[12:15], s33 offen offset:3072 nt lds
  s_mov_b32 s33, 65536
  s_add_u32 m0, s29, 0
  s_nop 0
  buffer_load_dwordx4 v1, s[12:15], s33 offen nt lds
  s_add_u32 m0, s29, 32
  s_nop 0
  buffer_load_dwordx4 v1, s[12:15], s33 offen offset:1024 nt lds
  s_add_u32 m0, s29, 64
  s_nop 0
  buffer_load_dwordx4 v1, s[12:15], s33 offen offset:2048 nt lds
  s_add_u32 m0, s29, 96
  s_nop 0
  buffer_load_dwordx4 v1, s[12:15], s33 offen offset:3072 nt lds
  s_mov_b32 s34, 0
  s_add_u32 m0, s29, 146944
  s_nop 0
  buffer_load_dwordx4 v1, s[16:19], s34 offen nt lds
  s_add_u32 m0, s29, 146976
  s_nop 0
  buffer_load_dwordx4 v1, s[16:19], s34 offen offset:1024 nt lds
  s_add_u32 m0, s29, 147008
  s_nop 0
  buffer_load_dwordx4 v1, s[16:19], s34 offen offset:2048 nt lds
  s_add_u32 m0, s29, 147040
  s_nop 0
  buffer_load_dwordx4 v1, s[16:19], s34 offen offset:3072 nt lds
  s_mov_b32 s34, 16384
  s_add_u32 m0, s29, 96256
  s_nop 0
  buffer_load_dwordx4 v1, s[16:19], s34 offen nt lds
  s_add_u32 m0, s29, 96288
  s_nop 0
  buffer_load_dwordx4 v1, s[16:19], s34 offen offset:1024 nt lds
  s_add_u32 m0, s29, 96320
  s_nop 0
  buffer_load_dwordx4 v1, s[16:19], s34 offen offset:2048 nt lds
  s_add_u32 m0, s29, 96352
  s_nop 0
  buffer_load_dwordx4 v1, s[16:19], s34 offen offset:3072 nt lds
  s_mov_b32 s34, 32768
  s_add_u32 m0, s29, 113152
  s_nop 0
  buffer_load_dwordx4 v1, s[16:19], s34 offen nt lds
  s_add_u32 m0, s29, 113184
  s_nop 0
  buffer_load_dwordx4 v1, s[16:19], s34 offen offset:1024 nt lds
  s_add_u32 m0, s29, 113216
  s_nop 0
  buffer_load_dwordx4 v1, s[16:19], s34 offen offset:2048 nt lds
  s_add_u32 m0, s29, 113248
  s_nop 0
  buffer_load_dwordx4 v1, s[16:19], s34 offen offset:3072 nt lds
  ds_max_f32 v15, v89 offset:0
  ds_max_f32 v15, v90 offset:2112
  ds_max_f32 v15, v91 offset:4224
  ds_max_f32 v15, v92 offset:6336
  ds_max_f32 v15, v93 offset:8448
  s_waitcnt vmcnt(0) lgkmcnt(0)
  s_barrier
  ds_read_b32 v89, v15 offset:0
  s_waitcnt lgkmcnt(0)
  v_mul_f32 v89, s55, v89
  ds_read_b32 v90, v15 offset:2112
  s_waitcnt lgkmcnt(0)
  v_mul_f32 v90, s55, v90
  ds_read_b32 v91, v15 offset:4224
  s_waitcnt lgkmcnt(0)
  v_mul_f32 v91, s55, v91
  ds_read_b32 v92, v15 offset:6336
  s_waitcnt lgkmcnt(0)
  v_mul_f32 v92, s55, v92
  ds_read_b32 v93, v15 offset:8448
  s_waitcnt lgkmcnt(0)
  v_mul_f32 v93, s55, v93
  v_fma_f32 v24, v24, s32, v89
  v_fma_f32 v25, v25, s32, v89
  v_fma_f32 v26, v26, s32, v89
  v_fma_f32 v27, v27, s32, v89
  v_exp_f32 v24, v24
  v_exp_f32 v25, v25
  v_exp_f32 v26, v26
  v_exp_f32 v27, v27
  v_cvt_pk_bf16_f32 v44, v24, v25
  v_cvt_pk_bf16_f32 v45, v26, v27
  v_add_f32 v84, v24, v25
  v_add_f32 v84, v84, v26
  v_add_f32 v84, v84, v27
  ds_write_b64 v7, v[44:45] offset:10240
  v_fma_f32 v28, v28, s32, v90
  v_fma_f32 v29, v29, s32, v90
  v_fma_f32 v30, v30, s32, v90
  v_fma_f32 v31, v31, s32, v90
  v_exp_f32 v28, v28
  v_exp_f32 v29, v29
  v_exp_f32 v30, v30
  v_exp_f32 v31, v31
  v_cvt_pk_bf16_f32 v48, v28, v29
  v_cvt_pk_bf16_f32 v49, v30, v31
  v_add_f32 v85, v28, v29
  v_add_f32 v85, v85, v30
  v_add_f32 v85, v85, v31
  ds_write_b64 v7, v[48:49] offset:10752
  v_fma_f32 v32, v32, s32, v91
  v_fma_f32 v33, v33, s32, v91
  v_fma_f32 v34, v34, s32, v91
  v_fma_f32 v35, v35, s32, v91
  v_exp_f32 v32, v32
  v_exp_f32 v33, v33
  v_exp_f32 v34, v34
  v_exp_f32 v35, v35
  v_cvt_pk_bf16_f32 v52, v32, v33
  v_cvt_pk_bf16_f32 v53, v34, v35
  v_add_f32 v86, v32, v33
  v_add_f32 v86, v86, v34
  v_add_f32 v86, v86, v35
  ds_write_b64 v7, v[52:53] offset:11264
  v_fma_f32 v36, v36, s32, v92
  v_fma_f32 v37, v37, s32, v92
  v_fma_f32 v38, v38, s32, v92
  v_fma_f32 v39, v39, s32, v92
  v_exp_f32 v36, v36
  v_exp_f32 v37, v37
  v_exp_f32 v38, v38
  v_exp_f32 v39, v39
  v_cvt_pk_bf16_f32 v56, v36, v37
  v_cvt_pk_bf16_f32 v57, v38, v39
  v_add_f32 v87, v36, v37
  v_add_f32 v87, v87, v38
  v_add_f32 v87, v87, v39
  ds_write_b64 v7, v[56:57] offset:11776
  v_fma_f32 v40, v40, s32, v93
  v_fma_f32 v41, v41, s32, v93
  v_fma_f32 v42, v42, s32, v93
  v_fma_f32 v43, v43, s32, v93
  v_exp_f32 v40, v40
  v_exp_f32 v41, v41
  v_exp_f32 v42, v42
  v_exp_f32 v43, v43
  v_cvt_pk_bf16_f32 v60, v40, v41
  v_cvt_pk_bf16_f32 v61, v42, v43
  v_add_f32 v88, v40, v41
  v_add_f32 v88, v88, v42
  v_add_f32 v88, v88, v43
  ds_write_b64 v7, v[60:61] offset:12288
  ds_read_b128 a[160:163], v4 offset:16896
  ds_read_b128 a[164:167], v4 offset:16960
  ds_read_b128 a[168:171], v4 offset:17024
  ds_read_b128 a[172:175], v4 offset:17088
  ds_read_b128 a[176:179], v4 offset:17152
  ds_read_b128 a[180:183], v4 offset:17216
  ds_read_b128 a[184:187], v4 offset:17280
  ds_read_b128 a[188:191], v4 offset:17344
  s_waitcnt vmcnt(0) lgkmcnt(0)
  s_barrier
  v_mfma_f32_16x16x32_bf16 v[24:27], a[160:163], a[0:3], 0
  s_mov_b32 s33, 81920
  ds_read_b64_tr_b16 a[192:193], v5 offset:50688
  s_add_u32 m0, s29, 16896
  v_mfma_f32_16x16x32_bf16 v[24:27], a[164:167], a[20:23], v[24:27]
  s_mov_b32 s34, 49152
  ds_read_b64_tr_b16 a[194:195], v6 offset:50688
  v_mfma_f32_16x16x32_bf16 v[24:27], a[168:171], a[40:43], v[24:27]
  buffer_load_dwordx4 v1, s[12:15], s33 offen nt lds
  s_add_u32 m0, s29, 16928
  v_mfma_f32_16x16x32_bf16 v[24:27], a[172:175], a[60:63], v[24:27]
  ds_read_b64 v[46:47], v8 offset:10240
  v_mfma_f32_16x16x32_bf16 v[24:27], a[176:179], a[80:83], v[24:27]
  ds_read_b64 v[50:51], v8 offset:10752
  v_mfma_f32_16x16x32_bf16 v[24:27], a[180:183], a[100:103], v[24:27]
  ds_read_b64 v[54:55], v8 offset:11264
  v_mfma_f32_16x16x32_bf16 v[24:27], a[184:187], a[120:123], v[24:27]
  ds_read_b64 v[58:59], v8 offset:11776
  v_mfma_f32_16x16x32_bf16 v[24:27], a[188:191], a[140:143], v[24:27]
  ds_read_b64 v[62:63], v8 offset:12288
  v_mfma_f32_16x16x32_bf16 v[28:31], a[188:191], a[144:147], 0
  ds_read_b64_tr_b16 a[196:197], v5 offset:50720
  v_mfma_f32_16x16x32_bf16 v[28:31], a[184:187], a[124:127], v[28:31]
  ds_read_b64_tr_b16 a[198:199], v6 offset:50720
  v_mfma_f32_16x16x32_bf16 v[28:31], a[180:183], a[104:107], v[28:31]
  ds_read_b64_tr_b16 a[200:201], v5 offset:50752
  v_mfma_f32_16x16x32_bf16 v[28:31], a[176:179], a[84:87], v[28:31]
  buffer_load_dwordx4 v1, s[12:15], s33 offen offset:1024 nt lds
  v_fma_f32 v24, v24, s32, v89
  v_mfma_f32_16x16x32_bf16 v[28:31], a[172:175], a[64:67], v[28:31]
  s_add_u32 m0, s29, 16960
  ds_read_b64_tr_b16 a[202:203], v6 offset:50752
  v_fma_f32 v25, v25, s32, v89
  v_mfma_f32_16x16x32_bf16 v[28:31], a[168:171], a[44:47], v[28:31]
  ds_read_b64_tr_b16 a[204:205], v5 offset:50784
  v_fma_f32 v26, v26, s32, v89
  v_mfma_f32_16x16x32_bf16 v[28:31], a[164:167], a[24:27], v[28:31]
  ds_read_b64_tr_b16 a[206:207], v6 offset:50784
  v_fma_f32 v27, v27, s32, v89
  v_mfma_f32_16x16x32_bf16 v[28:31], a[160:163], a[4:7], v[28:31]
  v_exp_f32 v24, v24
  v_mfma_f32_16x16x32_bf16 v[32:35], a[160:163], a[8:11], 0
  v_exp_f32 v25, v25
  v_mfma_f32_16x16x32_bf16 v[32:35], a[164:167], a[28:31], v[32:35]
  v_exp_f32 v26, v26
  v_mfma_f32_16x16x32_bf16 v[32:35], a[168:171], a[48:51], v[32:35]
  v_exp_f32 v27, v27
  v_mfma_f32_16x16x32_bf16 v[32:35], a[172:175], a[68:71], v[32:35]
  ds_read_b64_tr_b16 a[208:209], v5 offset:50816
  v_cvt_pk_bf16_f32 v64, v24, v25
  v_mfma_f32_16x16x32_bf16 v[32:35], a[176:179], a[88:91], v[32:35]
  buffer_load_dwordx4 v1, s[12:15], s33 offen offset:2048 nt lds
  v_cvt_pk_bf16_f32 v65, v26, v27
  v_mfma_f32_16x16x32_bf16 v[32:35], a[180:183], a[108:111], v[32:35]
  s_add_u32 m0, s29, 16992
  ds_write_b64 v7, v[64:65] offset:0
  v_mfma_f32_16x16x32_bf16 v[32:35], a[184:187], a[128:131], v[32:35]
  ds_read_b64_tr_b16 a[210:211], v6 offset:50816
  v_fma_f32 v28, v28, s32, v90
  v_mfma_f32_16x16x32_bf16 v[32:35], a[188:191], a[148:151], v[32:35]
  ds_read_b64_tr_b16 a[212:213], v5 offset:50848
  v_fma_f32 v29, v29, s32, v90
  v_mfma_f32_16x16x32_bf16 v[36:39], a[188:191], a[152:155], 0
  ds_read_b64_tr_b16 a[214:215], v6 offset:50848
  v_fma_f32 v30, v30, s32, v90
  v_mfma_f32_16x16x32_bf16 v[36:39], a[184:187], a[132:135], v[36:39]
  ds_read_b64_tr_b16 a[216:217], v5 offset:50880
  v_fma_f32 v31, v31, s32, v90
  v_mfma_f32_16x16x32_bf16 v[36:39], a[180:183], a[112:115], v[36:39]
  v_exp_f32 v28, v28
  v_mfma_f32_16x16x32_bf16 v[36:39], a[176:179], a[92:95], v[36:39]
  v_exp_f32 v29, v29
  v_mfma_f32_16x16x32_bf16 v[36:39], a[172:175], a[72:75], v[36:39]
  v_exp_f32 v30, v30
  v_mfma_f32_16x16x32_bf16 v[36:39], a[168:171], a[52:55], v[36:39]
  buffer_load_dwordx4 v1, s[12:15], s33 offen offset:3072 nt lds
  v_cvt_pk_bf16_f32 v68, v28, v29
  v_mfma_f32_16x16x32_bf16 v[36:39], a[164:167], a[32:35], v[36:39]
  s_add_u32 m0, s29, 130048
  v_exp_f32 v31, v31
  v_mfma_f32_16x16x32_bf16 v[36:39], a[160:163], a[12:15], v[36:39]
  s_mov_b32 s33, 98304
  ds_read_b64_tr_b16 a[218:219], v6 offset:50880
  v_cvt_pk_bf16_f32 v69, v30, v31
  v_mfma_f32_16x16x32_bf16 v[40:43], a[160:163], a[16:19], 0
  ds_write_b64 v7, v[68:69] offset:512
  v_mfma_f32_16x16x32_bf16 v[40:43], a[164:167], a[36:39], v[40:43]
  ds_read_b64_tr_b16 a[220:221], v5 offset:50912
  v_fma_f32 v32, v32, s32, v91
  v_mfma_f32_16x16x32_bf16 v[40:43], a[168:171], a[56:59], v[40:43]
  ds_read_b64_tr_b16 a[222:223], v6 offset:50912
  v_fma_f32 v33, v33, s32, v91
  v_mfma_f32_16x16x32_bf16 v[40:43], a[172:175], a[76:79], v[40:43]
  ds_read_b128 a[160:163], v4 offset:33792
  v_fma_f32 v34, v34, s32, v91
  v_mfma_f32_16x16x32_bf16 v[40:43], a[176:179], a[96:99], v[40:43]
  ds_read_b128 a[164:167], v4 offset:33856
  v_fma_f32 v35, v35, s32, v91
  v_mfma_f32_16x16x32_bf16 v[40:43], a[180:183], a[116:119], v[40:43]
  v_exp_f32 v32, v32
  v_mfma_f32_16x16x32_bf16 v[40:43], a[184:187], a[136:139], v[40:43]
  buffer_load_dwordx4 v1, s[16:19], s34 offen nt lds
  v_fma_f32 v36, v36, s32, v92
  v_mfma_f32_16x16x32_bf16 v[40:43], a[188:191], a[156:159], v[40:43]
  s_waitcnt lgkmcnt(5)
  s_add_u32 m0, s29, 130080
  v_exp_f32 v33, v33
  v_mfma_f32_16x16x32_bf16 v[96:99], v[44:47], a[192:195], 0
  v_exp_f32 v34, v34
  v_mfma_f32_16x16x32_bf16 v[100:103], v[48:51], a[192:195], 0
  v_exp_f32 v35, v35
  v_mfma_f32_16x16x32_bf16 v[104:107], v[52:55], a[192:195], 0
  ds_read_b128 a[168:171], v4 offset:33920
  v_cvt_pk_bf16_f32 v72, v32, v33
  v_mfma_f32_16x16x32_bf16 v[108:111], v[56:59], a[192:195], 0
  ds_read_b128 a[172:175], v4 offset:33984
  v_cvt_pk_bf16_f32 v73, v34, v35
  v_mfma_f32_16x16x32_bf16 v[112:115], v[60:63], a[192:195], 0
  ds_write_b64 v7, v[72:73] offset:1024
  v_mfma_f32_16x16x32_bf16 v[132:135], v[60:63], a[196:199], 0
  ds_read_b128 a[176:179], v4 offset:34048
  v_fma_f32 v37, v37, s32, v92
  v_mfma_f32_16x16x32_bf16 v[128:131], v[56:59], a[196:199], 0
  ds_read_b128 a[180:183], v4 offset:34112
  v_fma_f32 v38, v38, s32, v92
  v_mfma_f32_16x16x32_bf16 v[124:127], v[52:55], a[196:199], 0
  buffer_load_dwordx4 v1, s[16:19], s34 offen offset:1024 nt lds
  v_fma_f32 v39, v39, s32, v92
  v_mfma_f32_16x16x32_bf16 v[120:123], v[48:51], a[196:199], 0
  s_add_u32 m0, s29, 130112
  v_exp_f32 v36, v36
  v_mfma_f32_16x16x32_bf16 v[116:119], v[44:47], a[196:199], 0
  v_exp_f32 v37, v37
  v_mfma_f32_16x16x32_bf16 v[136:139], v[44:47], a[200:203], 0
  v_exp_f32 v38, v38
  v_mfma_f32_16x16x32_bf16 v[140:143], v[48:51], a[200:203], 0
  v_exp_f32 v39, v39
  v_mfma_f32_16x16x32_bf16 v[144:147], v[52:55], a[200:203], 0
  ds_read_b128 a[184:187], v4 offset:34176
  v_cvt_pk_bf16_f32 v76, v36, v37
  v_mfma_f32_16x16x32_bf16 v[148:151], v[56:59], a[200:203], 0
  ds_read_b128 a[188:191], v4 offset:34240
  v_cvt_pk_bf16_f32 v77, v38, v39
  v_mfma_f32_16x16x32_bf16 v[152:155], v[60:63], a[200:203], 0
  ds_write_b64 v7, v[76:77] offset:1536
  v_mfma_f32_16x16x32_bf16 v[172:175], v[60:63], a[204:207], 0
  v_fma_f32 v40, v40, s32, v93
  v_fma_f32 v41, v41, s32, v93
  v_mfma_f32_16x16x32_bf16 v[168:171], v[56:59], a[204:207], 0
  buffer_load_dwordx4 v1, s[16:19], s34 offen offset:2048 nt lds
  v_fma_f32 v42, v42, s32, v93
  v_mfma_f32_16x16x32_bf16 v[164:167], v[52:55], a[204:207], 0
  s_add_u32 m0, s29, 130144
  v_fma_f32 v43, v43, s32, v93
  v_add_f32 v84, v84, v24
  v_mfma_f32_16x16x32_bf16 v[160:163], v[48:51], a[204:207], 0
  v_exp_f32 v40, v40
  v_mfma_f32_16x16x32_bf16 v[156:159], v[44:47], a[204:207], 0
  v_exp_f32 v41, v41
  v_mfma_f32_16x16x32_bf16 v[176:179], v[44:47], a[208:211], 0
  v_exp_f32 v42, v42
  v_mfma_f32_16x16x32_bf16 v[180:183], v[48:51], a[208:211], 0
  v_exp_f32 v43, v43
  v_mfma_f32_16x16x32_bf16 v[184:187], v[52:55], a[208:211], 0
  v_cvt_pk_bf16_f32 v80, v40, v41
  v_cvt_pk_bf16_f32 v81, v42, v43
  v_mfma_f32_16x16x32_bf16 v[188:191], v[56:59], a[208:211], 0
  ds_write_b64 v7, v[80:81] offset:2048
  v_mfma_f32_16x16x32_bf16 v[192:195], v[60:63], a[208:211], 0
  v_add_f32 v84, v84, v25
  v_add_f32 v84, v84, v26
  v_mfma_f32_16x16x32_bf16 v[212:215], v[60:63], a[212:215], 0
  buffer_load_dwordx4 v1, s[16:19], s34 offen offset:3072 nt lds
  v_add_f32 v84, v84, v27
  v_mfma_f32_16x16x32_bf16 v[208:211], v[56:59], a[212:215], 0
  s_add_u32 m0, s29, 33792
  v_add_f32 v85, v85, v28
  v_add_f32 v85, v85, v29
  v_mfma_f32_16x16x32_bf16 v[204:207], v[52:55], a[212:215], 0
  s_mov_b32 s34, 65536
  v_add_f32 v85, v85, v30
  v_add_f32 v85, v85, v31
  v_mfma_f32_16x16x32_bf16 v[200:203], v[48:51], a[212:215], 0
  v_add_f32 v86, v86, v32
  v_add_f32 v86, v86, v33
  v_mfma_f32_16x16x32_bf16 v[196:199], v[44:47], a[212:215], 0
  v_add_f32 v86, v86, v34
  v_add_f32 v86, v86, v35
  v_mfma_f32_16x16x32_bf16 v[216:219], v[44:47], a[216:219], 0
  v_add_f32 v87, v87, v36
  v_add_f32 v87, v87, v37
  v_mfma_f32_16x16x32_bf16 v[220:223], v[48:51], a[216:219], 0
  v_add_f32 v87, v87, v38
  v_add_f32 v87, v87, v39
  v_mfma_f32_16x16x32_bf16 v[224:227], v[52:55], a[216:219], 0
  v_add_f32 v88, v88, v40
  v_add_f32 v88, v88, v41
  v_mfma_f32_16x16x32_bf16 v[228:231], v[56:59], a[216:219], 0
  v_add_f32 v88, v88, v42
  v_add_f32 v88, v88, v43
  v_mfma_f32_16x16x32_bf16 v[232:235], v[60:63], a[216:219], 0
  s_waitcnt lgkmcnt(0)
  v_mfma_f32_16x16x32_bf16 v[252:255], v[60:63], a[220:223], 0
  s_barrier
  v_mfma_f32_16x16x32_bf16 v[248:251], v[56:59], a[220:223], 0
  ds_read_b64_tr_b16 a[192:193], v5 offset:0
  v_mfma_f32_16x16x32_bf16 v[244:247], v[52:55], a[220:223], 0
  ds_read_b64_tr_b16 a[194:195], v6 offset:0
  v_mfma_f32_16x16x32_bf16 v[240:243], v[48:51], a[220:223], 0
  ds_read_b64 v[66:67], v8 offset:0
  v_mfma_f32_16x16x32_bf16 v[236:239], v[44:47], a[220:223], 0
  ds_read_b64 v[70:71], v8 offset:512
  v_mfma_f32_16x16x32_bf16 v[24:27], a[160:163], a[0:3], 0
  ds_read_b64 v[74:75], v8 offset:1024
  v_mfma_f32_16x16x32_bf16 v[24:27], a[164:167], a[20:23], v[24:27]
  ds_read_b64 v[78:79], v8 offset:1536
  v_mfma_f32_16x16x32_bf16 v[24:27], a[168:171], a[40:43], v[24:27]
  buffer_load_dwordx4 v1, s[12:15], s33 offen nt lds
  s_add_u32 m0, s29, 33824
  v_mfma_f32_16x16x32_bf16 v[24:27], a[172:175], a[60:63], v[24:27]
  ds_read_b64 v[82:83], v8 offset:2048
  v_mfma_f32_16x16x32_bf16 v[24:27], a[176:179], a[80:83], v[24:27]
  ds_read_b64_tr_b16 a[196:197], v5 offset:32
  v_mfma_f32_16x16x32_bf16 v[24:27], a[180:183], a[100:103], v[24:27]
  ds_read_b64_tr_b16 a[198:199], v6 offset:32
  v_mfma_f32_16x16x32_bf16 v[24:27], a[184:187], a[120:123], v[24:27]
  ds_read_b64_tr_b16 a[200:201], v5 offset:64
  v_mfma_f32_16x16x32_bf16 v[24:27], a[188:191], a[140:143], v[24:27]
  ds_read_b64_tr_b16 a[202:203], v6 offset:64
  v_mfma_f32_16x16x32_bf16 v[28:31], a[188:191], a[144:147], 0
  ds_read_b64_tr_b16 a[204:205], v5 offset:96
  v_mfma_f32_16x16x32_bf16 v[28:31], a[184:187], a[124:127], v[28:31]
  ds_read_b64_tr_b16 a[206:207], v6 offset:96
  v_mfma_f32_16x16x32_bf16 v[28:31], a[180:183], a[104:107], v[28:31]
  ds_read_b64_tr_b16 a[208:209], v5 offset:128
  v_mfma_f32_16x16x32_bf16 v[28:31], a[176:179], a[84:87], v[28:31]
  buffer_load_dwordx4 v1, s[12:15], s33 offen offset:1024 nt lds
  v_fma_f32 v24, v24, s32, v89
  v_mfma_f32_16x16x32_bf16 v[28:31], a[172:175], a[64:67], v[28:31]
  s_add_u32 m0, s29, 33856
  ds_read_b64_tr_b16 a[210:211], v6 offset:128
  v_fma_f32 v25, v25, s32, v89
  v_mfma_f32_16x16x32_bf16 v[28:31], a[168:171], a[44:47], v[28:31]
  ds_read_b64_tr_b16 a[212:213], v5 offset:160
  v_fma_f32 v26, v26, s32, v89
  v_mfma_f32_16x16x32_bf16 v[28:31], a[164:167], a[24:27], v[28:31]
  ds_read_b64_tr_b16 a[214:215], v6 offset:160
  v_fma_f32 v27, v27, s32, v89
  v_mfma_f32_16x16x32_bf16 v[28:31], a[160:163], a[4:7], v[28:31]
  v_exp_f32 v24, v24
  v_mfma_f32_16x16x32_bf16 v[32:35], a[160:163], a[8:11], 0
  v_exp_f32 v25, v25
  v_mfma_f32_16x16x32_bf16 v[32:35], a[164:167], a[28:31], v[32:35]
  v_exp_f32 v26, v26
  v_mfma_f32_16x16x32_bf16 v[32:35], a[168:171], a[48:51], v[32:35]
  v_exp_f32 v27, v27
  v_mfma_f32_16x16x32_bf16 v[32:35], a[172:175], a[68:71], v[32:35]
  ds_read_b64_tr_b16 a[216:217], v5 offset:192
  v_cvt_pk_bf16_f32 v44, v24, v25
  v_mfma_f32_16x16x32_bf16 v[32:35], a[176:179], a[88:91], v[32:35]
  buffer_load_dwordx4 v1, s[12:15], s33 offen offset:2048 nt lds
  v_cvt_pk_bf16_f32 v45, v26, v27
  v_mfma_f32_16x16x32_bf16 v[32:35], a[180:183], a[108:111], v[32:35]
  s_add_u32 m0, s29, 33888
  ds_write_b64 v7, v[44:45] offset:10240
  v_mfma_f32_16x16x32_bf16 v[32:35], a[184:187], a[128:131], v[32:35]
  ds_read_b64_tr_b16 a[218:219], v6 offset:192
  v_fma_f32 v28, v28, s32, v90
  v_mfma_f32_16x16x32_bf16 v[32:35], a[188:191], a[148:151], v[32:35]
  ds_read_b64_tr_b16 a[220:221], v5 offset:224
  v_fma_f32 v29, v29, s32, v90
  v_mfma_f32_16x16x32_bf16 v[36:39], a[188:191], a[152:155], 0
  ds_read_b64_tr_b16 a[222:223], v6 offset:224
  v_fma_f32 v30, v30, s32, v90
  v_mfma_f32_16x16x32_bf16 v[36:39], a[184:187], a[132:135], v[36:39]
  v_fma_f32 v31, v31, s32, v90
  v_add_f32 v84, v84, v24
  v_mfma_f32_16x16x32_bf16 v[36:39], a[180:183], a[112:115], v[36:39]
  v_exp_f32 v28, v28
  v_mfma_f32_16x16x32_bf16 v[36:39], a[176:179], a[92:95], v[36:39]
  v_exp_f32 v29, v29
  v_mfma_f32_16x16x32_bf16 v[36:39], a[172:175], a[72:75], v[36:39]
  v_exp_f32 v30, v30
  v_mfma_f32_16x16x32_bf16 v[36:39], a[168:171], a[52:55], v[36:39]
  buffer_load_dwordx4 v1, s[12:15], s33 offen offset:3072 nt lds
  v_cvt_pk_bf16_f32 v48, v28, v29
  v_mfma_f32_16x16x32_bf16 v[36:39], a[164:167], a[32:35], v[36:39]
  s_add_u32 m0, s29, 146944
  v_exp_f32 v31, v31
  v_mfma_f32_16x16x32_bf16 v[36:39], a[160:163], a[12:15], v[36:39]
  s_mov_b32 s33, 114688
  v_cvt_pk_bf16_f32 v49, v30, v31
  v_fma_f32 v32, v32, s32, v91
  v_mfma_f32_16x16x32_bf16 v[40:43], a[160:163], a[16:19], 0
  ds_write_b64 v7, v[48:49] offset:10752
  v_mfma_f32_16x16x32_bf16 v[40:43], a[164:167], a[36:39], v[40:43]
  ds_read_b128 a[160:163], v4 offset:50688
  v_fma_f32 v33, v33, s32, v91
  v_mfma_f32_16x16x32_bf16 v[40:43], a[168:171], a[56:59], v[40:43]
  ds_read_b128 a[164:167], v4 offset:50752
  v_fma_f32 v34, v34, s32, v91
  v_mfma_f32_16x16x32_bf16 v[40:43], a[172:175], a[76:79], v[40:43]
  ds_read_b128 a[168:171], v4 offset:50816
  v_fma_f32 v35, v35, s32, v91
  v_mfma_f32_16x16x32_bf16 v[40:43], a[176:179], a[96:99], v[40:43]
  v_exp_f32 v32, v32
  v_mfma_f32_16x16x32_bf16 v[40:43], a[180:183], a[116:119], v[40:43]
  v_exp_f32 v33, v33
  v_mfma_f32_16x16x32_bf16 v[40:43], a[184:187], a[136:139], v[40:43]
  buffer_load_dwordx4 v1, s[16:19], s34 offen nt lds
  v_cvt_pk_bf16_f32 v52, v32, v33
  v_mfma_f32_16x16x32_bf16 v[40:43], a[188:191], a[156:159], v[40:43]
  s_waitcnt lgkmcnt(4)
  s_add_u32 m0, s29, 146976
  v_exp_f32 v34, v34
  v_mfma_f32_16x16x32_bf16 v[96:99], v[64:67], a[192:195], v[96:99]
  v_exp_f32 v35, v35
  v_mfma_f32_16x16x32_bf16 v[100:103], v[68:71], a[192:195], v[100:103]
  ds_read_b128 a[172:175], v4 offset:50880
  v_cvt_pk_bf16_f32 v53, v34, v35
  v_mfma_f32_16x16x32_bf16 v[104:107], v[72:75], a[192:195], v[104:107]
  ds_write_b64 v7, v[52:53] offset:11264
  v_mfma_f32_16x16x32_bf16 v[108:111], v[76:79], a[192:195], v[108:111]
  ds_read_b128 a[176:179], v4 offset:50944
  v_fma_f32 v36, v36, s32, v92
  v_mfma_f32_16x16x32_bf16 v[112:115], v[80:83], a[192:195], v[112:115]
  ds_read_b128 a[180:183], v4 offset:51008
  v_fma_f32 v37, v37, s32, v92
  v_mfma_f32_16x16x32_bf16 v[132:135], v[80:83], a[196:199], v[132:135]
  ds_read_b128 a[184:187], v4 offset:51072
  v_fma_f32 v38, v38, s32, v92
  v_mfma_f32_16x16x32_bf16 v[128:131], v[76:79], a[196:199], v[128:131]
  ds_read_b128 a[188:191], v4 offset:51136
  v_fma_f32 v39, v39, s32, v92
  v_mfma_f32_16x16x32_bf16 v[124:127], v[72:75], a[196:199], v[124:127]
  buffer_load_dwordx4 v1, s[16:19], s34 offen offset:1024 nt lds
  v_fma_f32 v40, v40, s32, v93
  v_mfma_f32_16x16x32_bf16 v[120:123], v[68:71], a[196:199], v[120:123]
  s_add_u32 m0, s29, 147008
  v_exp_f32 v36, v36
  v_mfma_f32_16x16x32_bf16 v[116:119], v[64:67], a[196:199], v[116:119]
  v_exp_f32 v37, v37
  v_mfma_f32_16x16x32_bf16 v[136:139], v[64:67], a[200:203], v[136:139]
  v_exp_f32 v38, v38
  v_mfma_f32_16x16x32_bf16 v[140:143], v[68:71], a[200:203], v[140:143]
  v_exp_f32 v39, v39
  v_mfma_f32_16x16x32_bf16 v[144:147], v[72:75], a[200:203], v[144:147]
  v_cvt_pk_bf16_f32 v56, v36, v37
  v_cvt_pk_bf16_f32 v57, v38, v39
  v_mfma_f32_16x16x32_bf16 v[148:151], v[76:79], a[200:203], v[148:151]
  ds_write_b64 v7, v[56:57] offset:11776
  v_mfma_f32_16x16x32_bf16 v[152:155], v[80:83], a[200:203], v[152:155]
  v_fma_f32 v41, v41, s32, v93
  v_fma_f32 v42, v42, s32, v93
  v_mfma_f32_16x16x32_bf16 v[172:175], v[80:83], a[204:207], v[172:175]
  v_fma_f32 v43, v43, s32, v93
  v_add_f32 v84, v84, v25
  v_mfma_f32_16x16x32_bf16 v[168:171], v[76:79], a[204:207], v[168:171]
  buffer_load_dwordx4 v1, s[16:19], s34 offen offset:2048 nt lds
  v_add_f32 v84, v84, v26
  v_mfma_f32_16x16x32_bf16 v[164:167], v[72:75], a[204:207], v[164:167]
  s_add_u32 m0, s29, 147040
  v_exp_f32 v40, v40
  v_mfma_f32_16x16x32_bf16 v[160:163], v[68:71], a[204:207], v[160:163]
  v_exp_f32 v41, v41
  v_mfma_f32_16x16x32_bf16 v[156:159], v[64:67], a[204:207], v[156:159]
  v_exp_f32 v42, v42
  v_mfma_f32_16x16x32_bf16 v[176:179], v[64:67], a[208:211], v[176:179]
  v_exp_f32 v43, v43
  v_mfma_f32_16x16x32_bf16 v[180:183], v[68:71], a[208:211], v[180:183]
  v_cvt_pk_bf16_f32 v60, v40, v41
  v_cvt_pk_bf16_f32 v61, v42, v43
  v_mfma_f32_16x16x32_bf16 v[184:187], v[72:75], a[208:211], v[184:187]
  ds_write_b64 v7, v[60:61] offset:12288
  v_mfma_f32_16x16x32_bf16 v[188:191], v[76:79], a[208:211], v[188:191]
  v_add_f32 v84, v84, v27
  v_add_f32 v85, v85, v28
  v_mfma_f32_16x16x32_bf16 v[192:195], v[80:83], a[208:211], v[192:195]
  v_add_f32 v85, v85, v29
  v_add_f32 v85, v85, v30
  v_mfma_f32_16x16x32_bf16 v[212:215], v[80:83], a[212:215], v[212:215]
  buffer_load_dwordx4 v1, s[16:19], s34 offen offset:3072 nt lds
  v_add_f32 v85, v85, v31
  v_mfma_f32_16x16x32_bf16 v[208:211], v[76:79], a[212:215], v[208:211]
  s_add_u32 m0, s29, 50688
  v_add_f32 v86, v86, v32
  v_add_f32 v86, v86, v33
  v_mfma_f32_16x16x32_bf16 v[204:207], v[72:75], a[212:215], v[204:207]
  s_mov_b32 s34, 81920
  v_add_f32 v86, v86, v34
  v_add_f32 v86, v86, v35
  v_mfma_f32_16x16x32_bf16 v[200:203], v[68:71], a[212:215], v[200:203]
  v_add_f32 v87, v87, v36
  v_add_f32 v87, v87, v37
  v_mfma_f32_16x16x32_bf16 v[196:199], v[64:67], a[212:215], v[196:199]
  v_add_f32 v87, v87, v38
  v_add_f32 v87, v87, v39
  v_mfma_f32_16x16x32_bf16 v[216:219], v[64:67], a[216:219], v[216:219]
  v_add_f32 v88, v88, v40
  v_add_f32 v88, v88, v41
  v_mfma_f32_16x16x32_bf16 v[220:223], v[68:71], a[216:219], v[220:223]
  v_add_f32 v88, v88, v42
  v_add_f32 v88, v88, v43
  v_mfma_f32_16x16x32_bf16 v[224:227], v[72:75], a[216:219], v[224:227]
  v_mfma_f32_16x16x32_bf16 v[228:231], v[76:79], a[216:219], v[228:231]
  v_mfma_f32_16x16x32_bf16 v[232:235], v[80:83], a[216:219], v[232:235]
  v_mfma_f32_16x16x32_bf16 v[252:255], v[80:83], a[220:223], v[252:255]
  s_waitcnt lgkmcnt(0)
  s_barrier
  v_mfma_f32_16x16x32_bf16 v[248:251], v[76:79], a[220:223], v[248:251]
  ds_read_b64_tr_b16 a[192:193], v5 offset:16896
  v_mfma_f32_16x16x32_bf16 v[244:247], v[72:75], a[220:223], v[244:247]
  ds_read_b64_tr_b16 a[194:195], v6 offset:16896
  v_mfma_f32_16x16x32_bf16 v[240:243], v[68:71], a[220:223], v[240:243]
  ds_read_b64 v[46:47], v8 offset:10240
  v_mfma_f32_16x16x32_bf16 v[236:239], v[64:67], a[220:223], v[236:239]
  ds_read_b64 v[50:51], v8 offset:10752
  v_mfma_f32_16x16x32_bf16 v[24:27], a[160:163], a[0:3], 0
  ds_read_b64 v[54:55], v8 offset:11264
  v_mfma_f32_16x16x32_bf16 v[24:27], a[164:167], a[20:23], v[24:27]
  ds_read_b64 v[58:59], v8 offset:11776
  v_mfma_f32_16x16x32_bf16 v[24:27], a[168:171], a[40:43], v[24:27]
  buffer_load_dwordx4 v1, s[12:15], s33 offen nt lds
  s_add_u32 m0, s29, 50720
  v_mfma_f32_16x16x32_bf16 v[24:27], a[172:175], a[60:63], v[24:27]
  ds_read_b64 v[62:63], v8 offset:12288
  v_mfma_f32_16x16x32_bf16 v[24:27], a[176:179], a[80:83], v[24:27]
  ds_read_b64_tr_b16 a[196:197], v5 offset:16928
  v_mfma_f32_16x16x32_bf16 v[24:27], a[180:183], a[100:103], v[24:27]
  ds_read_b64_tr_b16 a[198:199], v6 offset:16928
  v_mfma_f32_16x16x32_bf16 v[24:27], a[184:187], a[120:123], v[24:27]
  ds_read_b64_tr_b16 a[200:201], v5 offset:16960
  v_mfma_f32_16x16x32_bf16 v[24:27], a[188:191], a[140:143], v[24:27]
  ds_read_b64_tr_b16 a[202:203], v6 offset:16960
  v_mfma_f32_16x16x32_bf16 v[28:31], a[188:191], a[144:147], 0
  ds_read_b64_tr_b16 a[204:205], v5 offset:16992
  v_mfma_f32_16x16x32_bf16 v[28:31], a[184:187], a[124:127], v[28:31]
  ds_read_b64_tr_b16 a[206:207], v6 offset:16992
  v_mfma_f32_16x16x32_bf16 v[28:31], a[180:183], a[104:107], v[28:31]
  ds_read_b64_tr_b16 a[208:209], v5 offset:17024
  v_mfma_f32_16x16x32_bf16 v[28:31], a[176:179], a[84:87], v[28:31]
  buffer_load_dwordx4 v1, s[12:15], s33 offen offset:1024 nt lds
  v_fma_f32 v24, v24, s32, v89
  v_mfma_f32_16x16x32_bf16 v[28:31], a[172:175], a[64:67], v[28:31]
  s_add_u32 m0, s29, 50752
  ds_read_b64_tr_b16 a[210:211], v6 offset:17024
  v_fma_f32 v25, v25, s32, v89
  v_mfma_f32_16x16x32_bf16 v[28:31], a[168:171], a[44:47], v[28:31]
  ds_read_b64_tr_b16 a[212:213], v5 offset:17056
  v_fma_f32 v26, v26, s32, v89
  v_mfma_f32_16x16x32_bf16 v[28:31], a[164:167], a[24:27], v[28:31]
  ds_read_b64_tr_b16 a[214:215], v6 offset:17056
  v_fma_f32 v27, v27, s32, v89
  v_mfma_f32_16x16x32_bf16 v[28:31], a[160:163], a[4:7], v[28:31]
  v_exp_f32 v24, v24
  v_mfma_f32_16x16x32_bf16 v[32:35], a[160:163], a[8:11], 0
  v_exp_f32 v25, v25
  v_mfma_f32_16x16x32_bf16 v[32:35], a[164:167], a[28:31], v[32:35]
  v_exp_f32 v26, v26
  v_mfma_f32_16x16x32_bf16 v[32:35], a[168:171], a[48:51], v[32:35]
  v_exp_f32 v27, v27
  v_mfma_f32_16x16x32_bf16 v[32:35], a[172:175], a[68:71], v[32:35]
  ds_read_b64_tr_b16 a[216:217], v5 offset:17088
  v_cvt_pk_bf16_f32 v64, v24, v25
  v_mfma_f32_16x16x32_bf16 v[32:35], a[176:179], a[88:91], v[32:35]
  buffer_load_dwordx4 v1, s[12:15], s33 offen offset:2048 nt lds
  v_cvt_pk_bf16_f32 v65, v26, v27
  v_mfma_f32_16x16x32_bf16 v[32:35], a[180:183], a[108:111], v[32:35]
  s_add_u32 m0, s29, 50784
  ds_write_b64 v7, v[64:65] offset:0
  v_mfma_f32_16x16x32_bf16 v[32:35], a[184:187], a[128:131], v[32:35]
  ds_read_b64_tr_b16 a[218:219], v6 offset:17088
  v_fma_f32 v28, v28, s32, v90
  v_mfma_f32_16x16x32_bf16 v[32:35], a[188:191], a[148:151], v[32:35]
  ds_read_b64_tr_b16 a[220:221], v5 offset:17120
  v_fma_f32 v29, v29, s32, v90
  v_mfma_f32_16x16x32_bf16 v[36:39], a[188:191], a[152:155], 0
  ds_read_b64_tr_b16 a[222:223], v6 offset:17120
  v_fma_f32 v30, v30, s32, v90
  v_mfma_f32_16x16x32_bf16 v[36:39], a[184:187], a[132:135], v[36:39]
  v_fma_f32 v31, v31, s32, v90
  v_add_f32 v84, v84, v24
  v_mfma_f32_16x16x32_bf16 v[36:39], a[180:183], a[112:115], v[36:39]
  v_exp_f32 v28, v28
  v_mfma_f32_16x16x32_bf16 v[36:39], a[176:179], a[92:95], v[36:39]
  v_exp_f32 v29, v29
  v_mfma_f32_16x16x32_bf16 v[36:39], a[172:175], a[72:75], v[36:39]
  v_exp_f32 v30, v30
  v_mfma_f32_16x16x32_bf16 v[36:39], a[168:171], a[52:55], v[36:39]
  buffer_load_dwordx4 v1, s[12:15], s33 offen offset:3072 nt lds
  v_cvt_pk_bf16_f32 v68, v28, v29
  v_mfma_f32_16x16x32_bf16 v[36:39], a[164:167], a[32:35], v[36:39]
  s_add_u32 m0, s29, 96256
  v_exp_f32 v31, v31
  v_mfma_f32_16x16x32_bf16 v[36:39], a[160:163], a[12:15], v[36:39]
  v_cvt_pk_bf16_f32 v69, v30, v31
  v_fma_f32 v32, v32, s32, v91
  v_mfma_f32_16x16x32_bf16 v[40:43], a[160:163], a[16:19], 0
  ds_write_b64 v7, v[68:69] offset:512
  v_mfma_f32_16x16x32_bf16 v[40:43], a[164:167], a[36:39], v[40:43]
  ds_read_b128 a[160:163], v4 offset:0
  v_fma_f32 v33, v33, s32, v91
  v_mfma_f32_16x16x32_bf16 v[40:43], a[168:171], a[56:59], v[40:43]
  ds_read_b128 a[164:167], v4 offset:64
  v_fma_f32 v34, v34, s32, v91
  v_mfma_f32_16x16x32_bf16 v[40:43], a[172:175], a[76:79], v[40:43]
  ds_read_b128 a[168:171], v4 offset:128
  v_fma_f32 v35, v35, s32, v91
  v_mfma_f32_16x16x32_bf16 v[40:43], a[176:179], a[96:99], v[40:43]
  v_exp_f32 v32, v32
  v_mfma_f32_16x16x32_bf16 v[40:43], a[180:183], a[116:119], v[40:43]
  v_exp_f32 v33, v33
  v_mfma_f32_16x16x32_bf16 v[40:43], a[184:187], a[136:139], v[40:43]
  buffer_load_dwordx4 v1, s[16:19], s34 offen nt lds
  v_cvt_pk_bf16_f32 v72, v32, v33
  v_mfma_f32_16x16x32_bf16 v[40:43], a[188:191], a[156:159], v[40:43]
  s_waitcnt lgkmcnt(4)
  s_add_u32 m0, s29, 96288
  v_exp_f32 v34, v34
  v_mfma_f32_16x16x32_bf16 v[96:99], v[44:47], a[192:195], v[96:99]
  v_exp_f32 v35, v35
  v_mfma_f32_16x16x32_bf16 v[100:103], v[48:51], a[192:195], v[100:103]
  ds_read_b128 a[172:175], v4 offset:192
  v_cvt_pk_bf16_f32 v73, v34, v35
  v_mfma_f32_16x16x32_bf16 v[104:107], v[52:55], a[192:195], v[104:107]
  ds_write_b64 v7, v[72:73] offset:1024
  v_mfma_f32_16x16x32_bf16 v[108:111], v[56:59], a[192:195], v[108:111]
  ds_read_b128 a[176:179], v4 offset:256
  v_fma_f32 v36, v36, s32, v92
  v_mfma_f32_16x16x32_bf16 v[112:115], v[60:63], a[192:195], v[112:115]
  ds_read_b128 a[180:183], v4 offset:320
  v_fma_f32 v37, v37, s32, v92
  v_mfma_f32_16x16x32_bf16 v[132:135], v[60:63], a[196:199], v[132:135]
  ds_read_b128 a[184:187], v4 offset:384
  v_fma_f32 v38, v38, s32, v92
  v_mfma_f32_16x16x32_bf16 v[128:131], v[56:59], a[196:199], v[128:131]
  ds_read_b128 a[188:191], v4 offset:448
  v_fma_f32 v39, v39, s32, v92
  v_mfma_f32_16x16x32_bf16 v[124:127], v[52:55], a[196:199], v[124:127]
  buffer_load_dwordx4 v1, s[16:19], s34 offen offset:1024 nt lds
  v_fma_f32 v40, v40, s32, v93
  v_mfma_f32_16x16x32_bf16 v[120:123], v[48:51], a[196:199], v[120:123]
  s_add_u32 m0, s29, 96320
  v_exp_f32 v36, v36
  v_mfma_f32_16x16x32_bf16 v[116:119], v[44:47], a[196:199], v[116:119]
  v_exp_f32 v37, v37
  v_mfma_f32_16x16x32_bf16 v[136:139], v[44:47], a[200:203], v[136:139]
  v_exp_f32 v38, v38
  v_mfma_f32_16x16x32_bf16 v[140:143], v[48:51], a[200:203], v[140:143]
  v_exp_f32 v39, v39
  v_mfma_f32_16x16x32_bf16 v[144:147], v[52:55], a[200:203], v[144:147]
  v_cvt_pk_bf16_f32 v76, v36, v37
  v_cvt_pk_bf16_f32 v77, v38, v39
  v_mfma_f32_16x16x32_bf16 v[148:151], v[56:59], a[200:203], v[148:151]
  ds_write_b64 v7, v[76:77] offset:1536
  v_mfma_f32_16x16x32_bf16 v[152:155], v[60:63], a[200:203], v[152:155]
  v_fma_f32 v41, v41, s32, v93
  v_fma_f32 v42, v42, s32, v93
  v_mfma_f32_16x16x32_bf16 v[172:175], v[60:63], a[204:207], v[172:175]
  v_fma_f32 v43, v43, s32, v93
  v_add_f32 v85, v85, v28
  v_mfma_f32_16x16x32_bf16 v[168:171], v[56:59], a[204:207], v[168:171]
  buffer_load_dwordx4 v1, s[16:19], s34 offen offset:2048 nt lds
  v_add_f32 v86, v86, v32
  v_mfma_f32_16x16x32_bf16 v[164:167], v[52:55], a[204:207], v[164:167]
  s_add_u32 m0, s29, 96352
  v_exp_f32 v40, v40
  v_mfma_f32_16x16x32_bf16 v[160:163], v[48:51], a[204:207], v[160:163]
  v_exp_f32 v41, v41
  v_mfma_f32_16x16x32_bf16 v[156:159], v[44:47], a[204:207], v[156:159]
  v_exp_f32 v42, v42
  v_mfma_f32_16x16x32_bf16 v[176:179], v[44:47], a[208:211], v[176:179]
  v_exp_f32 v43, v43
  v_mfma_f32_16x16x32_bf16 v[180:183], v[48:51], a[208:211], v[180:183]
  v_cvt_pk_bf16_f32 v80, v40, v41
  v_cvt_pk_bf16_f32 v81, v42, v43
  v_mfma_f32_16x16x32_bf16 v[184:187], v[52:55], a[208:211], v[184:187]
  ds_write_b64 v7, v[80:81] offset:2048
  v_mfma_f32_16x16x32_bf16 v[188:191], v[56:59], a[208:211], v[188:191]
  v_add_f32 v87, v87, v36
  v_add_f32 v88, v88, v40
  v_mfma_f32_16x16x32_bf16 v[192:195], v[60:63], a[208:211], v[192:195]
  v_add_f32 v84, v84, v25
  v_add_f32 v85, v85, v29
  v_mfma_f32_16x16x32_bf16 v[212:215], v[60:63], a[212:215], v[212:215]
  buffer_load_dwordx4 v1, s[16:19], s34 offen offset:3072 nt lds
  v_add_f32 v86, v86, v33
  v_mfma_f32_16x16x32_bf16 v[208:211], v[56:59], a[212:215], v[208:211]
  v_add_f32 v87, v87, v37
  v_add_f32 v88, v88, v41
  v_mfma_f32_16x16x32_bf16 v[204:207], v[52:55], a[212:215], v[204:207]
  v_add_f32 v84, v84, v26
  v_add_f32 v85, v85, v30
  v_mfma_f32_16x16x32_bf16 v[200:203], v[48:51], a[212:215], v[200:203]
  v_add_f32 v86, v86, v34
  v_add_f32 v87, v87, v38
  v_mfma_f32_16x16x32_bf16 v[196:199], v[44:47], a[212:215], v[196:199]
  v_add_f32 v88, v88, v42
  v_add_f32 v84, v84, v27
  v_mfma_f32_16x16x32_bf16 v[216:219], v[44:47], a[216:219], v[216:219]
  v_add_f32 v85, v85, v31
  v_add_f32 v86, v86, v35
  v_mfma_f32_16x16x32_bf16 v[220:223], v[48:51], a[216:219], v[220:223]
  v_add_f32 v87, v87, v39
  v_add_f32 v88, v88, v43
  v_mfma_f32_16x16x32_bf16 v[224:227], v[52:55], a[216:219], v[224:227]
  v_mfma_f32_16x16x32_bf16 v[228:231], v[56:59], a[216:219], v[228:231]
  v_mfma_f32_16x16x32_bf16 v[232:235], v[60:63], a[216:219], v[232:235]
  v_mfma_f32_16x16x32_bf16 v[252:255], v[60:63], a[220:223], v[252:255]
  s_waitcnt vmcnt(16) lgkmcnt(0)
  s_barrier
  v_mfma_f32_16x16x32_bf16 v[248:251], v[56:59], a[220:223], v[248:251]
  v_mfma_f32_16x16x32_bf16 v[244:247], v[52:55], a[220:223], v[244:247]
  v_mfma_f32_16x16x32_bf16 v[240:243], v[48:51], a[220:223], v[240:243]
  v_mfma_f32_16x16x32_bf16 v[236:239], v[44:47], a[220:223], v[236:239]
  s_branch L_preloop
L_code_end:
.section .rodata,"a"
.p2align 6
.amdhsa_kernel concat_heads__gqa_block_cached__mha_block_cached__near_ridge_kernel
  .amdhsa_next_free_vgpr 512
  .amdhsa_next_free_sgpr 102
  .amdhsa_accum_offset 256
  .amdhsa_group_segment_fixed_size 0
  .amdhsa_kernarg_size 104
  .amdhsa_user_sgpr_count 2
  .amdhsa_user_sgpr_kernarg_segment_ptr 1
  .amdhsa_system_sgpr_workgroup_id_x 1
.end_amdhsa_kernel
```
